```python
import torch

def _softmax(x, axis=-1):
    return torch.softmax(x, dim=axis)

def _gelu(x):
    return torch.nn.functional.gelu(x, approximate='tanh')

def _silu(x):
    return torch.nn.functional.silu(x)

def _sigmoid(x):
    return torch.sigmoid(x)

def _layernorm(x, axis=-1, eps=1e-05):
    m = x.mean(dim=axis, keepdim=True)
    v = x.var(dim=axis, keepdim=True, unbiased=False)
    return (x - m) / torch.sqrt(v + eps)

def _scatter_add(tgt, idx, src, axis=0):
    return tgt.clone().index_add_(axis, idx, src)

def _segment_sum(src, seg, n):
    out = torch.zeros((n,) + src.shape[1:], dtype=src.dtype)
    return out.index_add_(0, seg, src)

def _pad(x, pw):
    flat = tuple((v for pair in reversed(pw) for v in pair))
    return torch.nn.functional.pad(x, flat)
kernel_name = 'adaLN_cond__sliding_block__dense_activation_relu__prompt'

def setup_inputs():

    _w = lambda a: (lambda t: t.to(torch.bfloat16) if t.is_floating_point() else t)(torch.as_tensor(a))

    def _A_setup():
        B, S, D = (1, 2048, 512)
        return {'x': _w((lambda *s: torch.randn(*s, dtype=torch.bfloat16) * 0.05)(B, S, D)), 'wqkv': _w((lambda *s: torch.randn(*s, dtype=torch.bfloat16) * 0.05)(D, 3 * D)), 'wo': _w((lambda *s: torch.randn(*s, dtype=torch.bfloat16) * 0.05)(D, D))}
    _A_in = _A_setup()

    def _B_setup():
        B, S, D, Dff = (1, 2048, 512, 1792)
        return {'x': _w((lambda *s: torch.randn(*s, dtype=torch.bfloat16) * 0.05)(B, S, D)), 'w1': _w((lambda *s: torch.randn(*s, dtype=torch.bfloat16) * 0.05)(D, Dff)), 'w2': _w((lambda *s: torch.randn(*s, dtype=torch.bfloat16) * 0.05)(Dff, D))}
    _B_in = _B_setup()
    return {'A_x': _A_in['x'], 'A_wqkv': _A_in['wqkv'], 'A_wo': _A_in['wo'], 'B_x': _B_in['x'], 'B_w1': _B_in['w1'], 'B_w2': _B_in['w2'], 'c': _w((lambda *s: torch.randn(*s, dtype=torch.bfloat16) * 0.1)(1, 512) * 8.0), 'w_mod': _w((lambda *s: torch.randn(*s, dtype=torch.bfloat16) * 0.1)(512, 6 * 512) * 512 ** (-0.5) * 8.0)}

def reference(A_x, A_wqkv, A_wo, B_x, B_w1, B_w2, c, w_mod):

    def _A_ref(x, wqkv, wo):
        B, S, D = x.shape
        H = 32
        Dh = D // H
        W = 256
        qkv = (lambda x, *d: x.permute(*d))((x @ wqkv).reshape(B, S, 3, H, Dh), 2, 0, 3, 1, 4)
        q, k, v = (qkv[0], qkv[1], qkv[2])
        scores = torch.einsum('bhqd,bhkd->bhqk', q, k) * Dh ** (-0.5)
        idx = torch.arange(S)
        mask = (idx[:, None] - idx[None, :] >= 0) & (idx[:, None] - idx[None, :] < W)
        scores = torch.where(mask[None, None], scores, -1000000000.0)
        p = _softmax(scores, axis=-1)
        o = torch.einsum('bhqk,bhkd->bhqd', p, v)
        return (lambda x, *d: x.permute(*d))(o, 0, 2, 1, 3).reshape(B, S, D) @ wo

    def _B_ref(x, w1, w2):
        h = torch.einsum('bsd,df->bsf', x, w1)
        zero = torch.zeros_like(h)
        h = torch.maximum(h, zero)
        return torch.einsum('bsf,fd->bsd', h, w2)
    x = A_x
    mod = (_silu(c) @ w_mod).reshape(c.shape[0], 6, 1, -1)
    sa, ca, ga, sb, cb, gb = (mod[:, 0].clone(), mod[:, 1].clone(), mod[:, 2].clone(), mod[:, 3].clone(), mod[:, 4].clone(), mod[:, 5].clone())
    h = _layernorm(x, axis=-1) * (1 + ca) + sa
    x = x + ga * _A_ref(h, A_wqkv, A_wo)
    h = _layernorm(x, axis=-1) * (1 + cb) + sb
    x = x + gb * _B_ref(h, B_w1, B_w2)
    return x
```

```asm
; @launch grid=(256,1,1) block=(256,1,1) lds=163840
.amdgcn_target "amdgcn-amd-amdhsa--gfx950"
.text
.globl adaLN_cond__sliding_block__dense_activation_relu__prompt_kernel
.p2align 8
.type adaLN_cond__sliding_block__dense_activation_relu__prompt_kernel,@function
adaLN_cond__sliding_block__dense_activation_relu__prompt_kernel:
    s_load_dwordx16 s[8:23], s[0:1], 0
    s_load_dwordx4 s[24:27], s[0:1], 64
    s_load_dwordx2 s[28:29], s[0:1], 80
    s_cmp_ge_u32 s2, 256
    s_cbranch_scc1 L_exit
    s_getpc_b64 s[30:31]
L_pc:
    s_lshr_b32 s4, s2, 3
    s_lshl_b32 s79, s4, 10
    v_lshl_add_u32 v145, v0, 2, s79
    v_readfirstlane_b32 s5, v0
    global_load_dword v152, v145, s[30:31]
    s_and_b32 s3, s2, 7
    v_and_b32 v148, 7, v0
    v_bfe_u32 v149, v0, 3, 3
    s_lshr_b32 s5, s5, 6
    s_lshl_b32 s77, s3, 1
    s_lshl2_add_u32 s78, s3, 14
    s_cmp_lt_u32 s4, 8
    s_cselect_b32 s77, s77, s78
    s_lshr_b32 s78, s4, 2
    s_add_u32 s81, s77, s78
    s_and_b32 s71, s4, 3
    s_lshl2_add_u32 s77, s71, s5
    s_lshl_b32 s78, s77, 6
    s_mulk_i32 s77, 1536
    s_add_u32 s77, s77, s81
    s_lshl_b32 s77, s77, 7
    s_movk_i32 s80, 6144
    v_lshlrev_b32 v11, 3, v149
    v_mul_u32_u24 v13, s80, v149
    v_lshl_add_u32 v13, v148, 2, v13
    v_lshlrev_b32 v13, 2, v13
    s_cmp_lt_u32 s4, 24
    s_cselect_b32 s62, 0x300000, 0
    s_cselect_b32 s77, s77, 0
    s_cselect_b32 s80, s80, 0
    s_mov_b32 s63, 0x20000
    s_movk_i32 s66, 1024
    s_mov_b32 s67, s63
    s_waitcnt lgkmcnt(0)
    s_mov_b64 s[64:65], s[20:21]
    s_mov_b64 s[60:61], s[22:23]
    buffer_load_dwordx2 v[62:63], v11, s[64:67], s78 offen
    buffer_load_dwordx4 v[64:67], v13, s[60:63], s77 offen nt
    s_add_u32 s77, s77, s80
    buffer_load_dwordx4 v[68:71], v13, s[60:63], s77 offen nt
    s_add_u32 s77, s77, s80
    buffer_load_dwordx4 v[72:75], v13, s[60:63], s77 offen nt
    s_add_u32 s77, s77, s80
    buffer_load_dwordx4 v[76:79], v13, s[60:63], s77 offen nt
    s_load_dword s69, s[28:29], 0
    s_mov_b64 s[32:33], s[8:9]
    s_mov_b32 s34, 0x200000
    s_mov_b32 s35, 0x20000
    v_and_b32 v1, 63, v0
    v_lshlrev_b32 v10, 10, v148
    v_lshl_add_u32 v10, v149, 4, v10
    s_lshl_b32 s75, s3, 5
    s_add_u32 s75, s75, s4
    s_lshl_b32 s76, s75, 13
    s_lshl_b32 s79, s5, 8
    s_add_u32 s76, s76, s79
    s_barrier
    buffer_load_dwordx4 v[16:19], v10, s[32:35], s76 offen
    buffer_load_dwordx4 v[20:23], v10, s[32:35], s76 offen offset:128
    s_mov_b64 s[36:37], s[10:11]
    s_mov_b32 s38, 0x180000
    s_mov_b32 s39, 0x20000
    s_lshl2_add_u32 s65, s75, s5
    s_mul_i32 s65, s65, 1536
    v_lshlrev_b32 v144, 7, v1
    s_mov_b64 exec, 0xfff
    buffer_load_dword v155, v144, s[36:39], s65 offen
    s_mov_b64 exec, -1
    s_mov_b64 s[52:53], s[28:29]
    s_mov_b32 s54, 0x1600000
    s_mov_b32 s55, 0x20000
    s_and_b32 s7, s4, 15
    s_lshr_b32 s76, s4, 4
    s_lshl2_add_u32 s76, s76, s5
    s_lshl3_add_u32 s6, s3, s76
    s_lshr_b32 s76, s75, 2
    s_lshl2_add_u32 s76, s76, s5
    s_lshl_b32 s76, s76, 13
    s_lshl_b32 s77, s71, 7
    s_add_u32 s76, s76, s77
    s_add_u32 s100, s76, 4194304
    v_lshl_add_u32 v11, v1, 9, s100
    s_lshl_b32 s76, s6, 8
    s_add_u32 s76, s76, 4096
    v_lshl_add_u32 v103, v1, 2, s76
    v_writelane_b32 v11, s76, 16
    s_add_u32 s76, s76, 128
    v_writelane_b32 v11, s76, 17
    s_lshl_b32 s76, s3, 7
    s_add_u32 s76, s76, 24576
    v_writelane_b32 v11, s76, 18
    s_mul_i32 s76, s71, 48
    s_add_u32 s76, s76, s81
    s_and_b32 s77, s5, 1
    s_lshl1_add_u32 s76, s76, s77
    s_lshl_b32 s76, s76, 7
    s_add_u32 s76, s76, 327680
    v_writelane_b32 v11, s76, 19
    s_mov_b64 exec, 0xf0000
    buffer_load_dword v154, v11, s[52:55], 0 offen sc1
    s_mov_b64 exec, -1
    v_lshlrev_b32 v2, 4, v1
    s_mov_b64 s[44:45], s[16:17]
    s_mov_b32 s46, 0x1c0000
    s_mov_b32 s47, 0x20000
    v_lshrrev_b32 v12, 2, v1
    v_mul_u32_u24 v12, 3072, v12
    v_and_b32 v11, 3, v1
    v_lshl_add_u32 v96, v11, 4, v12
    s_lshl_b32 s76, s7, 6
    v_add_u32 v96, s76, v96
    s_lshr_b32 s76, s4, 4
    s_and_b32 s77, s4, 1
    s_lshl1_add_u32 s77, s76, s77
    s_lshr_b32 s76, s7, 1
    s_cmp_eq_u32 s76, 3
    s_cselect_b32 s82, s77, 0
    s_xor_b32 s76, s82, 0
    s_and_b32 s77, s76, 1
    s_lshl1_add_u32 s77, s5, s77
    s_lshr_b32 s76, s76, 1
    s_mul_i32 s78, s77, 192
    s_add_u32 s78, s78, s76
    s_lshl_b32 s78, s78, 10
    s_add_u32 s8, s78, 1024
    s_lshl3_add_u32 s77, s76, s77
    s_lshl_b32 s20, s77, 12
    s_xor_b32 s76, s82, 1
    s_and_b32 s77, s76, 1
    s_lshl1_add_u32 s77, s5, s77
    s_lshr_b32 s76, s76, 1
    s_mul_i32 s78, s77, 192
    s_add_u32 s78, s78, s76
    s_lshl_b32 s78, s78, 10
    s_add_u32 s9, s78, 1024
    s_lshl3_add_u32 s77, s76, s77
    s_lshl_b32 s21, s77, 12
    s_xor_b32 s76, s82, 2
    s_and_b32 s77, s76, 1
    s_lshl1_add_u32 s77, s5, s77
    s_lshr_b32 s76, s76, 1
    s_mul_i32 s78, s77, 192
    s_add_u32 s78, s78, s76
    s_lshl_b32 s78, s78, 10
    s_add_u32 s14, s78, 1024
    s_lshl3_add_u32 s77, s76, s77
    s_lshl_b32 s22, s77, 12
    s_xor_b32 s76, s82, 3
    s_and_b32 s77, s76, 1
    s_lshl1_add_u32 s77, s5, s77
    s_lshr_b32 s76, s76, 1
    s_mul_i32 s78, s77, 192
    s_add_u32 s78, s78, s76
    s_lshl_b32 s78, s78, 10
    s_add_u32 s15, s78, 1024
    s_lshl3_add_u32 s77, s76, s77
    s_lshl_b32 s23, s77, 12
    v_lshrrev_b32 v12, 5, v1
    v_lshl_add_u32 v12, v12, 3, v148
    s_lshl2_add_u32 s76, s5, 114688
    v_lshl_add_u32 v160, v12, 4, s76
    v_lshlrev_b32 v161, 4, v148
    v_add_u32 v161, 114688, v161
    v_lshrrev_b32 v11, 4, v1
    v_lshl_add_u32 v11, v148, 2, v11
    s_lshl_b32 s77, s5, 8
    s_add_u32 s77, s77, 115712
    v_lshl_add_u32 v11, v11, 3, s77
    v_and_b32 v12, 0xf0, v2
    v_add_u32 v15, 115712, v12
    s_mul_i32 s77, s71, 48
    s_add_u32 s77, s77, s81
    s_lshl_b32 s77, s77, 8
    s_add_u32 s77, s77, 327680
    s_getreg_b32 s83, hwreg(HW_REG_XCC_ID, 0, 4)
    s_waitcnt vmcnt(8)
    v_lshlrev_b32 v40, 16, v62
    v_and_b32 v41, 0xffff0000, v62
    v_lshlrev_b32 v42, 16, v63
    v_and_b32 v43, 0xffff0000, v63
    v_mul_f32 v44, 0xbfb8aa3b, v40
    v_mul_f32 v45, 0xbfb8aa3b, v41
    v_mul_f32 v46, 0xbfb8aa3b, v42
    v_mul_f32 v47, 0xbfb8aa3b, v43
    v_exp_f32 v44, v44
    v_exp_f32 v45, v45
    v_exp_f32 v46, v46
    v_exp_f32 v47, v47
    v_add_f32 v44, 1.0, v44
    v_add_f32 v45, 1.0, v45
    v_add_f32 v46, 1.0, v46
    v_add_f32 v47, 1.0, v47
    v_rcp_f32 v44, v44
    v_rcp_f32 v45, v45
    v_rcp_f32 v46, v46
    v_rcp_f32 v47, v47
    v_pk_mul_f32 v[40:41], v[40:41], v[44:45]
    v_pk_mul_f32 v[42:43], v[42:43], v[46:47]
    v_cvt_pk_bf16_f32 v44, v40, v41
    v_cvt_pk_bf16_f32 v45, v42, v43
    v_lshlrev_b32 v40, 16, v44
    v_and_b32 v41, 0xffff0000, v44
    v_lshlrev_b32 v42, 16, v45
    v_and_b32 v43, 0xffff0000, v45
    s_waitcnt vmcnt(7)
    v_lshlrev_b32 v80, 16, v64
    v_and_b32 v81, 0xffff0000, v64
    v_lshlrev_b32 v82, 16, v65
    v_and_b32 v83, 0xffff0000, v65
    v_lshlrev_b32 v84, 16, v66
    v_and_b32 v85, 0xffff0000, v66
    v_lshlrev_b32 v86, 16, v67
    v_and_b32 v87, 0xffff0000, v67
    v_pk_mul_f32 v[48:49], v[80:81], v[40:41] op_sel_hi:[1,0]
    v_pk_mul_f32 v[50:51], v[82:83], v[40:41] op_sel_hi:[1,0]
    v_pk_mul_f32 v[52:53], v[84:85], v[40:41] op_sel_hi:[1,0]
    v_pk_mul_f32 v[54:55], v[86:87], v[40:41] op_sel_hi:[1,0]
    s_waitcnt vmcnt(6)
    v_lshlrev_b32 v80, 16, v68
    v_and_b32 v81, 0xffff0000, v68
    v_lshlrev_b32 v82, 16, v69
    v_and_b32 v83, 0xffff0000, v69
    v_lshlrev_b32 v84, 16, v70
    v_and_b32 v85, 0xffff0000, v70
    v_lshlrev_b32 v86, 16, v71
    v_and_b32 v87, 0xffff0000, v71
    v_pk_fma_f32 v[48:49], v[80:81], v[40:41], v[48:49] op_sel:[0,1,0] op_sel_hi:[1,1,1]
    v_pk_fma_f32 v[50:51], v[82:83], v[40:41], v[50:51] op_sel:[0,1,0] op_sel_hi:[1,1,1]
    v_pk_fma_f32 v[52:53], v[84:85], v[40:41], v[52:53] op_sel:[0,1,0] op_sel_hi:[1,1,1]
    v_pk_fma_f32 v[54:55], v[86:87], v[40:41], v[54:55] op_sel:[0,1,0] op_sel_hi:[1,1,1]
    s_waitcnt vmcnt(5)
    v_lshlrev_b32 v80, 16, v72
    v_and_b32 v81, 0xffff0000, v72
    v_lshlrev_b32 v82, 16, v73
    v_and_b32 v83, 0xffff0000, v73
    v_lshlrev_b32 v84, 16, v74
    v_and_b32 v85, 0xffff0000, v74
    v_lshlrev_b32 v86, 16, v75
    v_and_b32 v87, 0xffff0000, v75
    v_pk_fma_f32 v[48:49], v[80:81], v[42:43], v[48:49] op_sel:[0,0,0] op_sel_hi:[1,0,1]
    v_pk_fma_f32 v[50:51], v[82:83], v[42:43], v[50:51] op_sel:[0,0,0] op_sel_hi:[1,0,1]
    v_pk_fma_f32 v[52:53], v[84:85], v[42:43], v[52:53] op_sel:[0,0,0] op_sel_hi:[1,0,1]
    v_pk_fma_f32 v[54:55], v[86:87], v[42:43], v[54:55] op_sel:[0,0,0] op_sel_hi:[1,0,1]
    s_waitcnt vmcnt(4)
    v_lshlrev_b32 v80, 16, v76
    v_and_b32 v81, 0xffff0000, v76
    v_lshlrev_b32 v82, 16, v77
    v_and_b32 v83, 0xffff0000, v77
    v_lshlrev_b32 v84, 16, v78
    v_and_b32 v85, 0xffff0000, v78
    v_lshlrev_b32 v86, 16, v79
    v_and_b32 v87, 0xffff0000, v79
    v_pk_fma_f32 v[48:49], v[80:81], v[42:43], v[48:49] op_sel:[0,1,0] op_sel_hi:[1,1,1]
    v_pk_fma_f32 v[50:51], v[82:83], v[42:43], v[50:51] op_sel:[0,1,0] op_sel_hi:[1,1,1]
    v_pk_fma_f32 v[52:53], v[84:85], v[42:43], v[52:53] op_sel:[0,1,0] op_sel_hi:[1,1,1]
    v_pk_fma_f32 v[54:55], v[86:87], v[42:43], v[54:55] op_sel:[0,1,0] op_sel_hi:[1,1,1]
    s_nop 0
    v_permlane32_swap_b32 v48, v52
    v_permlane32_swap_b32 v49, v53
    v_permlane32_swap_b32 v50, v54
    v_permlane32_swap_b32 v51, v55
    v_pk_add_f32 v[48:49], v[48:49], v[52:53]
    v_pk_add_f32 v[50:51], v[50:51], v[54:55]
    s_waitcnt lgkmcnt(0)
    s_mul_i32 s68, s69, 0x9e3779c1
    v_permlane16_swap_b32 v48, v50
    v_permlane16_swap_b32 v49, v51
    v_pk_add_f32 v[48:49], v[48:49], v[50:51]
    s_add_u32 s68, s68, 0x7f4a7c21
    v_mov_b32 v3, s68
    v_add_f32_dpp v50, v48, v48 row_ror:8 row_mask:0xf bank_mask:0xf
    v_add_f32_dpp v51, v49, v49 row_ror:8 row_mask:0xf bank_mask:0xf
    ds_write_b64 v11, v[50:51]
    s_bfe_u32 s40, s68, 0x80000
    s_bfe_u32 s41, s68, 0x80008
    s_bfe_u32 s42, s68, 0x80010
    s_bfe_u32 s43, s68, 0x80018
    s_add_u32 s83, s83, s68
    s_add_u32 s83, s83, 1
    v_mov_b32 v147, s83
    v_mov_b32 v10, 0xffffff00
    s_cmp_ge_u32 s4, 24
    s_cselect_b32 s76, 1, s5
    s_cmp_lg_u32 s76, 0
    s_waitcnt lgkmcnt(0)
    s_barrier
    s_cbranch_scc1 L_nopub_1
    ds_read_b128 v[64:67], v15 offset:0
    ds_read_b128 v[68:71], v15 offset:256
    ds_read_b128 v[72:75], v15 offset:512
    ds_read_b128 v[76:79], v15 offset:768
    s_mov_b64 exec, 0xffff
    s_waitcnt lgkmcnt(0)
    v_pk_add_f32 v[64:65], v[64:65], v[68:69]
    v_pk_add_f32 v[72:73], v[72:73], v[76:77]
    v_pk_add_f32 v[66:67], v[66:67], v[70:71]
    v_pk_add_f32 v[74:75], v[74:75], v[78:79]
    v_pk_add_f32 v[64:65], v[64:65], v[72:73]
    v_pk_add_f32 v[66:67], v[66:67], v[74:75]
    v_add_u32 v64, 0x80, v64
    v_add_u32 v65, 0x80, v65
    v_add_u32 v66, 0x80, v66
    v_add_u32 v67, 0x80, v67
    v_and_or_b32 v64, v64, v10, s40
    v_and_or_b32 v65, v65, v10, s41
    v_and_or_b32 v66, v66, v10, s42
    v_and_or_b32 v67, v67, v10, s43
    buffer_store_dwordx4 v[64:67], v12, s[52:55], s77 offen sc1
    s_mov_b64 exec, -1
L_nopub_1:
    s_cmp_lg_u32 s5, 1
    s_cbranch_scc1 L_noxc_2
    s_lshl2_add_u32 s76, s75, 24576
    s_mov_b64 exec, 1
    buffer_store_dword v147, off, s[52:55], s76
    s_mov_b64 exec, -1
L_noxc_2:
    s_and_b32 s69, s82, 2
    s_lshl_b32 s69, s69, 1
    s_mov_b32 s0, s8
    s_mov_b32 s1, s20
    s_add_u32 m0, s1, 0
    s_nop 0
    buffer_load_dwordx4 v96, s[36:39], s0 offen lds
    s_add_u32 m0, s1, 1024
    s_add_u32 s0, s0, 49152
    buffer_load_dwordx4 v96, s[36:39], s0 offen lds
    s_add_u32 m0, s1, 2048
    s_add_u32 s0, s0, 49152
    buffer_load_dwordx4 v96, s[36:39], s0 offen lds
    s_add_u32 m0, s1, 3072
    s_add_u32 s0, s0, 49152
    buffer_load_dwordx4 v96, s[36:39], s0 offen lds
    s_waitcnt vmcnt(6)
    v_lshlrev_b32 v24, 16, v16
    v_and_b32 v25, 0xffff0000, v16
    v_lshlrev_b32 v26, 16, v17
    v_and_b32 v27, 0xffff0000, v17
    v_lshlrev_b32 v28, 16, v18
    v_and_b32 v29, 0xffff0000, v18
    v_lshlrev_b32 v30, 16, v19
    v_and_b32 v31, 0xffff0000, v19
    v_lshlrev_b32 v32, 16, v20
    v_and_b32 v33, 0xffff0000, v20
    v_lshlrev_b32 v34, 16, v21
    v_and_b32 v35, 0xffff0000, v21
    v_lshlrev_b32 v36, 16, v22
    v_and_b32 v37, 0xffff0000, v22
    v_lshlrev_b32 v38, 16, v23
    v_and_b32 v39, 0xffff0000, v23
    v_pk_add_f32 v[40:41], v[24:25], v[26:27]
    v_pk_mul_f32 v[42:43], v[24:25], v[24:25]
    v_pk_fma_f32 v[42:43], v[26:27], v[26:27], v[42:43]
    v_pk_add_f32 v[40:41], v[40:41], v[28:29]
    v_pk_fma_f32 v[42:43], v[28:29], v[28:29], v[42:43]
    v_pk_add_f32 v[40:41], v[40:41], v[30:31]
    v_pk_fma_f32 v[42:43], v[30:31], v[30:31], v[42:43]
    v_pk_add_f32 v[40:41], v[40:41], v[32:33]
    v_pk_fma_f32 v[42:43], v[32:33], v[32:33], v[42:43]
    v_pk_add_f32 v[40:41], v[40:41], v[34:35]
    v_pk_fma_f32 v[42:43], v[34:35], v[34:35], v[42:43]
    v_pk_add_f32 v[40:41], v[40:41], v[36:37]
    v_pk_fma_f32 v[42:43], v[36:37], v[36:37], v[42:43]
    v_pk_add_f32 v[40:41], v[40:41], v[38:39]
    v_pk_fma_f32 v[42:43], v[38:39], v[38:39], v[42:43]
    v_add_f32 v40, v40, v41
    v_add_f32 v42, v42, v43
    s_nop 1
    v_permlane32_swap_b32 v40, v42
    v_add_f32 v40, v40, v42
    v_mov_b32 v41, v40
    s_nop 1
    v_permlane16_swap_b32 v40, v41
    v_add_f32 v40, v40, v41
    s_nop 1
    v_add_f32_dpp v41, v40, v40 row_ror:8 row_mask:0xf bank_mask:0xf
    ds_write_b32 v160, v41
    s_waitcnt lgkmcnt(0)
    s_barrier
    s_mov_b32 s0, s9
    s_mov_b32 s1, s21
    s_add_u32 m0, s1, 0
    s_nop 0
    buffer_load_dwordx4 v96, s[36:39], s0 offen lds
    s_add_u32 m0, s1, 1024
    s_add_u32 s0, s0, 49152
    buffer_load_dwordx4 v96, s[36:39], s0 offen lds
    s_add_u32 m0, s1, 2048
    s_add_u32 s0, s0, 49152
    buffer_load_dwordx4 v96, s[36:39], s0 offen lds
    s_add_u32 m0, s1, 3072
    s_add_u32 s0, s0, 49152
    buffer_load_dwordx4 v96, s[36:39], s0 offen lds
    s_mov_b32 s0, s14
    s_mov_b32 s1, s22
    s_add_u32 m0, s1, 0
    s_nop 0
    buffer_load_dwordx4 v96, s[36:39], s0 offen lds
    s_mov_b32 s90, 0x33337337
    s_mov_b32 s91, 0x33373337
    s_lshl2_add_u32 s76, s7, s5
    s_bitcmp1_b64 s[90:91], s76
    s_cselect_b32 s64, 0, -1
    s_bfm_b64 s[98:99], s76, 0
    s_and_b64 s[90:91], s[90:91], s[98:99]
    s_bcnt1_i32_b64 s67, s[90:91]
    s_lshr_b32 s76, s4, 4
    s_mul_i32 s76, s76, 36
    s_add_u32 s67, s67, s76
    s_cmp_lt_u32 s67, 56
    s_cselect_b64 s[48:49], s[18:19], s[12:13]
    s_cselect_b32 s50, 7, 2
    s_lshl_b32 s50, s50, 18
    s_mov_b32 s51, 0x20000
    s_cmp_lt_u32 s67, 56
    s_cselect_b32 s76, 0, 56
    s_cselect_b32 s77, 56, 16
    s_cselect_b32 s79, 2, 1
    s_cselect_b32 s80, 10, 11
    s_lshl_b32 s78, s79, 20
    s_lshl_b32 s79, s79, 10
    s_sub_u32 s76, s67, s76
    s_mul_i32 s77, s77, s3
    s_add_u32 s77, s77, s76
    s_lshl_b32 s77, s77, 12
    s_add_u32 s77, s77, s78
    s_or_b32 s64, s64, s77
    s_lshl_b32 s76, s76, 15
    s_lshl_b32 s77, s3, 7
    s_add_u32 s2, s76, s77
    v_lshrrev_b32 v98, 5, v1
    v_lshlrev_b32 v98, s80, v98
    v_bfe_u32 v99, v1, 2, 3
    v_lshl_add_u32 v98, v99, 7, v98
    v_and_b32 v99, 3, v1
    v_lshl_add_u32 v98, v99, 5, v98
    s_lshl_b32 s76, s5, 12
    s_add_u32 s76, s76, 98304
    v_add_u32 v98, s76, v98
    v_add_u32 v99, s79, v98
    s_add_u32 s67, s67, s77
    s_lshl_b32 s67, s67, 6
    s_add_u32 s67, s67, 196608
    v_lshrrev_b32 v10, 3, v1
    v_mul_u32_u24 v10, 896, v10
    v_add_u32 v97, v10, v2
    v_and_b32 v151, 31, v1
    v_lshrrev_b32 v12, 5, v1
    s_lshl_b32 s76, s5, 9
    v_lshl_add_u32 v156, v151, 4, s76
    v_lshl_add_u32 v156, v12, 11, v156
    v_cvt_f32_u32 v150, v12
    s_mov_b32 s92, 327680
    s_mov_b32 s93, 339968
    s_mov_b32 s94, 352256
    s_mov_b32 s95, 364544
    s_lshl_b32 s76, s3, 7
    s_add_u32 s76, s76, 24576
    v_lshl_add_u32 v157, v151, 2, s76
    s_lshl_b32 s77, s5, 10
    s_add_u32 s77, s77, 118784
    v_add_u32 v158, s77, v2
    v_lshl_add_u32 v159, v149, 5, s77
    v_lshlrev_b32 v12, 9, v149
    v_lshl_add_u32 v146, v148, 4, v12
    s_mov_b64 s[56:57], s[24:25]
    s_mov_b32 s58, 0x200000
    s_mov_b32 s59, 0x20000
    s_and_b32 s70, s4, 7
    s_lshr_b32 s76, s4, 3
    s_lshl_b32 s76, s76, 1
    s_lshl3_add_u32 s74, s3, s76
    s_mov_b32 s72, s5
    s_lshl1_add_u32 s73, s74, s72
    s_mov_b32 s86, 0x0000ffff
    s_mov_b32 s87, 0x0000ffff
    s_mov_b32 s88, 0xffff0000
    s_mov_b32 s89, 0xffff0000
    v_and_b32 v12, 3, v1
    v_lshlrev_b32 v13, 3, v12
    v_bfe_u32 v12, v1, 4, 1
    v_lshl_add_u32 v13, v12, 5, v13
    v_bfe_u32 v12, v1, 2, 2
    v_lshl_add_u32 v13, v12, 6, v13
    v_lshrrev_b32 v12, 5, v1
    v_lshl_add_u32 v13, v12, 9, v13
    v_add_u32 v14, 65536, v13
    s_lshl_b32 s77, s6, 15
    s_add_u32 s31, s77, 4194304
    s_mov_b64 s[84:85], 0xffff
    s_lshr_b32 s80, s75, 2
    s_lshl4_add_u32 s80, s80, s71
    s_lshl2_add_u32 s80, s80, s5
    s_lshl2_add_u32 s80, s80, 4096
    buffer_load_dword v58, v157, s[52:55], 0 offen sc1
    buffer_load_dwordx4 v[40:43], v156, s[52:55], s92 offen sc1
    buffer_load_dwordx4 v[44:47], v156, s[52:55], s93 offen sc1
    buffer_load_dwordx4 v[48:51], v156, s[52:55], s94 offen sc1
    buffer_load_dwordx4 v[52:55], v156, s[52:55], s95 offen sc1
    s_add_u32 m0, s1, 1024
    s_add_u32 s0, s0, 49152
    buffer_load_dwordx4 v96, s[36:39], s0 offen lds
    s_add_u32 m0, s1, 2048
    s_add_u32 s0, s0, 49152
    buffer_load_dwordx4 v96, s[36:39], s0 offen lds
    s_add_u32 m0, s1, 3072
    s_add_u32 s0, s0, 49152
    buffer_load_dwordx4 v96, s[36:39], s0 offen lds
    s_mov_b32 s0, s15
    s_mov_b32 s1, s23
    s_add_u32 m0, s1, 0
    s_nop 0
    buffer_load_dwordx4 v96, s[36:39], s0 offen lds
    ds_read_b128 v[64:67], v161
    ds_read_b128 v[68:71], v161 offset:128
    s_waitcnt lgkmcnt(0)
    v_pk_add_f32 v[64:65], v[64:65], v[66:67]
    v_pk_add_f32 v[68:69], v[68:69], v[70:71]
    v_add_f32 v64, v64, v65
    v_add_f32 v68, v68, v69
    v_mul_f32 v64, 0x3b000000, v64
    v_mul_f32 v68, 0x3b000000, v68
    v_fma_f32 v68, -v64, v64, v68
    v_max_f32 v68, 0, v68
    v_add_f32 v68, 0x3727c5ac, v68
    v_rsq_f32 v60, v68
    s_nop 0
    v_mul_f32 v61, -v64, v60
    v_pk_fma_f32 v[24:25], v[24:25], v[60:61], v[60:61] op_sel:[0,0,1] op_sel_hi:[1,0,1]
    v_pk_fma_f32 v[26:27], v[26:27], v[60:61], v[60:61] op_sel:[0,0,1] op_sel_hi:[1,0,1]
    v_pk_fma_f32 v[28:29], v[28:29], v[60:61], v[60:61] op_sel:[0,0,1] op_sel_hi:[1,0,1]
    v_pk_fma_f32 v[30:31], v[30:31], v[60:61], v[60:61] op_sel:[0,0,1] op_sel_hi:[1,0,1]
    v_pk_fma_f32 v[32:33], v[32:33], v[60:61], v[60:61] op_sel:[0,0,1] op_sel_hi:[1,0,1]
    v_pk_fma_f32 v[34:35], v[34:35], v[60:61], v[60:61] op_sel:[0,0,1] op_sel_hi:[1,0,1]
    v_pk_fma_f32 v[36:37], v[36:37], v[60:61], v[60:61] op_sel:[0,0,1] op_sel_hi:[1,0,1]
    v_pk_fma_f32 v[38:39], v[38:39], v[60:61], v[60:61] op_sel:[0,0,1] op_sel_hi:[1,0,1]
    s_waitcnt vmcnt(7)
    v_xor_b32 v40, s40, v40
    v_xor_b32 v41, s41, v41
    v_xor_b32 v42, s42, v42
    v_xor_b32 v43, s43, v43
    v_or3_b32 v56, v40, v41, v42
    v_or_b32 v56, v56, v43
    s_waitcnt vmcnt(6)
    v_xor_b32 v44, s40, v44
    v_xor_b32 v45, s41, v45
    v_xor_b32 v46, s42, v46
    v_xor_b32 v47, s43, v47
    v_or3_b32 v56, v44, v45, v56
    v_or3_b32 v56, v46, v47, v56
    s_waitcnt vmcnt(5)
    v_xor_b32 v48, s40, v48
    v_xor_b32 v49, s41, v49
    v_xor_b32 v50, s42, v50
    v_xor_b32 v51, s43, v51
    v_or3_b32 v56, v48, v49, v56
    v_or3_b32 v56, v50, v51, v56
    s_waitcnt vmcnt(4)
    v_xor_b32 v52, s40, v52
    v_xor_b32 v53, s41, v53
    v_xor_b32 v54, s42, v54
    v_xor_b32 v55, s43, v55
    v_or3_b32 v56, v52, v53, v56
    v_or3_b32 v56, v54, v55, v56
    v_and_b32 v56, 0xff, v56
    v_cmp_ne_u32 vcc, 0, v56
    s_mov_b32 s82, 0
    s_cbranch_vccz L_dmod_4
L_pmod_3:
    buffer_load_dword v58, v157, s[52:55], 0 offen sc1
    buffer_load_dwordx4 v[40:43], v156, s[52:55], s92 offen sc1
    buffer_load_dwordx4 v[44:47], v156, s[52:55], s93 offen sc1
    buffer_load_dwordx4 v[48:51], v156, s[52:55], s94 offen sc1
    buffer_load_dwordx4 v[52:55], v156, s[52:55], s95 offen sc1
    s_add_u32 s82, s82, 1
    s_waitcnt vmcnt(3)
    v_xor_b32 v40, s40, v40
    v_xor_b32 v41, s41, v41
    v_xor_b32 v42, s42, v42
    v_xor_b32 v43, s43, v43
    v_or3_b32 v56, v40, v41, v42
    v_or_b32 v56, v56, v43
    s_waitcnt vmcnt(2)
    v_xor_b32 v44, s40, v44
    v_xor_b32 v45, s41, v45
    v_xor_b32 v46, s42, v46
    v_xor_b32 v47, s43, v47
    v_or3_b32 v56, v44, v45, v56
    v_or3_b32 v56, v46, v47, v56
    s_waitcnt vmcnt(1)
    v_xor_b32 v48, s40, v48
    v_xor_b32 v49, s41, v49
    v_xor_b32 v50, s42, v50
    v_xor_b32 v51, s43, v51
    v_or3_b32 v56, v48, v49, v56
    v_or3_b32 v56, v50, v51, v56
    s_waitcnt vmcnt(0)
    v_xor_b32 v52, s40, v52
    v_xor_b32 v53, s41, v53
    v_xor_b32 v54, s42, v54
    v_xor_b32 v55, s43, v55
    v_or3_b32 v56, v52, v53, v56
    v_or3_b32 v56, v54, v55, v56
    v_and_b32 v56, 0xff, v56
    v_cmp_ne_u32 vcc, 0, v56
    s_cmp_lt_u32 s82, 131072
    s_cbranch_vccz L_dmod_4
    s_cbranch_scc1 L_pmod_3
L_dmod_4:
    v_cmp_ne_u32 vcc, s83, v58
    v_pk_add_f32 v[40:41], v[40:41], v[44:45]
    v_pk_add_f32 v[48:49], v[48:49], v[52:53]
    v_pk_add_f32 v[42:43], v[42:43], v[46:47]
    v_pk_add_f32 v[50:51], v[50:51], v[54:55]
    v_pk_add_f32 v[40:41], v[40:41], v[48:49]
    v_pk_add_f32 v[42:43], v[42:43], v[50:51]
    v_cvt_pk_bf16_f32 v44, v40, v41
    v_cvt_pk_bf16_f32 v45, v42, v43
    v_lshlrev_b32 v48, 16, v44
    v_and_b32 v49, 0xffff0000, v44
    v_lshlrev_b32 v50, 16, v45
    v_and_b32 v51, 0xffff0000, v45
    v_add_f32 v48, v150, v48
    v_add_f32 v49, v150, v49
    v_add_f32 v50, v150, v50
    v_add_f32 v51, v150, v51
    v_cvt_pk_bf16_f32 v40, v48, v49
    v_cvt_pk_bf16_f32 v41, v50, v51
    v_lshlrev_b32 v44, 16, v40
    v_and_b32 v45, 0xffff0000, v40
    v_lshlrev_b32 v46, 16, v41
    v_and_b32 v47, 0xffff0000, v41
    s_cbranch_vccnz L_xcslow
L_local:
    ds_write_b128 v158, v[44:47]
    s_add_u32 s79, s100, 4096
    s_waitcnt lgkmcnt(0)
    ds_read_b128 v[64:67], v159 offset:0
    ds_read_b128 v[68:71], v159 offset:512
    ds_read_b128 v[72:75], v159 offset:16
    ds_read_b128 v[76:79], v159 offset:528
    ds_read_b128 v[80:83], v159 offset:256
    ds_read_b128 v[84:87], v159 offset:768
    ds_read_b128 v[88:91], v159 offset:272
    ds_read_b128 v[92:95], v159 offset:784
    s_waitcnt lgkmcnt(6)
    v_pk_fma_f32 v[24:25], v[24:25], v[68:69], v[64:65]
    v_pk_fma_f32 v[26:27], v[26:27], v[70:71], v[66:67]
    v_cvt_pk_bf16_f32 v16, v24, v25
    v_cvt_pk_bf16_f32 v17, v26, v27
    s_waitcnt lgkmcnt(4)
    v_pk_fma_f32 v[28:29], v[28:29], v[76:77], v[72:73]
    v_pk_fma_f32 v[30:31], v[30:31], v[78:79], v[74:75]
    v_cvt_pk_bf16_f32 v18, v28, v29
    v_cvt_pk_bf16_f32 v19, v30, v31
    buffer_store_dwordx4 v[16:19], v146, s[52:55], s100 offen sc1
    s_waitcnt lgkmcnt(2)
    v_pk_fma_f32 v[32:33], v[32:33], v[84:85], v[80:81]
    v_pk_fma_f32 v[34:35], v[34:35], v[86:87], v[82:83]
    v_cvt_pk_bf16_f32 v20, v32, v33
    v_cvt_pk_bf16_f32 v21, v34, v35
    s_waitcnt lgkmcnt(0)
    v_pk_fma_f32 v[36:37], v[36:37], v[92:93], v[88:89]
    v_pk_fma_f32 v[38:39], v[38:39], v[94:95], v[90:91]
    v_cvt_pk_bf16_f32 v22, v36, v37
    v_cvt_pk_bf16_f32 v23, v38, v39
    buffer_store_dwordx4 v[20:23], v146, s[52:55], s79 offen sc1
    s_add_u32 m0, s1, 1024
    s_add_u32 s0, s0, 49152
    buffer_load_dwordx4 v96, s[36:39], s0 offen lds
    s_add_u32 m0, s1, 2048
    s_add_u32 s0, s0, 49152
    buffer_load_dwordx4 v96, s[36:39], s0 offen lds
    s_add_u32 m0, s1, 3072
    s_add_u32 s0, s0, 49152
    buffer_load_dwordx4 v96, s[36:39], s0 offen lds
    s_lshl4_add_u32 s76, s6, s7
    s_lshl_b32 s77, s76, 6
    s_add_u32 s8, s77, 65536
    s_lshl_b32 s77, s76, 12
    s_add_u32 s20, s77, 10485760
    s_sub_u32 s24, s76, 64
    s_max_i32 s24, s24, 0
    s_sub_u32 s25, s76, 128
    s_max_i32 s25, s25, 0
    v_mov_b32 v120, s24
    v_writelane_b32 v120, s25, 1
    v_lshlrev_b32 v120, 6, v120
    v_add_u32 v120, 65536, v120
    s_lshl_b32 s24, s24, 12
    s_add_u32 s24, s24, 10485760
    s_lshl_b32 s25, s25, 12
    s_add_u32 s25, s25, 10485760
    s_cmp_ge_u32 s6, 4
    s_cselect_b32 s98, 1, 0
    s_cselect_b32 s77, 0, 0x40000000
    v_add_u32 v121, s77, v2
    s_cmp_ge_u32 s6, 8
    s_cselect_b32 s98, 3, s98
    s_cselect_b32 s77, 0, 0x40000000
    v_add_u32 v122, s77, v2
    s_mov_b32 s99, 0
    s_lshl_b32 s77, s6, 6
    s_add_u32 s77, s77, s7
    s_lshl2_add_u32 s9, s77, 4160
    s_add_u32 s15, s9, 128
    s_lshr_b32 s77, s73, 1
    s_lshl_b32 s77, s77, 5
    s_add_u32 s77, s77, s70
    s_and_b32 s78, s73, 1
    s_lshl1_add_u32 s77, s77, s78
    s_lshl2_add_u32 s14, s77, 4224
    s_lshl_b32 s77, s6, 15
    s_add_u32 s28, s77, 8388608
    s_add_u32 s29, s77, 8404992
    s_lshl_b32 s78, s7, 10
    s_add_u32 s77, s77, s78
    s_add_u32 s21, s77, 6291456
    s_lshl3_add_u32 s77, s73, s70
    s_lshl_b32 s78, s77, 11
    s_add_u32 s22, s78, 8388608
    s_lshl_b32 s78, s77, 7
    s_add_u32 s23, s78, 524288
    s_lshl_b32 s78, s6, 11
    s_add_u32 s30, s78, 524288
    s_lshr_b32 s77, s7, 1
    s_lshl4_add_u32 s77, s6, s77
    s_mul_i32 s77, s77, 7168
    s_add_u32 s26, s77, 14680064
    s_add_u32 s27, s77, 14737408
    s_lshl3_add_u32 s77, s74, s5
    s_waitcnt vmcnt(3)
    s_mov_b64 exec, 1
    buffer_store_dword v3, off, s[52:55], s80
    s_mov_b64 exec, -1
    s_bitcmp1_b32 s64, 31
    s_cbranch_scc1 L_norole_5
    s_lshl_b32 s65, s5, 12
    s_add_u32 m0, s65, 98304
    s_nop 0
    buffer_load_dwordx4 v97, s[48:51], s2 offen nt lds
    s_lshl_b32 s65, s5, 12
    s_add_u32 m0, s65, 99328
    s_add_u32 s2, s2, 8192
    buffer_load_dwordx4 v97, s[48:51], s2 offen nt lds
    s_lshl_b32 s65, s5, 12
    s_add_u32 m0, s65, 100352
    s_add_u32 s2, s2, 8192
    buffer_load_dwordx4 v97, s[48:51], s2 offen nt lds
    s_lshl_b32 s65, s5, 12
    s_add_u32 m0, s65, 101376
    s_add_u32 s2, s2, 8192
    buffer_load_dwordx4 v97, s[48:51], s2 offen nt lds
L_norole_5:
    s_add_u32 s78, s72, 1
    s_and_b32 s78, s78, 3
    s_lshl2_add_u32 s78, s78, s77
    s_lshl_b32 s79, s78, 12
    s_add_u32 s10, s79, 6291456
    s_mul_i32 s79, s78, 14336
    s_add_u32 s16, s79, 14680064
    s_add_u32 s78, s72, 2
    s_and_b32 s78, s78, 3
    s_lshl2_add_u32 s78, s78, s77
    s_lshl_b32 s79, s78, 12
    s_add_u32 s11, s79, 6291456
    s_mul_i32 s79, s78, 14336
    s_add_u32 s17, s79, 14680064
    s_add_u32 s78, s72, 3
    s_and_b32 s78, s78, 3
    s_lshl2_add_u32 s78, s78, s77
    s_lshl_b32 s79, s78, 12
    s_add_u32 s12, s79, 6291456
    s_mul_i32 s79, s78, 14336
    s_add_u32 s18, s79, 14680064
    s_add_u32 s78, s72, 4
    s_and_b32 s78, s78, 3
    s_lshl2_add_u32 s78, s78, s77
    s_lshl_b32 s79, s78, 12
    s_add_u32 s13, s79, 6291456
    s_mul_i32 s79, s78, 14336
    s_add_u32 s19, s79, 14680064
    s_lshl2_add_u32 s77, s70, s5
    s_lshl_b32 s78, s77, 14
    s_add_u32 s96, s78, 1048576
    s_mul_i32 s78, s77, 57344
    s_add_u32 s101, s78, 2097152
    s_lshr_b32 s77, s5, 1
    s_and_b32 s78, s5, 1
    s_lshl3_add_u32 s77, s77, s78
    s_lshl_b32 s77, s77, 7
    s_add_u32 s77, s77, s7
    s_mul_i32 s62, s77, 224
    s_mul_i32 s63, s5, 7168
    s_lshl_b32 s77, s5, 2
    s_lshl_b32 s60, 15, s77
    s_mov_b32 s61, s60
    s_lshl_b32 s77, s5, 12
    s_add_u32 s77, s77, 114688
    v_add_u32 v119, s77, v2
    v_writelane_b32 v10, s8, 33
    v_writelane_b32 v10, s67, 34
    s_mov_b32 exec_lo, 0x0
    s_mov_b32 exec_hi, 0x6
    buffer_load_dword v154, v10, s[52:55], 0 offen sc1
    s_mov_b64 exec, -1
    v_and_b32 v12, 15, v1
    v_lshrrev_b32 v15, 4, v1
    s_lshl_b32 s76, s73, 14
    s_lshl_b32 s77, s70, 7
    s_add_u32 s76, s76, s77
    v_lshrrev_b32 v11, 3, v1
    v_lshl_add_u32 v10, v11, 10, s76
    v_xor_b32 v11, v11, v148
    v_lshl_add_u32 v4, v11, 4, v10
    s_add_u32 s77, s77, 115712
    v_lshl_add_u32 v127, v15, 5, s77
    s_mov_b32 s77, 116736
    v_lshl_add_u32 v5, v15, 6, s77
    s_mov_b32 s77, 118784
    v_lshl_add_u32 v102, v15, 4, s77
    s_lshl_b32 s76, s5, 10
    s_add_u32 s77, s76, 333824
    v_add_u32 v124, s77, v2
    s_lshr_b32 s76, s76, 1
    s_add_u32 s77, s76, 114688
    v_lshl_add_u32 v110, v1, 3, s77
    v_bfe_u32 v11, v1, 3, 1
    v_lshl_add_u32 v10, v15, 1, v11
    v_mul_u32_u24 v10, 6144, v10
    v_lshl_add_u32 v10, v148, 4, v10
    s_and_b32 s76, s5, 1
    s_lshl1_add_u32 s77, s70, s76
    s_lshl_b32 s77, s77, 7
    s_add_u32 s77, s77, 331776
    v_add_u32 v125, s77, v10
    s_lshl_b32 s76, s76, 7
    s_add_u32 s76, s76, 116736
    v_lshl_add_u32 v10, v11, 8, s76
    v_lshl_add_u32 v10, v148, 4, v10
    v_lshrrev_b32 v11, 5, v1
    v_lshl_add_u32 v10, v11, 2, v10
    v_and_b32 v15, 1, v15
    v_lshl_add_u32 v111, v15, 3, v10
    v_lshlrev_b32 v10, 4, v12
    v_lshl_add_u32 v10, v15, 14, v10
    v_lshl_add_u32 v123, v11, 8, v10
    v_lshlrev_b32 v10, 2, v12
    v_lshl_add_u32 v105, v11, 6, v10
    v_lshl_add_u32 v106, v15, 10, v105
    s_lshl_b32 s76, s74, 8
    s_add_u32 s76, s76, 4096
    v_lshl_add_u32 v10, v11, 7, s76
    v_lshl_add_u32 v104, v1, 2, v10
    v_bfe_u32 v10, v1, 2, 3
    v_lshl_add_u32 v10, v11, 4, v10
    v_mul_u32_u24 v10, 224, v10
    v_and_b32 v11, 3, v1
    v_lshl_add_u32 v100, v11, 3, v10
    v_add_u32 v101, 57344, v100
    s_and_b32 s76, s7, 1
    s_lshl_b32 s77, s76, 12
    v_add_u32 v107, s77, v2
    s_lshl_b32 s77, s76, 9
    v_lshlrev_b32 v109, 2, v1
    v_add_u32 v108, s77, v109
    s_add_u32 s76, s5, 1
    s_and_b32 s76, s76, 3
    s_lshl_b32 s76, s76, 13
    s_add_u32 s76, s76, 122880
    v_add_u32 v6, s76, v2
    s_add_u32 s76, s5, 2
    s_and_b32 s76, s76, 3
    s_lshl_b32 s76, s76, 13
    s_add_u32 s76, s76, 126976
    v_add_u32 v7, s76, v2
    s_add_u32 s76, s5, 3
    s_and_b32 s76, s76, 3
    s_lshl_b32 s76, s76, 13
    s_add_u32 s76, s76, 122880
    v_add_u32 v8, s76, v2
    s_add_u32 s76, s5, 4
    s_and_b32 s76, s76, 3
    s_lshl_b32 s76, s76, 13
    s_add_u32 s76, s76, 122880
    v_add_u32 v9, s76, v2
    s_mul_i32 s76, s5, 14
    v_min_u32 v10, 13, v12
    v_add_u32 v10, s76, v10
    s_lshl2_add_u32 s76, s5, 56
    v_and_b32 v11, 3, v1
    v_add_u32 v11, s76, v11
    v_cndmask_b32 v10, v11, v10, s[84:85]
    s_lshl_b32 s76, s70, 13
    s_add_u32 s76, s76, 196608
    v_lshl_add_u32 v10, v10, 6, s76
    s_mov_b32 s76, 65536
    v_lshl_add_u32 v11, v148, 13, s76
    s_or_b32 s76, s75, s5
    s_min_u32 s76, s76, 1
    s_sub_u32 s76, s76, 1
    s_and_b32 s93, s76, 0xff
    s_mov_b32 s92, 0
    v_cndmask_b32 v126, v10, v11, s[92:93]
    s_and_b32 s80, s7, 1
    s_lshl_b32 s80, s80, 1
    buffer_load_dword v15, v103, s[52:55], 0 offen offset:0 sc1
    s_lshl3_add_u32 s65, s5, s69
    s_mul_i32 s0, s65, 49152
    s_lshl_b32 s1, s65, 10
    s_add_u32 s1, s1, 65536
    s_add_u32 m0, s1, 0
    s_nop 0
    buffer_load_dwordx4 v96, s[36:39], s0 offen lds
    s_add_u32 m0, s1, 1024
    s_add_u32 s0, s0, 49152
    buffer_load_dwordx4 v96, s[36:39], s0 offen lds
    s_waitcnt vmcnt(2)
    v_cmp_ne_u32 vcc, s68, v15
    s_nop 0
    s_and_b64 vcc, vcc, s[84:85]
    s_cbranch_scc0 L_qh_7
    s_mov_b32 s82, 0
L_ph_8:
    buffer_load_dword v15, v103, s[52:55], 0 offen offset:0 sc1
    s_add_u32 s82, s82, 1
    s_waitcnt vmcnt(0)
    v_cmp_ne_u32 vcc, s68, v15
    s_nop 0
    s_and_b64 vcc, vcc, s[84:85]
    s_cbranch_scc0 L_dh_9
    s_cmp_lt_u32 s82, 131072
    s_cbranch_scc1 L_ph_8
L_dh_9:
L_qh_7:
    buffer_load_dwordx4 v[128:131], v2, s[52:55], s31 offen offset:0 sc1
    buffer_load_dwordx4 v[132:135], v2, s[52:55], s31 offen offset:1024 sc1
    buffer_load_dwordx4 v[136:139], v2, s[52:55], s31 offen offset:2048 sc1
    buffer_load_dwordx4 v[140:143], v2, s[52:55], s31 offen offset:3072 sc1
    s_add_u32 s31, s31, 4096
    buffer_load_dwordx4 v[144:147], v2, s[52:55], s31 offen offset:0 sc1
    buffer_load_dwordx4 v[148:151], v2, s[52:55], s31 offen offset:1024 sc1
    buffer_load_dwordx4 v[152:155], v2, s[52:55], s31 offen offset:2048 sc1
    buffer_load_dwordx4 v[156:159], v2, s[52:55], s31 offen offset:3072 sc1
    s_add_u32 s31, s31, 4096
    buffer_load_dwordx4 v[160:163], v2, s[52:55], s31 offen offset:0 sc1
    buffer_load_dwordx4 v[164:167], v2, s[52:55], s31 offen offset:1024 sc1
    s_barrier
    ds_read_b64_tr_b16 v[64:65], v13 offset:0
    ds_read_b64_tr_b16 v[66:67], v13 offset:256
    ds_read_b64_tr_b16 v[68:69], v13 offset:32768
    ds_read_b64_tr_b16 v[70:71], v13 offset:33024
    ds_read_b64_tr_b16 v[72:73], v13 offset:1024
    ds_read_b64_tr_b16 v[74:75], v13 offset:1280
    ds_read_b64_tr_b16 v[76:77], v13 offset:33792
    ds_read_b64_tr_b16 v[78:79], v13 offset:34048
    ds_read_b64_tr_b16 v[80:81], v13 offset:2048
    ds_read_b64_tr_b16 v[82:83], v13 offset:2304
    ds_read_b64_tr_b16 v[84:85], v13 offset:34816
    ds_read_b64_tr_b16 v[86:87], v13 offset:35072
    v_add_u32 v10, 0, v1
    v_mul_u32_u24 v11, 4682, v10
    v_lshrrev_b32 v11, 16, v11
    v_mad_i32_i24 v10, v11, -14, v10
    v_add_u32 v10, s80, v10
    v_subrev_u32 v12, 14, v10
    v_min_u32 v10, v10, v12
    v_and_b32 v12, 4, v11
    v_mad_u32_u24 v12, v12, 3, v11
    v_and_b32 v15, 16, v11
    v_add_u32 v12, v12, v15
    v_bfe_u32 v15, v11, 3, 1
    s_waitcnt vmcnt(9) lgkmcnt(8)
    v_mfma_f32_32x32x16_bf16 v[16:31], v[64:67], v[128:131], 0
    buffer_load_dwordx4 v[168:171], v2, s[52:55], s31 offen offset:2048 sc1
    ds_read_b64_tr_b16 v[88:89], v13 offset:3072
    ds_read_b64_tr_b16 v[90:91], v13 offset:3328
    v_mad_i32_i24 v12, v15, -4, v12
    v_mfma_f32_32x32x16_bf16 v[32:47], v[128:131], v[68:71], 0
    ds_read_b64_tr_b16 v[92:93], v13 offset:35840
    ds_read_b64_tr_b16 v[94:95], v13 offset:36096
    v_mul_u32_u24 v12, 3584, v12
    v_lshl_add_u32 v112, v10, 4, v12
    s_waitcnt vmcnt(9) lgkmcnt(8)
    v_mfma_f32_32x32x16_bf16 v[16:31], v[72:75], v[132:135], v[16:31]
    buffer_load_dwordx4 v[172:175], v2, s[52:55], s31 offen offset:3072 sc1
    ds_read_b64_tr_b16 v[64:65], v13 offset:4096
    ds_read_b64_tr_b16 v[66:67], v13 offset:4352
    v_add_u32 v10, 64, v1
    v_mfma_f32_32x32x16_bf16 v[32:47], v[132:135], v[76:79], v[32:47]
    ds_read_b64_tr_b16 v[68:69], v13 offset:36864
    ds_read_b64_tr_b16 v[70:71], v13 offset:37120
    v_mul_u32_u24 v11, 4682, v10
    v_lshrrev_b32 v11, 16, v11
    s_waitcnt vmcnt(9) lgkmcnt(8)
    v_mfma_f32_32x32x16_bf16 v[16:31], v[80:83], v[136:139], v[16:31]
    s_add_u32 s31, s31, 4096
    buffer_load_dwordx4 v[176:179], v2, s[52:55], s31 offen offset:0 sc1
    ds_read_b64_tr_b16 v[72:73], v13 offset:5120
    ds_read_b64_tr_b16 v[74:75], v13 offset:5376
    v_mad_i32_i24 v10, v11, -14, v10
    v_mfma_f32_32x32x16_bf16 v[32:47], v[136:139], v[84:87], v[32:47]
    ds_read_b64_tr_b16 v[76:77], v13 offset:37888
    ds_read_b64_tr_b16 v[78:79], v13 offset:38144
    v_add_u32 v10, s80, v10
    v_subrev_u32 v12, 14, v10
    s_waitcnt vmcnt(9) lgkmcnt(8)
    v_mfma_f32_32x32x16_bf16 v[16:31], v[88:91], v[140:143], v[16:31]
    buffer_load_dwordx4 v[180:183], v2, s[52:55], s31 offen offset:1024 sc1
    ds_read_b64_tr_b16 v[80:81], v13 offset:6144
    ds_read_b64_tr_b16 v[82:83], v13 offset:6400
    v_min_u32 v10, v10, v12
    v_mfma_f32_32x32x16_bf16 v[32:47], v[140:143], v[92:95], v[32:47]
    ds_read_b64_tr_b16 v[84:85], v13 offset:38912
    ds_read_b64_tr_b16 v[86:87], v13 offset:39168
    v_and_b32 v12, 4, v11
    v_mad_u32_u24 v12, v12, 3, v11
    s_waitcnt vmcnt(9) lgkmcnt(8)
    v_mfma_f32_32x32x16_bf16 v[16:31], v[64:67], v[144:147], v[16:31]
    buffer_load_dwordx4 v[184:187], v2, s[52:55], s31 offen offset:2048 sc1
    ds_read_b64_tr_b16 v[88:89], v13 offset:7168
    ds_read_b64_tr_b16 v[90:91], v13 offset:7424
    v_and_b32 v15, 16, v11
    v_mfma_f32_32x32x16_bf16 v[32:47], v[144:147], v[68:71], v[32:47]
    ds_read_b64_tr_b16 v[92:93], v13 offset:39936
    ds_read_b64_tr_b16 v[94:95], v13 offset:40192
    v_add_u32 v12, v12, v15
    v_bfe_u32 v15, v11, 3, 1
    s_waitcnt vmcnt(9) lgkmcnt(8)
    v_mfma_f32_32x32x16_bf16 v[16:31], v[72:75], v[148:151], v[16:31]
    buffer_load_dwordx4 v[188:191], v2, s[52:55], s31 offen offset:3072 sc1
    ds_read_b64_tr_b16 v[64:65], v13 offset:8192
    ds_read_b64_tr_b16 v[66:67], v13 offset:8448
    v_mad_i32_i24 v12, v15, -4, v12
    v_mfma_f32_32x32x16_bf16 v[32:47], v[148:151], v[76:79], v[32:47]
    ds_read_b64_tr_b16 v[68:69], v13 offset:40960
    ds_read_b64_tr_b16 v[70:71], v13 offset:41216
    v_mul_u32_u24 v12, 3584, v12
    v_lshl_add_u32 v113, v10, 4, v12
    s_waitcnt vmcnt(9) lgkmcnt(8)
    v_mfma_f32_32x32x16_bf16 v[16:31], v[80:83], v[152:155], v[16:31]
    s_add_u32 s31, s31, 4096
    buffer_load_dwordx4 v[192:195], v2, s[52:55], s31 offen offset:0 sc1
    ds_read_b64_tr_b16 v[72:73], v13 offset:9216
    ds_read_b64_tr_b16 v[74:75], v13 offset:9472
    v_add_u32 v10, 128, v1
    v_mfma_f32_32x32x16_bf16 v[32:47], v[152:155], v[84:87], v[32:47]
    ds_read_b64_tr_b16 v[76:77], v13 offset:41984
    ds_read_b64_tr_b16 v[78:79], v13 offset:42240
    v_mul_u32_u24 v11, 4682, v10
    v_lshrrev_b32 v11, 16, v11
    s_waitcnt vmcnt(9) lgkmcnt(8)
    v_mfma_f32_32x32x16_bf16 v[16:31], v[88:91], v[156:159], v[16:31]
    buffer_load_dwordx4 v[196:199], v2, s[52:55], s31 offen offset:1024 sc1
    ds_read_b64_tr_b16 v[80:81], v13 offset:10240
    ds_read_b64_tr_b16 v[82:83], v13 offset:10496
    v_mad_i32_i24 v10, v11, -14, v10
    v_mfma_f32_32x32x16_bf16 v[32:47], v[156:159], v[92:95], v[32:47]
    ds_read_b64_tr_b16 v[84:85], v13 offset:43008
    ds_read_b64_tr_b16 v[86:87], v13 offset:43264
    v_add_u32 v10, s80, v10
    v_subrev_u32 v12, 14, v10
    s_waitcnt vmcnt(9) lgkmcnt(8)
    v_mfma_f32_32x32x16_bf16 v[16:31], v[64:67], v[160:163], v[16:31]
    buffer_load_dwordx4 v[200:203], v2, s[52:55], s31 offen offset:2048 sc1
    ds_read_b64_tr_b16 v[88:89], v13 offset:11264
    ds_read_b64_tr_b16 v[90:91], v13 offset:11520
    v_min_u32 v10, v10, v12
    v_mfma_f32_32x32x16_bf16 v[32:47], v[160:163], v[68:71], v[32:47]
    ds_read_b64_tr_b16 v[92:93], v13 offset:44032
    ds_read_b64_tr_b16 v[94:95], v13 offset:44288
    v_and_b32 v12, 4, v11
    v_mad_u32_u24 v12, v12, 3, v11
    s_waitcnt vmcnt(9) lgkmcnt(8)
    v_mfma_f32_32x32x16_bf16 v[16:31], v[72:75], v[164:167], v[16:31]
    buffer_load_dwordx4 v[204:207], v2, s[52:55], s31 offen offset:3072 sc1
    ds_read_b64_tr_b16 v[64:65], v13 offset:12288
    ds_read_b64_tr_b16 v[66:67], v13 offset:12544
    v_and_b32 v15, 16, v11
    v_mfma_f32_32x32x16_bf16 v[32:47], v[164:167], v[76:79], v[32:47]
    ds_read_b64_tr_b16 v[68:69], v13 offset:45056
    ds_read_b64_tr_b16 v[70:71], v13 offset:45312
    v_add_u32 v12, v12, v15
    v_bfe_u32 v15, v11, 3, 1
    s_waitcnt vmcnt(9) lgkmcnt(8)
    v_mfma_f32_32x32x16_bf16 v[16:31], v[80:83], v[168:171], v[16:31]
    s_add_u32 s31, s31, 4096
    buffer_load_dwordx4 v[208:211], v2, s[52:55], s31 offen offset:0 sc1
    ds_read_b64_tr_b16 v[72:73], v13 offset:13312
    ds_read_b64_tr_b16 v[74:75], v13 offset:13568
    v_mad_i32_i24 v12, v15, -4, v12
    v_mfma_f32_32x32x16_bf16 v[32:47], v[168:171], v[84:87], v[32:47]
    ds_read_b64_tr_b16 v[76:77], v13 offset:46080
    ds_read_b64_tr_b16 v[78:79], v13 offset:46336
    v_mul_u32_u24 v12, 3584, v12
    v_lshl_add_u32 v114, v10, 4, v12
    s_waitcnt vmcnt(9) lgkmcnt(8)
    v_mfma_f32_32x32x16_bf16 v[16:31], v[88:91], v[172:175], v[16:31]
    buffer_load_dwordx4 v[212:215], v2, s[52:55], s31 offen offset:1024 sc1
    ds_read_b64_tr_b16 v[80:81], v13 offset:14336
    ds_read_b64_tr_b16 v[82:83], v13 offset:14592
    v_add_u32 v10, 192, v1
    v_mfma_f32_32x32x16_bf16 v[32:47], v[172:175], v[92:95], v[32:47]
    ds_read_b64_tr_b16 v[84:85], v13 offset:47104
    ds_read_b64_tr_b16 v[86:87], v13 offset:47360
    v_mul_u32_u24 v11, 4682, v10
    v_lshrrev_b32 v11, 16, v11
    s_waitcnt vmcnt(9) lgkmcnt(8)
    v_mfma_f32_32x32x16_bf16 v[16:31], v[64:67], v[176:179], v[16:31]
    buffer_load_dwordx4 v[216:219], v2, s[52:55], s31 offen offset:2048 sc1
    ds_read_b64_tr_b16 v[88:89], v13 offset:15360
    ds_read_b64_tr_b16 v[90:91], v13 offset:15616
    v_mad_i32_i24 v10, v11, -14, v10
    v_mfma_f32_32x32x16_bf16 v[32:47], v[176:179], v[68:71], v[32:47]
    ds_read_b64_tr_b16 v[92:93], v13 offset:48128
    ds_read_b64_tr_b16 v[94:95], v13 offset:48384
    v_add_u32 v10, s80, v10
    v_subrev_u32 v12, 14, v10
    s_waitcnt vmcnt(9) lgkmcnt(8)
    v_mfma_f32_32x32x16_bf16 v[16:31], v[72:75], v[180:183], v[16:31]
    buffer_load_dwordx4 v[220:223], v2, s[52:55], s31 offen offset:3072 sc1
    ds_read_b64_tr_b16 v[64:65], v13 offset:16384
    ds_read_b64_tr_b16 v[66:67], v13 offset:16640
    v_min_u32 v10, v10, v12
    v_mfma_f32_32x32x16_bf16 v[32:47], v[180:183], v[76:79], v[32:47]
    ds_read_b64_tr_b16 v[68:69], v13 offset:49152
    ds_read_b64_tr_b16 v[70:71], v13 offset:49408
    v_and_b32 v12, 4, v11
    v_mad_u32_u24 v12, v12, 3, v11
    s_waitcnt vmcnt(9) lgkmcnt(8)
    v_mfma_f32_32x32x16_bf16 v[16:31], v[80:83], v[184:187], v[16:31]
    s_add_u32 s31, s31, 4096
    buffer_load_dwordx4 v[224:227], v2, s[52:55], s31 offen offset:0 sc1
    ds_read_b64_tr_b16 v[72:73], v13 offset:17408
    ds_read_b64_tr_b16 v[74:75], v13 offset:17664
    v_and_b32 v15, 16, v11
    v_mfma_f32_32x32x16_bf16 v[32:47], v[184:187], v[84:87], v[32:47]
    ds_read_b64_tr_b16 v[76:77], v13 offset:50176
    ds_read_b64_tr_b16 v[78:79], v13 offset:50432
    v_add_u32 v12, v12, v15
    v_bfe_u32 v15, v11, 3, 1
    s_waitcnt vmcnt(9) lgkmcnt(8)
    v_mfma_f32_32x32x16_bf16 v[16:31], v[88:91], v[188:191], v[16:31]
    buffer_load_dwordx4 v[228:231], v2, s[52:55], s31 offen offset:1024 sc1
    ds_read_b64_tr_b16 v[80:81], v13 offset:18432
    ds_read_b64_tr_b16 v[82:83], v13 offset:18688
    v_mad_i32_i24 v12, v15, -4, v12
    v_mfma_f32_32x32x16_bf16 v[32:47], v[188:191], v[92:95], v[32:47]
    ds_read_b64_tr_b16 v[84:85], v13 offset:51200
    ds_read_b64_tr_b16 v[86:87], v13 offset:51456
    v_mul_u32_u24 v12, 3584, v12
    v_lshl_add_u32 v115, v10, 4, v12
    s_waitcnt vmcnt(9) lgkmcnt(8)
    v_mfma_f32_32x32x16_bf16 v[16:31], v[64:67], v[192:195], v[16:31]
    buffer_load_dwordx4 v[232:235], v2, s[52:55], s31 offen offset:2048 sc1
    ds_read_b64_tr_b16 v[88:89], v13 offset:19456
    ds_read_b64_tr_b16 v[90:91], v13 offset:19712
    v_add_u32 v10, 256, v1
    v_mfma_f32_32x32x16_bf16 v[32:47], v[192:195], v[68:71], v[32:47]
    ds_read_b64_tr_b16 v[92:93], v13 offset:52224
    ds_read_b64_tr_b16 v[94:95], v13 offset:52480
    v_mul_u32_u24 v11, 4682, v10
    v_lshrrev_b32 v11, 16, v11
    s_waitcnt vmcnt(9) lgkmcnt(8)
    v_mfma_f32_32x32x16_bf16 v[16:31], v[72:75], v[196:199], v[16:31]
    buffer_load_dwordx4 v[236:239], v2, s[52:55], s31 offen offset:3072 sc1
    ds_read_b64_tr_b16 v[64:65], v13 offset:20480
    ds_read_b64_tr_b16 v[66:67], v13 offset:20736
    v_mad_i32_i24 v10, v11, -14, v10
    v_mfma_f32_32x32x16_bf16 v[32:47], v[196:199], v[76:79], v[32:47]
    ds_read_b64_tr_b16 v[68:69], v13 offset:53248
    ds_read_b64_tr_b16 v[70:71], v13 offset:53504
    v_add_u32 v10, s80, v10
    v_subrev_u32 v12, 14, v10
    s_waitcnt vmcnt(9) lgkmcnt(8)
    v_mfma_f32_32x32x16_bf16 v[16:31], v[80:83], v[200:203], v[16:31]
    s_add_u32 s31, s31, 4096
    buffer_load_dwordx4 v[240:243], v2, s[52:55], s31 offen offset:0 sc1
    ds_read_b64_tr_b16 v[72:73], v13 offset:21504
    ds_read_b64_tr_b16 v[74:75], v13 offset:21760
    v_min_u32 v10, v10, v12
    v_mfma_f32_32x32x16_bf16 v[32:47], v[200:203], v[84:87], v[32:47]
    ds_read_b64_tr_b16 v[76:77], v13 offset:54272
    ds_read_b64_tr_b16 v[78:79], v13 offset:54528
    v_and_b32 v12, 4, v11
    v_mad_u32_u24 v12, v12, 3, v11
    s_waitcnt vmcnt(9) lgkmcnt(8)
    v_mfma_f32_32x32x16_bf16 v[16:31], v[88:91], v[204:207], v[16:31]
    buffer_load_dwordx4 v[244:247], v2, s[52:55], s31 offen offset:1024 sc1
    ds_read_b64_tr_b16 v[80:81], v13 offset:22528
    ds_read_b64_tr_b16 v[82:83], v13 offset:22784
    v_and_b32 v15, 16, v11
    v_mfma_f32_32x32x16_bf16 v[32:47], v[204:207], v[92:95], v[32:47]
    ds_read_b64_tr_b16 v[84:85], v13 offset:55296
    ds_read_b64_tr_b16 v[86:87], v13 offset:55552
    v_add_u32 v12, v12, v15
    v_bfe_u32 v15, v11, 3, 1
    s_waitcnt vmcnt(9) lgkmcnt(8)
    v_mfma_f32_32x32x16_bf16 v[16:31], v[64:67], v[208:211], v[16:31]
    buffer_load_dwordx4 v[248:251], v2, s[52:55], s31 offen offset:2048 sc1
    ds_read_b64_tr_b16 v[88:89], v13 offset:23552
    ds_read_b64_tr_b16 v[90:91], v13 offset:23808
    v_mad_i32_i24 v12, v15, -4, v12
    v_mfma_f32_32x32x16_bf16 v[32:47], v[208:211], v[68:71], v[32:47]
    ds_read_b64_tr_b16 v[92:93], v13 offset:56320
    ds_read_b64_tr_b16 v[94:95], v13 offset:56576
    v_mul_u32_u24 v12, 3584, v12
    v_lshl_add_u32 v116, v10, 4, v12
    s_waitcnt vmcnt(9) lgkmcnt(8)
    v_mfma_f32_32x32x16_bf16 v[16:31], v[72:75], v[212:215], v[16:31]
    buffer_load_dwordx4 v[252:255], v2, s[52:55], s31 offen offset:3072 sc1
    ds_read_b64_tr_b16 v[64:65], v13 offset:24576
    ds_read_b64_tr_b16 v[66:67], v13 offset:24832
    v_add_u32 v10, 320, v1
    v_mfma_f32_32x32x16_bf16 v[32:47], v[212:215], v[76:79], v[32:47]
    ds_read_b64_tr_b16 v[68:69], v13 offset:57344
    ds_read_b64_tr_b16 v[70:71], v13 offset:57600
    v_mul_u32_u24 v11, 4682, v10
    v_lshrrev_b32 v11, 16, v11
    s_waitcnt vmcnt(9) lgkmcnt(8)
    v_mfma_f32_32x32x16_bf16 v[16:31], v[80:83], v[216:219], v[16:31]
    s_add_u32 m0, s1, 2048
    s_add_u32 s0, s0, 49152
    buffer_load_dwordx4 v96, s[36:39], s0 offen lds
    ds_read_b64_tr_b16 v[72:73], v13 offset:25600
    ds_read_b64_tr_b16 v[74:75], v13 offset:25856
    v_mad_i32_i24 v10, v11, -14, v10
    v_mfma_f32_32x32x16_bf16 v[32:47], v[216:219], v[84:87], v[32:47]
    ds_read_b64_tr_b16 v[76:77], v13 offset:58368
    ds_read_b64_tr_b16 v[78:79], v13 offset:58624
    v_add_u32 v10, s80, v10
    v_subrev_u32 v12, 14, v10
    s_waitcnt vmcnt(9) lgkmcnt(8)
    v_mfma_f32_32x32x16_bf16 v[16:31], v[88:91], v[220:223], v[16:31]
    s_add_u32 m0, s1, 3072
    s_add_u32 s0, s0, 49152
    buffer_load_dwordx4 v96, s[36:39], s0 offen lds
    ds_read_b64_tr_b16 v[80:81], v13 offset:26624
    ds_read_b64_tr_b16 v[82:83], v13 offset:26880
    v_min_u32 v10, v10, v12
    v_mfma_f32_32x32x16_bf16 v[32:47], v[220:223], v[92:95], v[32:47]
    ds_read_b64_tr_b16 v[84:85], v13 offset:59392
    ds_read_b64_tr_b16 v[86:87], v13 offset:59648
    v_and_b32 v12, 4, v11
    v_mad_u32_u24 v12, v12, 3, v11
    s_waitcnt vmcnt(9) lgkmcnt(8)
    v_mfma_f32_32x32x16_bf16 v[16:31], v[64:67], v[224:227], v[16:31]
    s_xor_b32 s69, s69, 4
    s_lshl3_add_u32 s65, s5, s69
    s_mul_i32 s0, s65, 49152
    s_lshl_b32 s1, s65, 10
    s_add_u32 s1, s1, 65536
    s_add_u32 m0, s1, 0
    s_nop 0
    buffer_load_dwordx4 v96, s[36:39], s0 offen lds
    ds_read_b64_tr_b16 v[88:89], v13 offset:27648
    ds_read_b64_tr_b16 v[90:91], v13 offset:27904
    v_and_b32 v15, 16, v11
    v_mfma_f32_32x32x16_bf16 v[32:47], v[224:227], v[68:71], v[32:47]
    ds_read_b64_tr_b16 v[92:93], v13 offset:60416
    ds_read_b64_tr_b16 v[94:95], v13 offset:60672
    v_add_u32 v12, v12, v15
    v_bfe_u32 v15, v11, 3, 1
    s_waitcnt vmcnt(9) lgkmcnt(8)
    v_mfma_f32_32x32x16_bf16 v[16:31], v[72:75], v[228:231], v[16:31]
    s_add_u32 m0, s1, 1024
    s_add_u32 s0, s0, 49152
    buffer_load_dwordx4 v96, s[36:39], s0 offen lds
    ds_read_b64_tr_b16 v[64:65], v13 offset:28672
    ds_read_b64_tr_b16 v[66:67], v13 offset:28928
    v_mad_i32_i24 v12, v15, -4, v12
    v_mfma_f32_32x32x16_bf16 v[32:47], v[228:231], v[76:79], v[32:47]
    ds_read_b64_tr_b16 v[68:69], v13 offset:61440
    ds_read_b64_tr_b16 v[70:71], v13 offset:61696
    v_mul_u32_u24 v12, 3584, v12
    v_lshl_add_u32 v117, v10, 4, v12
    s_waitcnt vmcnt(9) lgkmcnt(8)
    v_mfma_f32_32x32x16_bf16 v[16:31], v[80:83], v[232:235], v[16:31]
    ds_read_b64_tr_b16 v[72:73], v13 offset:29696
    ds_read_b64_tr_b16 v[74:75], v13 offset:29952
    v_add_u32 v10, 384, v1
    v_mfma_f32_32x32x16_bf16 v[32:47], v[232:235], v[84:87], v[32:47]
    ds_read_b64_tr_b16 v[76:77], v13 offset:62464
    ds_read_b64_tr_b16 v[78:79], v13 offset:62720
    v_mul_u32_u24 v11, 4682, v10
    v_lshrrev_b32 v11, 16, v11
    s_waitcnt vmcnt(8) lgkmcnt(8)
    v_mfma_f32_32x32x16_bf16 v[16:31], v[88:91], v[236:239], v[16:31]
    ds_read_b64_tr_b16 v[80:81], v13 offset:30720
    ds_read_b64_tr_b16 v[82:83], v13 offset:30976
    v_mad_i32_i24 v10, v11, -14, v10
    v_mfma_f32_32x32x16_bf16 v[32:47], v[236:239], v[92:95], v[32:47]
    ds_read_b64_tr_b16 v[84:85], v13 offset:63488
    ds_read_b64_tr_b16 v[86:87], v13 offset:63744
    v_add_u32 v10, s80, v10
    v_subrev_u32 v12, 14, v10
    s_waitcnt vmcnt(7) lgkmcnt(8)
    v_mfma_f32_32x32x16_bf16 v[16:31], v[64:67], v[240:243], v[16:31]
    ds_read_b64_tr_b16 v[88:89], v13 offset:31744
    ds_read_b64_tr_b16 v[90:91], v13 offset:32000
    v_min_u32 v10, v10, v12
    v_mfma_f32_32x32x16_bf16 v[32:47], v[240:243], v[68:71], v[32:47]
    ds_read_b64_tr_b16 v[92:93], v13 offset:64512
    ds_read_b64_tr_b16 v[94:95], v13 offset:64768
    v_and_b32 v12, 4, v11
    v_mad_u32_u24 v12, v12, 3, v11
    s_waitcnt vmcnt(6) lgkmcnt(8)
    v_mfma_f32_32x32x16_bf16 v[16:31], v[72:75], v[244:247], v[16:31]
    v_and_b32 v15, 16, v11
    v_mfma_f32_32x32x16_bf16 v[32:47], v[244:247], v[76:79], v[32:47]
    v_add_u32 v12, v12, v15
    v_bfe_u32 v15, v11, 3, 1
    s_waitcnt vmcnt(5) lgkmcnt(4)
    v_mfma_f32_32x32x16_bf16 v[16:31], v[80:83], v[248:251], v[16:31]
    v_mad_i32_i24 v12, v15, -4, v12
    v_mfma_f32_32x32x16_bf16 v[32:47], v[248:251], v[84:87], v[32:47]
    v_mul_u32_u24 v12, 3584, v12
    v_lshl_add_u32 v118, v10, 4, v12
    s_waitcnt vmcnt(4) lgkmcnt(0)
    v_mfma_f32_32x32x16_bf16 v[16:31], v[88:91], v[252:255], v[16:31]
    v_mfma_f32_32x32x16_bf16 v[32:47], v[252:255], v[92:95], v[32:47]
    s_nop 10
    v_cvt_pk_bf16_f32 v48, v16, v17
    v_cvt_pk_bf16_f32 v49, v18, v19
    v_cvt_pk_bf16_f32 v50, v20, v21
    v_cvt_pk_bf16_f32 v51, v22, v23
    buffer_store_dwordx4 v[48:51], v2, s[52:55], s20 offen offset:0 sc1
    v_cvt_pk_bf16_f32 v52, v24, v25
    v_cvt_pk_bf16_f32 v53, v26, v27
    v_cvt_pk_bf16_f32 v54, v28, v29
    v_cvt_pk_bf16_f32 v55, v30, v31
    buffer_store_dwordx4 v[52:55], v2, s[52:55], s20 offen offset:1024 sc1
    v_cvt_pk_bf16_f32 v56, v32, v33
    v_cvt_pk_bf16_f32 v57, v34, v35
    v_cvt_pk_bf16_f32 v58, v36, v37
    v_cvt_pk_bf16_f32 v59, v38, v39
    buffer_store_dwordx4 v[56:59], v2, s[52:55], s20 offen offset:2048 sc1
    v_cvt_pk_bf16_f32 v60, v40, v41
    v_cvt_pk_bf16_f32 v61, v42, v43
    v_cvt_pk_bf16_f32 v62, v44, v45
    v_cvt_pk_bf16_f32 v63, v46, v47
    buffer_store_dwordx4 v[60:63], v2, s[52:55], s20 offen offset:3072 sc1
    s_add_u32 m0, s1, 2048
    s_add_u32 s0, s0, 49152
    buffer_load_dwordx4 v96, s[36:39], s0 offen lds
    s_add_u32 m0, s1, 3072
    s_add_u32 s0, s0, 49152
    buffer_load_dwordx4 v96, s[36:39], s0 offen lds
    ds_write_b128 v119, v[48:51] offset:32768
    ds_write_b128 v119, v[52:55] offset:33792
    ds_write_b128 v119, v[56:59] offset:34816
    ds_write_b128 v119, v[60:63] offset:35840
    ds_read_b64_tr_b16 a[0:1], v98 offset:0
    ds_read_b64_tr_b16 a[2:3], v99 offset:0
    ds_read_b64_tr_b16 a[4:5], v98 offset:8
    ds_read_b64_tr_b16 a[6:7], v99 offset:8
    ds_read_b64_tr_b16 a[8:9], v98 offset:16
    ds_read_b64_tr_b16 a[10:11], v99 offset:16
    ds_read_b64_tr_b16 a[12:13], v98 offset:24
    ds_read_b64_tr_b16 a[14:15], v99 offset:24
    v_and_b32 v11, 31, v1
    v_lshrrev_b32 v12, 5, v1
    v_lshlrev_b32 v12, 2, v12
    v_sub_u32 v11, v11, v12
    v_mov_b32 v12, 0xff800000
    v_cmp_le_i32 s[90:91], 0, v11
    v_cmp_le_i32 s[92:93], 1, v11
    v_cmp_le_i32 s[94:95], 2, v11
    v_cndmask_b32 v16, v12, 0, s[90:91]
    v_cndmask_b32 v32, 0, v12, s[90:91]
    v_cmp_le_i32 s[90:91], 3, v11
    v_cndmask_b32 v17, v12, 0, s[92:93]
    v_cndmask_b32 v33, 0, v12, s[92:93]
    v_cmp_le_i32 s[92:93], 8, v11
    v_cndmask_b32 v18, v12, 0, s[94:95]
    v_cndmask_b32 v34, 0, v12, s[94:95]
    v_cmp_le_i32 s[94:95], 9, v11
    v_cndmask_b32 v19, v12, 0, s[90:91]
    v_cndmask_b32 v35, 0, v12, s[90:91]
    v_cmp_le_i32 s[90:91], 10, v11
    v_cndmask_b32 v20, v12, 0, s[92:93]
    v_cndmask_b32 v36, 0, v12, s[92:93]
    v_cmp_le_i32 s[92:93], 11, v11
    v_cndmask_b32 v21, v12, 0, s[94:95]
    v_cndmask_b32 v37, 0, v12, s[94:95]
    v_cmp_le_i32 s[94:95], 16, v11
    v_cndmask_b32 v22, v12, 0, s[90:91]
    v_cndmask_b32 v38, 0, v12, s[90:91]
    v_cmp_le_i32 s[90:91], 17, v11
    v_cndmask_b32 v23, v12, 0, s[92:93]
    v_cndmask_b32 v39, 0, v12, s[92:93]
    v_cmp_le_i32 s[92:93], 18, v11
    v_cndmask_b32 v24, v12, 0, s[94:95]
    v_cndmask_b32 v40, 0, v12, s[94:95]
    v_cmp_le_i32 s[94:95], 19, v11
    v_cndmask_b32 v25, v12, 0, s[90:91]
    v_cndmask_b32 v41, 0, v12, s[90:91]
    v_cmp_le_i32 s[90:91], 24, v11
    v_cndmask_b32 v26, v12, 0, s[92:93]
    v_cndmask_b32 v42, 0, v12, s[92:93]
    v_cmp_le_i32 s[92:93], 25, v11
    v_cndmask_b32 v27, v12, 0, s[94:95]
    v_cndmask_b32 v43, 0, v12, s[94:95]
    v_cmp_le_i32 s[94:95], 26, v11
    v_cndmask_b32 v28, v12, 0, s[90:91]
    v_cndmask_b32 v44, 0, v12, s[90:91]
    v_cmp_le_i32 s[90:91], 27, v11
    v_cndmask_b32 v29, v12, 0, s[92:93]
    v_cndmask_b32 v45, 0, v12, s[92:93]
    v_cndmask_b32 v30, v12, 0, s[94:95]
    v_cndmask_b32 v46, 0, v12, s[94:95]
    v_cndmask_b32 v31, v12, 0, s[90:91]
    v_cndmask_b32 v47, 0, v12, s[90:91]
    s_waitcnt vmcnt(2)
    s_mov_b64 exec, 1
    buffer_store_dword v3, off, s[52:55], s8 sc1
    s_mov_b64 exec, -1
    s_lshl_b32 s79, s5, 5
    s_add_u32 s80, s79, 128
    s_min_u32 s80, s80, 192
    v_add_u32 v88, s79, v100
    v_add_u32 v89, s79, v101
    v_add_u32 v90, s80, v100
    v_add_u32 v91, s80, v101
    v_and_b32 v10, 1, v1
    v_lshlrev_b32 v11, 10, v10
    v_sub_u32 v11, 115712, v11
    v_lshrrev_b32 v12, 4, v1
    v_lshl_add_u32 v92, v12, 5, v11
    v_lshl_add_u32 v12, v10, 9, v102
    v_lshl_add_u32 v93, s79, 1, v12
    v_lshl_add_u32 v94, s80, 1, v12
    v_and_b32 v103, 0xffffff7f, v103
    s_lshl_b32 s78, s5, 12
    s_mov_b32 s76, 0x3eb8aa3b
    s_mov_b32 s77, 0x3eb8aa3b
    s_waitcnt lgkmcnt(0)
    s_bitcmp1_b32 s64, 31
    s_cbranch_scc1 L_norole_10
    buffer_store_dwordx4 a[0:3], v2, s[52:55], s64 offen offset:0 sc1
    buffer_store_dwordx4 a[4:7], v2, s[52:55], s64 offen offset:1024 sc1
    buffer_store_dwordx4 a[8:11], v2, s[52:55], s64 offen offset:2048 sc1
    buffer_store_dwordx4 a[12:15], v2, s[52:55], s64 offen offset:3072 sc1
    s_waitcnt vmcnt(5)
    s_branch L_role_11
L_norole_10:
    s_waitcnt vmcnt(1)
L_role_11:
    s_barrier
    ds_read_b64_tr_b16 v[64:65], v14 offset:0
    ds_read_b64_tr_b16 v[66:67], v14 offset:256
    ds_read_b64_tr_b16 v[68:69], v14 offset:1024
    ds_read_b64_tr_b16 v[70:71], v14 offset:1280
    ds_read_b64_tr_b16 v[72:73], v14 offset:2048
    ds_read_b64_tr_b16 v[74:75], v14 offset:2304
    ds_read_b64_tr_b16 v[76:77], v14 offset:3072
    ds_read_b64_tr_b16 v[78:79], v14 offset:3328
    ds_read_b64_tr_b16 v[80:81], v14 offset:4096
    ds_read_b64_tr_b16 v[82:83], v14 offset:4352
    s_waitcnt lgkmcnt(8)
    v_mfma_f32_32x32x16_bf16 v[48:63], v[64:67], v[128:131], 0
    ds_read_b64_tr_b16 v[84:85], v14 offset:5120
    ds_read_b64_tr_b16 v[86:87], v14 offset:5376
    s_waitcnt lgkmcnt(8)
    v_mfma_f32_32x32x16_bf16 v[48:63], v[68:71], v[132:135], v[48:63]
    ds_read_b64_tr_b16 v[64:65], v14 offset:6144
    ds_read_b64_tr_b16 v[66:67], v14 offset:6400
    s_waitcnt lgkmcnt(8)
    v_mfma_f32_32x32x16_bf16 v[48:63], v[72:75], v[136:139], v[48:63]
    buffer_load_dword v15, v120, s[52:55], 0 offen offset:0 sc1
    ds_read_b64_tr_b16 v[68:69], v14 offset:7168
    ds_read_b64_tr_b16 v[70:71], v14 offset:7424
    s_waitcnt lgkmcnt(8)
    v_mfma_f32_32x32x16_bf16 v[48:63], v[76:79], v[140:143], v[48:63]
    ds_read_b64_tr_b16 v[72:73], v14 offset:8192
    ds_read_b64_tr_b16 v[74:75], v14 offset:8448
    s_waitcnt lgkmcnt(8)
    v_mfma_f32_32x32x16_bf16 v[48:63], v[80:83], v[144:147], v[48:63]
    ds_read_b64_tr_b16 v[76:77], v14 offset:9216
    ds_read_b64_tr_b16 v[78:79], v14 offset:9472
    s_waitcnt lgkmcnt(8)
    v_mfma_f32_32x32x16_bf16 v[48:63], v[84:87], v[148:151], v[48:63]
    ds_read_b64_tr_b16 v[80:81], v14 offset:10240
    ds_read_b64_tr_b16 v[82:83], v14 offset:10496
    s_waitcnt lgkmcnt(8)
    v_mfma_f32_32x32x16_bf16 v[48:63], v[64:67], v[152:155], v[48:63]
    ds_read_b64_tr_b16 v[84:85], v14 offset:11264
    ds_read_b64_tr_b16 v[86:87], v14 offset:11520
    s_mov_b32 s92, 0x00110011
    s_mov_b32 s93, 0x00110011
    s_waitcnt lgkmcnt(8)
    v_mfma_f32_32x32x16_bf16 v[48:63], v[68:71], v[156:159], v[48:63]
    ds_read_b64_tr_b16 v[64:65], v14 offset:12288
    ds_read_b64_tr_b16 v[66:67], v14 offset:12544
    v_mov_b32 v10, 0x3f803f80
    v_cndmask_b32 v136, 0, v10, s[92:93]
    s_waitcnt lgkmcnt(8)
    v_mfma_f32_32x32x16_bf16 v[48:63], v[72:75], v[160:163], v[48:63]
    ds_read_b64_tr_b16 v[68:69], v14 offset:13312
    ds_read_b64_tr_b16 v[70:71], v14 offset:13568
    v_mov_b32 v137, v136
    v_mov_b32 v138, v136
    s_waitcnt lgkmcnt(8)
    v_mfma_f32_32x32x16_bf16 v[48:63], v[76:79], v[164:167], v[48:63]
    ds_read_b64_tr_b16 v[72:73], v14 offset:14336
    ds_read_b64_tr_b16 v[74:75], v14 offset:14592
    v_mov_b32 v139, v136
    v_mov_b32 v140, v136
    s_waitcnt lgkmcnt(8)
    v_mfma_f32_32x32x16_bf16 v[48:63], v[80:83], v[168:171], v[48:63]
    ds_read_b64_tr_b16 v[76:77], v14 offset:15360
    ds_read_b64_tr_b16 v[78:79], v14 offset:15616
    v_mov_b32 v141, v136
    v_mov_b32 v142, v136
    s_waitcnt lgkmcnt(8)
    v_mfma_f32_32x32x16_bf16 v[48:63], v[84:87], v[172:175], v[48:63]
    ds_read_b64_tr_b16 v[80:81], v14 offset:16384
    ds_read_b64_tr_b16 v[82:83], v14 offset:16640
    v_mov_b32 v143, v136
    v_mov_b32 v144, v136
    s_waitcnt lgkmcnt(8)
    v_mfma_f32_32x32x16_bf16 v[48:63], v[64:67], v[176:179], v[48:63]
    ds_read_b64_tr_b16 v[84:85], v14 offset:17408
    ds_read_b64_tr_b16 v[86:87], v14 offset:17664
    v_mov_b32 v145, v136
    v_mov_b32 v146, v136
    s_waitcnt lgkmcnt(8)
    v_mfma_f32_32x32x16_bf16 v[48:63], v[68:71], v[180:183], v[48:63]
    ds_read_b64_tr_b16 v[64:65], v14 offset:18432
    ds_read_b64_tr_b16 v[66:67], v14 offset:18688
    v_mov_b32 v147, v136
    v_mov_b32 v148, v136
    s_waitcnt lgkmcnt(8)
    v_mfma_f32_32x32x16_bf16 v[48:63], v[72:75], v[184:187], v[48:63]
    ds_read_b64_tr_b16 v[68:69], v14 offset:19456
    ds_read_b64_tr_b16 v[70:71], v14 offset:19712
    v_mov_b32 v149, v136
    v_mov_b32 v150, v136
    s_waitcnt lgkmcnt(8)
    v_mfma_f32_32x32x16_bf16 v[48:63], v[76:79], v[188:191], v[48:63]
    ds_read_b64_tr_b16 v[72:73], v14 offset:20480
    ds_read_b64_tr_b16 v[74:75], v14 offset:20736
    v_mov_b32 v151, v136
    s_waitcnt lgkmcnt(8)
    v_mfma_f32_32x32x16_bf16 v[48:63], v[80:83], v[192:195], v[48:63]
    ds_read_b64_tr_b16 v[76:77], v14 offset:21504
    ds_read_b64_tr_b16 v[78:79], v14 offset:21760
    s_waitcnt vmcnt(0)
    v_cmp_ne_u32 vcc, s68, v15
    s_nop 0
    s_and_b64 vcc, vcc, s[98:99]
    s_cbranch_scc0 L_kvseen_12
    s_mov_b32 s82, 0
L_pkv_13:
    buffer_load_dword v15, v120, s[52:55], 0 offen offset:0 sc1
    s_add_u32 s82, s82, 1
    s_waitcnt vmcnt(0)
    v_cmp_ne_u32 vcc, s68, v15
    s_nop 0
    s_and_b64 vcc, vcc, s[98:99]
    s_cbranch_scc0 L_dkv_14
    s_cmp_lt_u32 s82, 131072
    s_cbranch_scc1 L_pkv_13
L_dkv_14:
L_kvseen_12:
    s_add_u32 m0, s78, 131072
    s_nop 0
    buffer_load_dwordx4 v121, s[52:55], s24 offen offset:0 sc1 lds
    buffer_load_dwordx4 v121, s[52:55], s24 offen offset:1024 sc1 lds
    buffer_load_dwordx4 v121, s[52:55], s24 offen offset:2048 sc1 lds
    buffer_load_dwordx4 v121, s[52:55], s24 offen offset:3072 sc1 lds
    s_waitcnt lgkmcnt(8)
    v_mfma_f32_32x32x16_bf16 v[48:63], v[84:87], v[196:199], v[48:63]
    s_add_u32 m0, s78, 114688
    ds_read_b64_tr_b16 v[80:81], v14 offset:22528
    ds_read_b64_tr_b16 v[82:83], v14 offset:22784
    buffer_load_dwordx4 v122, s[52:55], s25 offen offset:0 sc1 lds
    buffer_load_dwordx4 v122, s[52:55], s25 offen offset:1024 sc1 lds
    s_waitcnt lgkmcnt(8)
    v_mfma_f32_32x32x16_bf16 v[48:63], v[64:67], v[200:203], v[48:63]
    ds_read_b64_tr_b16 v[84:85], v14 offset:23552
    ds_read_b64_tr_b16 v[86:87], v14 offset:23808
    buffer_load_dwordx4 v122, s[52:55], s25 offen offset:2048 sc1 lds
    buffer_load_dwordx4 v122, s[52:55], s25 offen offset:3072 sc1 lds
    s_waitcnt lgkmcnt(8)
    v_mfma_f32_32x32x16_bf16 v[48:63], v[68:71], v[204:207], v[48:63]
    ds_read_b64_tr_b16 v[64:65], v14 offset:24576
    ds_read_b64_tr_b16 v[66:67], v14 offset:24832
    s_waitcnt lgkmcnt(8)
    v_mfma_f32_32x32x16_bf16 v[48:63], v[72:75], v[208:211], v[48:63]
    ds_read_b64_tr_b16 v[68:69], v14 offset:25600
    ds_read_b64_tr_b16 v[70:71], v14 offset:25856
    s_waitcnt lgkmcnt(8)
    v_mfma_f32_32x32x16_bf16 v[48:63], v[76:79], v[212:215], v[48:63]
    ds_read_b64_tr_b16 v[72:73], v14 offset:26624
    ds_read_b64_tr_b16 v[74:75], v14 offset:26880
    s_waitcnt lgkmcnt(8)
    v_mfma_f32_32x32x16_bf16 v[48:63], v[80:83], v[216:219], v[48:63]
    ds_read_b64_tr_b16 v[76:77], v14 offset:27648
    ds_read_b64_tr_b16 v[78:79], v14 offset:27904
    s_waitcnt lgkmcnt(8)
    v_mfma_f32_32x32x16_bf16 v[48:63], v[84:87], v[220:223], v[48:63]
    ds_read_b64_tr_b16 v[80:81], v14 offset:28672
    ds_read_b64_tr_b16 v[82:83], v14 offset:28928
    s_waitcnt lgkmcnt(8)
    v_mfma_f32_32x32x16_bf16 v[48:63], v[64:67], v[224:227], v[48:63]
    ds_read_b64_tr_b16 v[84:85], v14 offset:29696
    ds_read_b64_tr_b16 v[86:87], v14 offset:29952
    s_waitcnt lgkmcnt(8)
    v_mfma_f32_32x32x16_bf16 v[48:63], v[68:71], v[228:231], v[48:63]
    ds_read_b64_tr_b16 v[64:65], v14 offset:30720
    ds_read_b64_tr_b16 v[66:67], v14 offset:30976
    s_waitcnt lgkmcnt(8)
    v_mfma_f32_32x32x16_bf16 v[48:63], v[72:75], v[232:235], v[48:63]
    ds_read_b64_tr_b16 v[68:69], v14 offset:31744
    ds_read_b64_tr_b16 v[70:71], v14 offset:32000
    s_waitcnt lgkmcnt(8)
    v_mfma_f32_32x32x16_bf16 v[48:63], v[76:79], v[236:239], v[48:63]
    s_waitcnt lgkmcnt(6)
    v_mfma_f32_32x32x16_bf16 v[48:63], v[80:83], v[240:243], v[48:63]
    ds_read_b128 v[128:131], v119 offset:32768
    ds_read_b128 v[132:135], v119 offset:33792
    s_waitcnt lgkmcnt(6)
    v_mfma_f32_32x32x16_bf16 v[48:63], v[84:87], v[244:247], v[48:63]
    s_mov_b64 exec, s[86:87]
    ds_read_b128 v[136:139], v119 offset:34816
    ds_read_b128 v[140:143], v119 offset:35840
    s_mov_b64 exec, -1
    s_waitcnt lgkmcnt(6)
    v_mfma_f32_32x32x16_bf16 v[48:63], v[64:67], v[248:251], v[48:63]
    s_waitcnt lgkmcnt(4)
    v_mfma_f32_32x32x16_bf16 v[48:63], v[68:71], v[252:255], v[48:63]
    s_nop 11
    v_pk_mul_f32 v[48:49], v[48:49], s[76:77]
    v_pk_mul_f32 v[50:51], v[50:51], s[76:77]
    v_pk_mul_f32 v[52:53], v[52:53], s[76:77]
    v_pk_mul_f32 v[54:55], v[54:55], s[76:77]
    v_pk_mul_f32 v[56:57], v[56:57], s[76:77]
    v_pk_mul_f32 v[58:59], v[58:59], s[76:77]
    v_pk_mul_f32 v[60:61], v[60:61], s[76:77]
    v_pk_mul_f32 v[62:63], v[62:63], s[76:77]
    v_cvt_pk_bf16_f32 v48, v48, v49
    v_cvt_pk_bf16_f32 v49, v50, v51
    v_cvt_pk_bf16_f32 v50, v52, v53
    v_cvt_pk_bf16_f32 v51, v54, v55
    v_cvt_pk_bf16_f32 v52, v56, v57
    v_cvt_pk_bf16_f32 v53, v58, v59
    v_cvt_pk_bf16_f32 v54, v60, v61
    v_cvt_pk_bf16_f32 v55, v62, v63
    s_waitcnt lgkmcnt(0)
    v_mfma_f32_32x32x16_bf16 v[160:175], v[128:131], v[48:51], v[16:31]
    v_mfma_f32_32x32x16_bf16 v[176:191], v[132:135], v[52:55], v[16:31]
    s_mov_b64 exec, s[88:89]
    ds_read_b128 v[144:147], v119 offset:34816
    ds_read_b128 v[148:151], v119 offset:35840
    s_mov_b64 exec, -1
    s_nop 6
    v_exp_f32 v160, v160
    v_exp_f32 v161, v161
    v_exp_f32 v162, v162
    v_exp_f32 v163, v163
    v_exp_f32 v164, v164
    v_exp_f32 v165, v165
    v_exp_f32 v166, v166
    v_exp_f32 v167, v167
    v_cvt_pk_bf16_f32 v192, v160, v161
    v_cvt_pk_bf16_f32 v193, v162, v163
    v_cvt_pk_bf16_f32 v194, v164, v165
    v_cvt_pk_bf16_f32 v195, v166, v167
    v_exp_f32 v168, v168
    v_exp_f32 v169, v169
    v_exp_f32 v170, v170
    v_exp_f32 v171, v171
    v_mfma_f32_32x32x16_bf16 v[208:223], v[136:139], v[192:195], 0
    s_waitcnt vmcnt(4)
    s_barrier
    ds_read_b128 v[128:131], v119 offset:28672
    s_add_u32 s65, s3, 0
    s_and_b32 s65, s65, 3
    s_mul_i32 s65, s65, 28672
    s_add_u32 s1, s63, s65
    s_lshl4_add_u32 s0, s65, s62
    s_add_u32 m0, s1, 0
    s_nop 0
    buffer_load_dwordx4 v112, s[44:47], s0 offen lds
    s_add_u32 m0, s1, 1024
    s_nop 0
    buffer_load_dwordx4 v113, s[44:47], s0 offen lds
    s_add_u32 m0, s1, 2048
    s_nop 0
    buffer_load_dwordx4 v114, s[44:47], s0 offen lds
    s_add_u32 m0, s1, 3072
    v_exp_f32 v172, v172
    v_exp_f32 v173, v173
    v_exp_f32 v174, v174
    v_exp_f32 v175, v175
    v_cvt_pk_bf16_f32 v196, v168, v169
    v_cvt_pk_bf16_f32 v197, v170, v171
    v_cvt_pk_bf16_f32 v198, v172, v173
    v_cvt_pk_bf16_f32 v199, v174, v175
    s_waitcnt lgkmcnt(0)
    v_mfma_f32_32x32x16_bf16 v[160:175], v[128:131], v[48:51], 0
    s_cmp_lt_u32 s6, 1
    ds_read_b128 v[132:135], v119 offset:29696
    buffer_load_dwordx4 v115, s[44:47], s0 offen lds
    v_exp_f32 v176, v176
    v_exp_f32 v177, v177
    v_exp_f32 v178, v178
    v_exp_f32 v179, v179
    v_mfma_f32_32x32x16_bf16 v[208:223], v[140:143], v[196:199], v[208:223]
    s_cselect_b64 exec, -1, s[86:87]
    ds_read_b128 v[136:139], v119 offset:30720
    ds_read_b128 v[140:143], v119 offset:31744
    s_mov_b64 exec, -1
    s_add_u32 m0, s1, 4096
    v_exp_f32 v180, v180
    v_exp_f32 v181, v181
    v_exp_f32 v182, v182
    v_exp_f32 v183, v183
    v_cvt_pk_bf16_f32 v200, v176, v177
    v_cvt_pk_bf16_f32 v201, v178, v179
    v_cvt_pk_bf16_f32 v202, v180, v181
    v_cvt_pk_bf16_f32 v203, v182, v183
    v_exp_f32 v184, v184
    v_exp_f32 v185, v185
    v_exp_f32 v186, v186
    v_exp_f32 v187, v187
    v_mfma_f32_32x32x16_bf16 v[224:239], v[144:147], v[200:203], 0
    s_waitcnt lgkmcnt(0)
    buffer_load_dwordx4 v116, s[44:47], s0 offen lds
    s_bitcmp1_b32 s64, 31
    s_cbranch_scc1 L_norole_17
    s_mov_b64 exec, 1
    buffer_store_dword v3, off, s[52:55], s67 sc1
    s_mov_b64 exec, -1
L_norole_17:
    v_exp_f32 v188, v188
    v_exp_f32 v189, v189
    v_exp_f32 v190, v190
    v_exp_f32 v191, v191
    v_cvt_pk_bf16_f32 v204, v184, v185
    v_cvt_pk_bf16_f32 v205, v186, v187
    v_cvt_pk_bf16_f32 v206, v188, v189
    v_cvt_pk_bf16_f32 v207, v190, v191
    v_mfma_f32_32x32x16_bf16 v[176:191], v[132:135], v[52:55], 0
    s_cmp_lt_u32 s6, 1
    ds_read_b128 v[128:131], v119 offset:24576
    v_exp_f32 v160, v160
    v_exp_f32 v161, v161
    v_exp_f32 v162, v162
    v_exp_f32 v163, v163
    v_mfma_f32_32x32x16_bf16 v[224:239], v[148:151], v[204:207], v[224:239]
    s_cselect_b64 exec, -1, s[88:89]
    ds_read_b128 v[144:147], v119 offset:30720
    ds_read_b128 v[148:151], v119 offset:31744
    s_mov_b64 exec, -1
    s_add_u32 m0, s1, 5120
    v_exp_f32 v164, v164
    v_exp_f32 v165, v165
    v_exp_f32 v166, v166
    v_exp_f32 v167, v167
    v_cvt_pk_bf16_f32 v192, v160, v161
    v_cvt_pk_bf16_f32 v193, v162, v163
    v_cvt_pk_bf16_f32 v194, v164, v165
    v_cvt_pk_bf16_f32 v195, v166, v167
    v_exp_f32 v168, v168
    v_exp_f32 v169, v169
    v_exp_f32 v170, v170
    v_exp_f32 v171, v171
    v_mfma_f32_32x32x16_bf16 v[208:223], v[136:139], v[192:195], v[208:223]
    s_waitcnt lgkmcnt(0)
    buffer_load_dwordx4 v117, s[44:47], s0 offen lds
    s_add_u32 m0, s1, 6144
    v_exp_f32 v172, v172
    v_exp_f32 v173, v173
    v_exp_f32 v174, v174
    v_exp_f32 v175, v175
    v_cvt_pk_bf16_f32 v196, v168, v169
    v_cvt_pk_bf16_f32 v197, v170, v171
    v_cvt_pk_bf16_f32 v198, v172, v173
    v_cvt_pk_bf16_f32 v199, v174, v175
    v_mfma_f32_32x32x16_bf16 v[160:175], v[128:131], v[48:51], 0
    s_cmp_lt_u32 s6, 2
    ds_read_b128 v[132:135], v119 offset:25600
    buffer_load_dwordx4 v118, s[44:47], s0 offen lds
    v_exp_f32 v176, v176
    v_exp_f32 v177, v177
    v_exp_f32 v178, v178
    v_exp_f32 v179, v179
    v_mfma_f32_32x32x16_bf16 v[208:223], v[140:143], v[196:199], v[208:223]
    s_cselect_b64 exec, -1, s[86:87]
    ds_read_b128 v[136:139], v119 offset:26624
    ds_read_b128 v[140:143], v119 offset:27648
    s_mov_b64 exec, -1
    s_add_u32 s65, s3, 1
    s_and_b32 s65, s65, 3
    s_mul_i32 s65, s65, 28672
    s_add_u32 s1, s63, s65
    s_lshl4_add_u32 s0, s65, s62
    s_add_u32 m0, s1, 0
    v_exp_f32 v180, v180
    v_exp_f32 v181, v181
    v_exp_f32 v182, v182
    v_exp_f32 v183, v183
    v_cvt_pk_bf16_f32 v200, v176, v177
    v_cvt_pk_bf16_f32 v201, v178, v179
    v_cvt_pk_bf16_f32 v202, v180, v181
    v_cvt_pk_bf16_f32 v203, v182, v183
    v_exp_f32 v184, v184
    v_exp_f32 v185, v185
    v_exp_f32 v186, v186
    v_exp_f32 v187, v187
    v_mfma_f32_32x32x16_bf16 v[224:239], v[144:147], v[200:203], v[224:239]
    s_waitcnt lgkmcnt(0)
    buffer_load_dwordx4 v112, s[44:47], s0 offen lds
    s_add_u32 m0, s1, 1024
    v_exp_f32 v188, v188
    v_exp_f32 v189, v189
    v_exp_f32 v190, v190
    v_exp_f32 v191, v191
    v_cvt_pk_bf16_f32 v204, v184, v185
    v_cvt_pk_bf16_f32 v205, v186, v187
    v_cvt_pk_bf16_f32 v206, v188, v189
    v_cvt_pk_bf16_f32 v207, v190, v191
    v_mfma_f32_32x32x16_bf16 v[176:191], v[132:135], v[52:55], 0
    s_cmp_lt_u32 s6, 2
    ds_read_b128 v[128:131], v119 offset:20480
    buffer_load_dwordx4 v113, s[44:47], s0 offen lds
    v_exp_f32 v160, v160
    v_exp_f32 v161, v161
    v_exp_f32 v162, v162
    v_exp_f32 v163, v163
    v_mfma_f32_32x32x16_bf16 v[224:239], v[148:151], v[204:207], v[224:239]
    s_cselect_b64 exec, -1, s[88:89]
    ds_read_b128 v[144:147], v119 offset:26624
    ds_read_b128 v[148:151], v119 offset:27648
    s_mov_b64 exec, -1
    s_add_u32 m0, s1, 2048
    v_exp_f32 v164, v164
    v_exp_f32 v165, v165
    v_exp_f32 v166, v166
    v_exp_f32 v167, v167
    v_cvt_pk_bf16_f32 v192, v160, v161
    v_cvt_pk_bf16_f32 v193, v162, v163
    v_cvt_pk_bf16_f32 v194, v164, v165
    v_cvt_pk_bf16_f32 v195, v166, v167
    v_exp_f32 v168, v168
    v_exp_f32 v169, v169
    v_exp_f32 v170, v170
    v_exp_f32 v171, v171
    v_mfma_f32_32x32x16_bf16 v[208:223], v[136:139], v[192:195], v[208:223]
    s_waitcnt lgkmcnt(0)
    buffer_load_dwordx4 v114, s[44:47], s0 offen lds
    s_add_u32 m0, s1, 3072
    v_exp_f32 v172, v172
    v_exp_f32 v173, v173
    v_exp_f32 v174, v174
    v_exp_f32 v175, v175
    v_cvt_pk_bf16_f32 v196, v168, v169
    v_cvt_pk_bf16_f32 v197, v170, v171
    v_cvt_pk_bf16_f32 v198, v172, v173
    v_cvt_pk_bf16_f32 v199, v174, v175
    v_mfma_f32_32x32x16_bf16 v[160:175], v[128:131], v[48:51], 0
    s_cmp_lt_u32 s6, 3
    ds_read_b128 v[132:135], v119 offset:21504
    buffer_load_dwordx4 v115, s[44:47], s0 offen lds
    v_exp_f32 v176, v176
    v_exp_f32 v177, v177
    v_exp_f32 v178, v178
    v_exp_f32 v179, v179
    v_mfma_f32_32x32x16_bf16 v[208:223], v[140:143], v[196:199], v[208:223]
    s_cselect_b64 exec, -1, s[86:87]
    ds_read_b128 v[136:139], v119 offset:22528
    ds_read_b128 v[140:143], v119 offset:23552
    s_mov_b64 exec, -1
    s_add_u32 m0, s1, 4096
    v_exp_f32 v180, v180
    v_exp_f32 v181, v181
    v_exp_f32 v182, v182
    v_exp_f32 v183, v183
    v_cvt_pk_bf16_f32 v200, v176, v177
    v_cvt_pk_bf16_f32 v201, v178, v179
    v_cvt_pk_bf16_f32 v202, v180, v181
    v_cvt_pk_bf16_f32 v203, v182, v183
    v_exp_f32 v184, v184
    v_exp_f32 v185, v185
    v_exp_f32 v186, v186
    v_exp_f32 v187, v187
    v_mfma_f32_32x32x16_bf16 v[224:239], v[144:147], v[200:203], v[224:239]
    s_waitcnt lgkmcnt(0)
    buffer_load_dwordx4 v116, s[44:47], s0 offen lds
    s_add_u32 m0, s1, 5120
    v_exp_f32 v188, v188
    v_exp_f32 v189, v189
    v_exp_f32 v190, v190
    v_exp_f32 v191, v191
    v_cvt_pk_bf16_f32 v204, v184, v185
    v_cvt_pk_bf16_f32 v205, v186, v187
    v_cvt_pk_bf16_f32 v206, v188, v189
    v_cvt_pk_bf16_f32 v207, v190, v191
    v_mfma_f32_32x32x16_bf16 v[176:191], v[132:135], v[52:55], 0
    s_cmp_lt_u32 s6, 3
    ds_read_b128 v[128:131], v119 offset:16384
    buffer_load_dwordx4 v117, s[44:47], s0 offen lds
    v_exp_f32 v160, v160
    v_exp_f32 v161, v161
    v_exp_f32 v162, v162
    v_exp_f32 v163, v163
    v_mfma_f32_32x32x16_bf16 v[224:239], v[148:151], v[204:207], v[224:239]
    s_cselect_b64 exec, -1, s[88:89]
    ds_read_b128 v[144:147], v119 offset:22528
    ds_read_b128 v[148:151], v119 offset:23552
    s_mov_b64 exec, -1
    s_add_u32 m0, s1, 6144
    v_exp_f32 v164, v164
    v_exp_f32 v165, v165
    v_exp_f32 v166, v166
    v_exp_f32 v167, v167
    v_cvt_pk_bf16_f32 v192, v160, v161
    v_cvt_pk_bf16_f32 v193, v162, v163
    v_cvt_pk_bf16_f32 v194, v164, v165
    v_cvt_pk_bf16_f32 v195, v166, v167
    v_exp_f32 v168, v168
    v_exp_f32 v169, v169
    v_exp_f32 v170, v170
    v_exp_f32 v171, v171
    v_mfma_f32_32x32x16_bf16 v[208:223], v[136:139], v[192:195], v[208:223]
    s_waitcnt lgkmcnt(0)
    buffer_load_dwordx4 v118, s[44:47], s0 offen lds
    s_add_u32 s65, s3, 2
    s_and_b32 s65, s65, 3
    s_mul_i32 s65, s65, 28672
    s_add_u32 s1, s63, s65
    s_lshl4_add_u32 s0, s65, s62
    s_add_u32 m0, s1, 0
    v_exp_f32 v172, v172
    v_exp_f32 v173, v173
    v_exp_f32 v174, v174
    v_exp_f32 v175, v175
    v_cvt_pk_bf16_f32 v196, v168, v169
    v_cvt_pk_bf16_f32 v197, v170, v171
    v_cvt_pk_bf16_f32 v198, v172, v173
    v_cvt_pk_bf16_f32 v199, v174, v175
    v_mfma_f32_32x32x16_bf16 v[160:175], v[128:131], v[48:51], 0
    s_cmp_lt_u32 s6, 4
    ds_read_b128 v[132:135], v119 offset:17408
    buffer_load_dwordx4 v112, s[44:47], s0 offen lds
    v_exp_f32 v176, v176
    v_exp_f32 v177, v177
    v_exp_f32 v178, v178
    v_exp_f32 v179, v179
    v_mfma_f32_32x32x16_bf16 v[208:223], v[140:143], v[196:199], v[208:223]
    s_cselect_b64 exec, -1, s[86:87]
    ds_read_b128 v[136:139], v119 offset:18432
    ds_read_b128 v[140:143], v119 offset:19456
    s_mov_b64 exec, -1
    s_add_u32 m0, s1, 1024
    v_exp_f32 v180, v180
    v_exp_f32 v181, v181
    v_exp_f32 v182, v182
    v_exp_f32 v183, v183
    v_cvt_pk_bf16_f32 v200, v176, v177
    v_cvt_pk_bf16_f32 v201, v178, v179
    v_cvt_pk_bf16_f32 v202, v180, v181
    v_cvt_pk_bf16_f32 v203, v182, v183
    v_exp_f32 v184, v184
    v_exp_f32 v185, v185
    v_exp_f32 v186, v186
    v_exp_f32 v187, v187
    v_mfma_f32_32x32x16_bf16 v[224:239], v[144:147], v[200:203], v[224:239]
    s_waitcnt vmcnt(15) lgkmcnt(0)
    s_barrier
    buffer_load_dwordx4 v113, s[44:47], s0 offen lds
    s_add_u32 m0, s1, 2048
    v_exp_f32 v188, v188
    v_exp_f32 v189, v189
    v_exp_f32 v190, v190
    v_exp_f32 v191, v191
    v_cvt_pk_bf16_f32 v204, v184, v185
    v_cvt_pk_bf16_f32 v205, v186, v187
    v_cvt_pk_bf16_f32 v206, v188, v189
    v_cvt_pk_bf16_f32 v207, v190, v191
    v_mfma_f32_32x32x16_bf16 v[176:191], v[132:135], v[52:55], 0
    s_cmp_lt_u32 s6, 4
    ds_read_b128 v[128:131], v119 offset:12288
    buffer_load_dwordx4 v114, s[44:47], s0 offen lds
    v_exp_f32 v160, v160
    v_exp_f32 v161, v161
    v_exp_f32 v162, v162
    v_exp_f32 v163, v163
    v_mfma_f32_32x32x16_bf16 v[224:239], v[148:151], v[204:207], v[224:239]
    s_cselect_b64 exec, -1, s[88:89]
    ds_read_b128 v[144:147], v119 offset:18432
    ds_read_b128 v[148:151], v119 offset:19456
    s_mov_b64 exec, -1
    s_add_u32 m0, s1, 3072
    v_exp_f32 v164, v164
    v_exp_f32 v165, v165
    v_exp_f32 v166, v166
    v_exp_f32 v167, v167
    v_cvt_pk_bf16_f32 v192, v160, v161
    v_cvt_pk_bf16_f32 v193, v162, v163
    v_cvt_pk_bf16_f32 v194, v164, v165
    v_cvt_pk_bf16_f32 v195, v166, v167
    v_exp_f32 v168, v168
    v_exp_f32 v169, v169
    v_exp_f32 v170, v170
    v_exp_f32 v171, v171
    v_mfma_f32_32x32x16_bf16 v[208:223], v[136:139], v[192:195], v[208:223]
    s_waitcnt lgkmcnt(0)
    buffer_load_dwordx4 v115, s[44:47], s0 offen lds
    s_add_u32 m0, s1, 4096
    v_exp_f32 v172, v172
    v_exp_f32 v173, v173
    v_exp_f32 v174, v174
    v_exp_f32 v175, v175
    v_cvt_pk_bf16_f32 v196, v168, v169
    v_cvt_pk_bf16_f32 v197, v170, v171
    v_cvt_pk_bf16_f32 v198, v172, v173
    v_cvt_pk_bf16_f32 v199, v174, v175
    v_mfma_f32_32x32x16_bf16 v[160:175], v[128:131], v[48:51], 0
    s_cmp_lt_u32 s6, 5
    ds_read_b128 v[132:135], v119 offset:13312
    buffer_load_dwordx4 v116, s[44:47], s0 offen lds
    v_exp_f32 v176, v176
    v_exp_f32 v177, v177
    v_exp_f32 v178, v178
    v_exp_f32 v179, v179
    v_mfma_f32_32x32x16_bf16 v[208:223], v[140:143], v[196:199], v[208:223]
    s_cselect_b64 exec, -1, s[86:87]
    ds_read_b128 v[136:139], v119 offset:14336
    ds_read_b128 v[140:143], v119 offset:15360
    s_mov_b64 exec, -1
    s_add_u32 m0, s1, 5120
    v_exp_f32 v180, v180
    v_exp_f32 v181, v181
    v_exp_f32 v182, v182
    v_exp_f32 v183, v183
    v_cvt_pk_bf16_f32 v200, v176, v177
    v_cvt_pk_bf16_f32 v201, v178, v179
    v_cvt_pk_bf16_f32 v202, v180, v181
    v_cvt_pk_bf16_f32 v203, v182, v183
    v_exp_f32 v184, v184
    v_exp_f32 v185, v185
    v_exp_f32 v186, v186
    v_exp_f32 v187, v187
    v_mfma_f32_32x32x16_bf16 v[224:239], v[144:147], v[200:203], v[224:239]
    s_waitcnt lgkmcnt(0)
    buffer_load_dwordx4 v117, s[44:47], s0 offen lds
    s_add_u32 m0, s1, 6144
    v_exp_f32 v188, v188
    v_exp_f32 v189, v189
    v_exp_f32 v190, v190
    v_exp_f32 v191, v191
    v_cvt_pk_bf16_f32 v204, v184, v185
    v_cvt_pk_bf16_f32 v205, v186, v187
    v_cvt_pk_bf16_f32 v206, v188, v189
    v_cvt_pk_bf16_f32 v207, v190, v191
    v_mfma_f32_32x32x16_bf16 v[176:191], v[132:135], v[52:55], 0
    s_cmp_lt_u32 s6, 5
    ds_read_b128 v[128:131], v119 offset:8192
    buffer_load_dwordx4 v118, s[44:47], s0 offen lds
    v_exp_f32 v160, v160
    v_exp_f32 v161, v161
    v_exp_f32 v162, v162
    v_exp_f32 v163, v163
    v_mfma_f32_32x32x16_bf16 v[224:239], v[148:151], v[204:207], v[224:239]
    s_cselect_b64 exec, -1, s[88:89]
    ds_read_b128 v[144:147], v119 offset:14336
    ds_read_b128 v[148:151], v119 offset:15360
    s_mov_b64 exec, -1
    s_add_u32 s65, s3, 3
    s_and_b32 s65, s65, 3
    s_mul_i32 s65, s65, 28672
    s_add_u32 s1, s63, s65
    s_lshl4_add_u32 s0, s65, s62
    s_add_u32 m0, s1, 0
    v_exp_f32 v164, v164
    v_exp_f32 v165, v165
    v_exp_f32 v166, v166
    v_exp_f32 v167, v167
    v_cvt_pk_bf16_f32 v192, v160, v161
    v_cvt_pk_bf16_f32 v193, v162, v163
    v_cvt_pk_bf16_f32 v194, v164, v165
    v_cvt_pk_bf16_f32 v195, v166, v167
    v_exp_f32 v168, v168
    v_exp_f32 v169, v169
    v_exp_f32 v170, v170
    v_exp_f32 v171, v171
    v_mfma_f32_32x32x16_bf16 v[208:223], v[136:139], v[192:195], v[208:223]
    s_waitcnt lgkmcnt(0)
    buffer_load_dwordx4 v112, s[44:47], s0 offen lds
    s_add_u32 m0, s1, 1024
    v_exp_f32 v172, v172
    v_exp_f32 v173, v173
    v_exp_f32 v174, v174
    v_exp_f32 v175, v175
    v_cvt_pk_bf16_f32 v196, v168, v169
    v_cvt_pk_bf16_f32 v197, v170, v171
    v_cvt_pk_bf16_f32 v198, v172, v173
    v_cvt_pk_bf16_f32 v199, v174, v175
    v_mfma_f32_32x32x16_bf16 v[160:175], v[128:131], v[48:51], 0
    s_cmp_lt_u32 s6, 6
    ds_read_b128 v[132:135], v119 offset:9216
    buffer_load_dwordx4 v113, s[44:47], s0 offen lds
    v_exp_f32 v176, v176
    v_exp_f32 v177, v177
    v_exp_f32 v178, v178
    v_exp_f32 v179, v179
    v_mfma_f32_32x32x16_bf16 v[208:223], v[140:143], v[196:199], v[208:223]
    s_cselect_b64 exec, -1, s[86:87]
    ds_read_b128 v[136:139], v119 offset:10240
    ds_read_b128 v[140:143], v119 offset:11264
    s_mov_b64 exec, -1
    s_add_u32 m0, s1, 2048
    v_exp_f32 v180, v180
    v_exp_f32 v181, v181
    v_exp_f32 v182, v182
    v_exp_f32 v183, v183
    v_cvt_pk_bf16_f32 v200, v176, v177
    v_cvt_pk_bf16_f32 v201, v178, v179
    v_cvt_pk_bf16_f32 v202, v180, v181
    v_cvt_pk_bf16_f32 v203, v182, v183
    v_exp_f32 v184, v184
    v_exp_f32 v185, v185
    v_exp_f32 v186, v186
    v_exp_f32 v187, v187
    v_mfma_f32_32x32x16_bf16 v[224:239], v[144:147], v[200:203], v[224:239]
    s_waitcnt lgkmcnt(0)
    buffer_load_dwordx4 v114, s[44:47], s0 offen lds
    s_add_u32 m0, s1, 3072
    v_exp_f32 v188, v188
    v_exp_f32 v189, v189
    v_exp_f32 v190, v190
    v_exp_f32 v191, v191
    v_cvt_pk_bf16_f32 v204, v184, v185
    v_cvt_pk_bf16_f32 v205, v186, v187
    v_cvt_pk_bf16_f32 v206, v188, v189
    v_cvt_pk_bf16_f32 v207, v190, v191
    v_mfma_f32_32x32x16_bf16 v[176:191], v[132:135], v[52:55], 0
    s_cmp_lt_u32 s6, 6
    ds_read_b128 v[128:131], v119 offset:4096
    buffer_load_dwordx4 v115, s[44:47], s0 offen lds
    v_exp_f32 v160, v160
    v_exp_f32 v161, v161
    v_exp_f32 v162, v162
    v_exp_f32 v163, v163
    v_mfma_f32_32x32x16_bf16 v[224:239], v[148:151], v[204:207], v[224:239]
    s_cselect_b64 exec, -1, s[88:89]
    ds_read_b128 v[144:147], v119 offset:10240
    ds_read_b128 v[148:151], v119 offset:11264
    s_mov_b64 exec, -1
    v_exp_f32 v164, v164
    v_exp_f32 v165, v165
    v_exp_f32 v166, v166
    v_exp_f32 v167, v167
    v_cvt_pk_bf16_f32 v192, v160, v161
    v_cvt_pk_bf16_f32 v193, v162, v163
    v_cvt_pk_bf16_f32 v194, v164, v165
    v_cvt_pk_bf16_f32 v195, v166, v167
    v_exp_f32 v168, v168
    v_exp_f32 v169, v169
    v_exp_f32 v170, v170
    v_exp_f32 v171, v171
    v_mfma_f32_32x32x16_bf16 v[208:223], v[136:139], v[192:195], v[208:223]
    s_waitcnt lgkmcnt(0)
    buffer_load_dword v15, v126, s[52:55], 0 offen offset:0 sc1
    s_add_u32 m0, s1, 4096
    v_exp_f32 v172, v172
    v_exp_f32 v173, v173
    v_exp_f32 v174, v174
    v_exp_f32 v175, v175
    v_cvt_pk_bf16_f32 v196, v168, v169
    v_cvt_pk_bf16_f32 v197, v170, v171
    v_cvt_pk_bf16_f32 v198, v172, v173
    v_cvt_pk_bf16_f32 v199, v174, v175
    v_mfma_f32_32x32x16_bf16 v[160:175], v[128:131], v[48:51], 0
    s_cmp_lt_u32 s6, 7
    ds_read_b128 v[132:135], v119 offset:5120
    buffer_load_dwordx4 v116, s[44:47], s0 offen lds
    v_exp_f32 v176, v176
    v_exp_f32 v177, v177
    v_exp_f32 v178, v178
    v_exp_f32 v179, v179
    v_mfma_f32_32x32x16_bf16 v[208:223], v[140:143], v[196:199], v[208:223]
    s_cselect_b64 exec, -1, s[86:87]
    ds_read_b128 v[136:139], v119 offset:6144
    ds_read_b128 v[140:143], v119 offset:7168
    s_mov_b64 exec, -1
    s_add_u32 m0, s1, 5120
    v_exp_f32 v180, v180
    v_exp_f32 v181, v181
    v_exp_f32 v182, v182
    v_exp_f32 v183, v183
    v_cvt_pk_bf16_f32 v200, v176, v177
    v_cvt_pk_bf16_f32 v201, v178, v179
    v_cvt_pk_bf16_f32 v202, v180, v181
    v_cvt_pk_bf16_f32 v203, v182, v183
    v_exp_f32 v184, v184
    v_exp_f32 v185, v185
    v_exp_f32 v186, v186
    v_exp_f32 v187, v187
    v_mfma_f32_32x32x16_bf16 v[224:239], v[144:147], v[200:203], v[224:239]
    s_waitcnt lgkmcnt(0)
    buffer_load_dwordx4 v117, s[44:47], s0 offen lds
    v_exp_f32 v188, v188
    v_exp_f32 v189, v189
    v_exp_f32 v190, v190
    v_exp_f32 v191, v191
    v_cvt_pk_bf16_f32 v204, v184, v185
    v_cvt_pk_bf16_f32 v205, v186, v187
    v_cvt_pk_bf16_f32 v206, v188, v189
    v_cvt_pk_bf16_f32 v207, v190, v191
    v_mfma_f32_32x32x16_bf16 v[176:191], v[132:135], v[52:55], 0
    s_cmp_lt_u32 s6, 7
    ds_read_b128 v[128:131], v119 offset:0
    s_mov_b32 s65, 0
    buffer_load_dwordx4 v[64:67], v124, s[52:55], s65 offen sc1
    v_exp_f32 v160, v160
    v_exp_f32 v161, v161
    v_exp_f32 v162, v162
    v_exp_f32 v163, v163
    v_mfma_f32_32x32x16_bf16 v[224:239], v[148:151], v[204:207], v[224:239]
    s_cselect_b64 exec, -1, s[88:89]
    ds_read_b128 v[144:147], v119 offset:6144
    ds_read_b128 v[148:151], v119 offset:7168
    s_mov_b64 exec, -1
    v_exp_f32 v164, v164
    v_exp_f32 v165, v165
    v_exp_f32 v166, v166
    v_exp_f32 v167, v167
    v_cvt_pk_bf16_f32 v192, v160, v161
    v_cvt_pk_bf16_f32 v193, v162, v163
    v_cvt_pk_bf16_f32 v194, v164, v165
    v_cvt_pk_bf16_f32 v195, v166, v167
    v_exp_f32 v168, v168
    v_exp_f32 v169, v169
    v_exp_f32 v170, v170
    v_exp_f32 v171, v171
    v_mfma_f32_32x32x16_bf16 v[208:223], v[136:139], v[192:195], v[208:223]
    s_waitcnt lgkmcnt(0)
    s_mov_b32 s65, 12288
    buffer_load_dwordx4 v[68:71], v124, s[52:55], s65 offen sc1
    v_exp_f32 v172, v172
    v_exp_f32 v173, v173
    v_exp_f32 v174, v174
    v_exp_f32 v175, v175
    v_cvt_pk_bf16_f32 v196, v168, v169
    v_cvt_pk_bf16_f32 v197, v170, v171
    v_cvt_pk_bf16_f32 v198, v172, v173
    v_cvt_pk_bf16_f32 v199, v174, v175
    v_mfma_f32_32x32x16_bf16 v[160:175], v[128:131], v[48:51], v[32:47]
    s_cmp_lt_u32 s6, 8
    ds_read_b128 v[132:135], v119 offset:1024
    s_mov_b32 s65, 24576
    buffer_load_dwordx4 v[72:75], v124, s[52:55], s65 offen sc1
    v_exp_f32 v176, v176
    v_exp_f32 v177, v177
    v_exp_f32 v178, v178
    v_exp_f32 v179, v179
    v_mfma_f32_32x32x16_bf16 v[208:223], v[140:143], v[196:199], v[208:223]
    s_cselect_b64 exec, -1, s[86:87]
    ds_read_b128 v[136:139], v119 offset:2048
    ds_read_b128 v[140:143], v119 offset:3072
    s_mov_b64 exec, -1
    v_exp_f32 v180, v180
    v_exp_f32 v181, v181
    v_exp_f32 v182, v182
    v_exp_f32 v183, v183
    v_cvt_pk_bf16_f32 v200, v176, v177
    v_cvt_pk_bf16_f32 v201, v178, v179
    v_cvt_pk_bf16_f32 v202, v180, v181
    v_cvt_pk_bf16_f32 v203, v182, v183
    v_exp_f32 v184, v184
    v_exp_f32 v185, v185
    v_exp_f32 v186, v186
    v_exp_f32 v187, v187
    v_mfma_f32_32x32x16_bf16 v[224:239], v[144:147], v[200:203], v[224:239]
    s_waitcnt lgkmcnt(0)
    s_mov_b32 s65, 36864
    buffer_load_dwordx4 v[76:79], v124, s[52:55], s65 offen sc1
    v_exp_f32 v188, v188
    v_exp_f32 v189, v189
    v_exp_f32 v190, v190
    v_exp_f32 v191, v191
    v_cvt_pk_bf16_f32 v204, v184, v185
    v_cvt_pk_bf16_f32 v205, v186, v187
    v_cvt_pk_bf16_f32 v206, v188, v189
    v_cvt_pk_bf16_f32 v207, v190, v191
    v_mfma_f32_32x32x16_bf16 v[176:191], v[132:135], v[52:55], v[32:47]
    s_cmp_lt_u32 s6, 8
    buffer_load_dwordx4 v[80:83], v125, s[52:55], 0 offen sc1
    v_exp_f32 v160, v160
    v_exp_f32 v161, v161
    v_exp_f32 v162, v162
    v_exp_f32 v163, v163
    v_mfma_f32_32x32x16_bf16 v[224:239], v[148:151], v[204:207], v[224:239]
    s_cselect_b64 exec, -1, s[88:89]
    ds_read_b128 v[144:147], v119 offset:2048
    ds_read_b128 v[148:151], v119 offset:3072
    s_mov_b64 exec, -1
    v_exp_f32 v164, v164
    v_exp_f32 v165, v165
    v_exp_f32 v166, v166
    v_exp_f32 v167, v167
    v_cvt_pk_bf16_f32 v192, v160, v161
    v_cvt_pk_bf16_f32 v193, v162, v163
    v_cvt_pk_bf16_f32 v194, v164, v165
    v_cvt_pk_bf16_f32 v195, v166, v167
    v_exp_f32 v168, v168
    v_exp_f32 v169, v169
    v_exp_f32 v170, v170
    v_exp_f32 v171, v171
    v_mfma_f32_32x32x16_bf16 v[208:223], v[136:139], v[192:195], v[208:223]
    s_waitcnt lgkmcnt(0)
    s_waitcnt vmcnt(7)
    v_cmp_ne_u32 vcc, s68, v15
    s_cbranch_vccnz L_fpretry_15
L_fpback_16:
    v_exp_f32 v172, v172
    v_exp_f32 v173, v173
    v_exp_f32 v174, v174
    v_exp_f32 v175, v175
    v_cvt_pk_bf16_f32 v196, v168, v169
    v_cvt_pk_bf16_f32 v197, v170, v171
    v_cvt_pk_bf16_f32 v198, v172, v173
    v_cvt_pk_bf16_f32 v199, v174, v175
    buffer_load_dwordx4 a[192:195], v2, s[52:55], s96 offen offset:0 sc1
    v_exp_f32 v176, v176
    v_exp_f32 v177, v177
    v_exp_f32 v178, v178
    v_exp_f32 v179, v179
    v_mfma_f32_32x32x16_bf16 v[208:223], v[140:143], v[196:199], v[208:223]
    v_exp_f32 v180, v180
    v_exp_f32 v181, v181
    v_exp_f32 v182, v182
    v_exp_f32 v183, v183
    v_cvt_pk_bf16_f32 v200, v176, v177
    v_cvt_pk_bf16_f32 v201, v178, v179
    v_cvt_pk_bf16_f32 v202, v180, v181
    v_cvt_pk_bf16_f32 v203, v182, v183
    v_exp_f32 v184, v184
    v_exp_f32 v185, v185
    v_exp_f32 v186, v186
    v_exp_f32 v187, v187
    v_mfma_f32_32x32x16_bf16 v[224:239], v[144:147], v[200:203], v[224:239]
    buffer_load_dwordx4 a[196:199], v2, s[52:55], s96 offen offset:1024 sc1
    v_exp_f32 v188, v188
    v_exp_f32 v189, v189
    v_exp_f32 v190, v190
    v_exp_f32 v191, v191
    v_cvt_pk_bf16_f32 v204, v184, v185
    v_cvt_pk_bf16_f32 v205, v186, v187
    v_cvt_pk_bf16_f32 v206, v188, v189
    v_cvt_pk_bf16_f32 v207, v190, v191
    s_nop 1
    v_mfma_f32_32x32x16_bf16 v[224:239], v[148:151], v[204:207], v[224:239]
    s_mov_b32 s76, 0x1f800000
    s_mov_b32 s77, 0x5f800000
    s_mov_b32 s78, 0x7f000000
    v_add_f32 v10, abs(v208), abs(v209)
    v_add_f32 v10, v10, abs(v210)
    v_add_f32 v10, v10, abs(v211)
    v_add_f32 v10, v10, abs(v212)
    v_add_f32 v10, v10, abs(v213)
    v_add_f32 v10, v10, abs(v214)
    v_add_f32 v10, v10, abs(v215)
    v_cmp_nle_f32 vcc, s76, v216
    v_cmp_nge_f32 s[92:93], s77, v216
    v_add_f32 v10, v10, abs(v232)
    v_add_f32 v10, v10, abs(v233)
    v_add_f32 v10, v10, abs(v234)
    v_add_f32 v10, v10, abs(v235)
    v_add_f32 v10, v10, abs(v236)
    v_add_f32 v10, v10, abs(v237)
    v_add_f32 v10, v10, abs(v238)
    v_add_f32 v10, v10, abs(v239)
    s_or_b64 vcc, vcc, s[92:93]
    v_cmp_nle_f32 s[92:93], s76, v224
    v_cmp_nge_f32 s[94:95], s77, v224
    v_cmp_ngt_f32 s[90:91], s78, v10
    v_rcp_f32 v10, v216
    v_rcp_f32 v12, v224
    s_or_b64 vcc, vcc, s[92:93]
    s_or_b64 vcc, vcc, s[94:95]
    s_or_b64 vcc, vcc, s[90:91]
    s_cbranch_scc1 L_fb_19
L_attok_20:
    v_pk_mul_f32 v[208:209], v[208:209], v[10:11] op_sel_hi:[1,0]
    v_pk_mul_f32 v[210:211], v[210:211], v[10:11] op_sel_hi:[1,0]
    v_pk_mul_f32 v[212:213], v[212:213], v[10:11] op_sel_hi:[1,0]
    v_pk_mul_f32 v[214:215], v[214:215], v[10:11] op_sel_hi:[1,0]
    v_cvt_pk_bf16_f32 v192, v208, v209
    v_cvt_pk_bf16_f32 v193, v210, v211
    v_cvt_pk_bf16_f32 v194, v212, v213
    v_cvt_pk_bf16_f32 v195, v214, v215
    buffer_store_dwordx4 v[192:195], v123, s[52:55], s21 offen offset:0 sc1
    v_pk_mul_f32 v[232:233], v[232:233], v[12:13] op_sel_hi:[1,0]
    v_pk_mul_f32 v[234:235], v[234:235], v[12:13] op_sel_hi:[1,0]
    v_pk_mul_f32 v[236:237], v[236:237], v[12:13] op_sel_hi:[1,0]
    v_pk_mul_f32 v[238:239], v[238:239], v[12:13] op_sel_hi:[1,0]
    v_cvt_pk_bf16_f32 v196, v232, v233
    v_cvt_pk_bf16_f32 v197, v234, v235
    v_cvt_pk_bf16_f32 v198, v236, v237
    v_cvt_pk_bf16_f32 v199, v238, v239
    buffer_store_dwordx4 v[196:199], v123, s[52:55], s21 offen offset:512 sc1
    buffer_load_dwordx4 a[200:203], v2, s[52:55], s96 offen offset:2048 sc1
    buffer_load_dwordx4 a[204:207], v2, s[52:55], s96 offen offset:3072 sc1
    s_add_u32 s96, s96, 4096
    buffer_load_dwordx4 a[208:211], v2, s[52:55], s96 offen offset:0 sc1
    buffer_load_dwordx4 a[212:215], v2, s[52:55], s96 offen offset:1024 sc1
    buffer_load_dwordx4 a[216:219], v2, s[52:55], s96 offen offset:2048 sc1
    buffer_load_dwordx4 a[220:223], v2, s[52:55], s96 offen offset:3072 sc1
    s_add_u32 s96, s96, 4096
    buffer_load_dwordx4 a[224:227], v2, s[52:55], s96 offen offset:0 sc1
    buffer_load_dwordx4 a[228:231], v2, s[52:55], s96 offen offset:1024 sc1
    s_waitcnt vmcnt(10)
    s_mov_b32 s82, 0
L_pmr_21:
    v_xor_b32 v64, s40, v64
    v_xor_b32 v65, s41, v65
    v_xor_b32 v66, s42, v66
    v_xor_b32 v67, s43, v67
    v_or3_b32 v84, v64, v65, v66
    v_or_b32 v84, v84, v67
    v_xor_b32 v68, s40, v68
    v_xor_b32 v69, s41, v69
    v_xor_b32 v70, s42, v70
    v_xor_b32 v71, s43, v71
    v_or3_b32 v84, v68, v69, v84
    v_or3_b32 v84, v70, v71, v84
    v_xor_b32 v72, s40, v72
    v_xor_b32 v73, s41, v73
    v_xor_b32 v74, s42, v74
    v_xor_b32 v75, s43, v75
    v_or3_b32 v84, v72, v73, v84
    v_or3_b32 v84, v74, v75, v84
    v_xor_b32 v76, s40, v76
    v_xor_b32 v77, s41, v77
    v_xor_b32 v78, s42, v78
    v_xor_b32 v79, s43, v79
    v_or3_b32 v84, v76, v77, v84
    v_or3_b32 v84, v78, v79, v84
    v_xor_b32 v80, s40, v80
    v_xor_b32 v81, s41, v81
    v_xor_b32 v82, s42, v82
    v_xor_b32 v83, s43, v83
    v_or3_b32 v84, v80, v81, v84
    v_or3_b32 v84, v82, v83, v84
    v_and_b32 v84, 0xff, v84
    v_cmp_ne_u32 vcc, 0, v84
    s_cbranch_vccz L_dmr_22
    s_add_u32 s82, s82, 1
    s_cmp_ge_u32 s82, 131072
    s_cbranch_scc1 L_dmr_22
    s_mov_b32 s65, 0
    buffer_load_dwordx4 v[64:67], v124, s[52:55], s65 offen sc1
    s_mov_b32 s65, 12288
    buffer_load_dwordx4 v[68:71], v124, s[52:55], s65 offen sc1
    s_mov_b32 s65, 24576
    buffer_load_dwordx4 v[72:75], v124, s[52:55], s65 offen sc1
    s_mov_b32 s65, 36864
    buffer_load_dwordx4 v[76:79], v124, s[52:55], s65 offen sc1
    buffer_load_dwordx4 v[80:83], v125, s[52:55], 0 offen sc1
    s_waitcnt vmcnt(0)
    s_branch L_pmr_21
L_dmr_22:
    s_waitcnt vmcnt(8)
    s_mov_b64 exec, 1
    buffer_store_dword v3, off, s[52:55], s9
    s_mov_b64 exec, -1
    s_getpc_b64 s[90:91]
L_pc_23:
    s_lshl2_add_u32 s65, s4, s5
    s_lshl_b32 s65, s65, 7
    s_min_u32 s65, s65, L_localend-L_pc_23-4
    v_mov_b32 v10, s65
    global_load_dword v152, v10, s[90:91]
    buffer_load_dwordx4 a[232:235], v2, s[52:55], s96 offen offset:2048 sc1
    buffer_load_dwordx4 a[236:239], v2, s[52:55], s96 offen offset:3072 sc1
    s_add_u32 s96, s96, 4096
    buffer_load_dwordx4 a[240:243], v2, s[52:55], s96 offen offset:0 sc1
    s_cmp_ge_u32 s5, 2
    s_cselect_b32 s80, 1.0, 0
    v_permlane32_swap_b32 v80, v81
    v_permlane32_swap_b32 v82, v83
    v_add_f32 v80, v80, v81
    v_add_f32 v82, v82, v83
    v_pk_add_f32 v[64:65], v[64:65], v[68:69]
    v_pk_add_f32 v[72:73], v[72:73], v[76:77]
    v_pk_add_f32 v[66:67], v[66:67], v[70:71]
    v_pk_add_f32 v[74:75], v[74:75], v[78:79]
    v_pk_add_f32 v[64:65], v[64:65], v[72:73]
    v_pk_add_f32 v[66:67], v[66:67], v[74:75]
    v_cvt_pk_bf16_f32 v68, v64, v65
    v_cvt_pk_bf16_f32 v69, v66, v67
    v_lshlrev_b32 v72, 16, v68
    v_and_b32 v73, 0xffff0000, v68
    v_lshlrev_b32 v74, 16, v69
    v_and_b32 v75, 0xffff0000, v69
    v_add_f32 v72, s80, v72
    v_add_f32 v73, s80, v73
    v_add_f32 v74, s80, v74
    v_add_f32 v75, s80, v75
    v_cvt_pk_bf16_f32 v64, v72, v73
    v_cvt_pk_bf16_f32 v65, v74, v75
    v_permlane16_swap_b32 v80, v82
    v_add_f32 v80, v80, v82
    v_cvt_pk_bf16_f32 v80, v80, v80
    v_lshlrev_b32 v12, 16, v80
    s_lshl_b32 s76, s5, 11
    s_add_u32 s76, s76, 155648
    s_mov_b32 s77, 8192
    v_and_b32 v13, 15, v1
    v_lshrrev_b32 v14, 3, v1
    v_and_b32 v14, 6, v14
    v_xor_b32 v14, v14, v13
    v_and_b32 v14, 7, v14
    v_lshl_add_u32 v13, v13, 7, s76
    v_lshl_add_u32 v13, v14, 4, v13
    v_xor_b32 v14, 16, v13
    v_mov_b32 v95, v127
    s_barrier
    s_add_u32 m0, s76, 0
    s_nop 0
    buffer_load_dwordx4 v4, s[32:35], 0 offen lds
    s_add_u32 m0, s76, 1024
    s_nop 0
    buffer_load_dwordx4 v4, s[32:35], s77 offen lds
    ds_write_b64 v110, v[64:65]
    ds_write_b32 v111, v12
    s_waitcnt lgkmcnt(0)
    buffer_load_dword v15, v104, s[52:55], 0 offen offset:64 sc1
    buffer_load_dwordx4 a[244:247], v2, s[52:55], s96 offen offset:1024 sc1
    buffer_load_dwordx4 a[248:251], v2, s[52:55], s96 offen offset:2048 sc1
    buffer_load_dwordx4 a[252:255], v2, s[52:55], s96 offen offset:3072 sc1
    s_add_u32 m0, s1, 6144
    s_nop 0
    buffer_load_dwordx4 v118, s[44:47], s0 offen lds
    s_waitcnt vmcnt(4)
    v_cmp_ne_u32 vcc, s68, v15
    s_nop 0
    s_and_b64 vcc, vcc, s[60:61]
    s_cbranch_scc0 L_qo_24
    s_mov_b32 s82, 0
L_po_25:
    buffer_load_dword v15, v104, s[52:55], 0 offen offset:64 sc1
    s_add_u32 s82, s82, 1
    s_waitcnt vmcnt(0)
    v_cmp_ne_u32 vcc, s68, v15
    s_nop 0
    s_and_b64 vcc, vcc, s[60:61]
    s_cbranch_scc0 L_do_26
    s_cmp_lt_u32 s82, 131072
    s_cbranch_scc1 L_po_25
L_do_26:
L_qo_24:
    buffer_load_dwordx4 v[128:131], v2, s[52:55], s10 offen offset:0 sc1
    buffer_load_dwordx4 v[132:135], v2, s[52:55], s10 offen offset:1024 sc1
    buffer_load_dwordx4 v[136:139], v2, s[52:55], s10 offen offset:2048 sc1
    buffer_load_dwordx4 v[140:143], v2, s[52:55], s10 offen offset:3072 sc1
    buffer_load_dwordx4 v[144:147], v2, s[52:55], s11 offen offset:0 sc1
    buffer_load_dwordx4 v[148:151], v2, s[52:55], s11 offen offset:1024 sc1
    buffer_load_dwordx4 v[152:155], v2, s[52:55], s11 offen offset:2048 sc1
    buffer_load_dwordx4 v[156:159], v2, s[52:55], s11 offen offset:3072 sc1
    buffer_load_dwordx4 v[160:163], v2, s[52:55], s12 offen offset:0 sc1
    buffer_load_dwordx4 v[164:167], v2, s[52:55], s12 offen offset:1024 sc1
    buffer_load_dwordx4 v[168:171], v2, s[52:55], s12 offen offset:2048 sc1
    buffer_load_dwordx4 v[172:175], v2, s[52:55], s12 offen offset:3072 sc1
    ds_read_b128 v[192:195], v13
    ds_read_b128 v[196:199], v14
    s_waitcnt lgkmcnt(0)
    v_lshlrev_b32 v240, 16, v192
    v_and_b32 v241, 0xffff0000, v192
    v_lshlrev_b32 v242, 16, v193
    v_and_b32 v243, 0xffff0000, v193
    v_lshlrev_b32 v244, 16, v194
    v_and_b32 v245, 0xffff0000, v194
    v_lshlrev_b32 v246, 16, v195
    v_and_b32 v247, 0xffff0000, v195
    v_lshlrev_b32 v248, 16, v196
    v_and_b32 v249, 0xffff0000, v196
    v_lshlrev_b32 v250, 16, v197
    v_and_b32 v251, 0xffff0000, v197
    v_lshlrev_b32 v252, 16, v198
    v_and_b32 v253, 0xffff0000, v198
    v_lshlrev_b32 v254, 16, v199
    v_and_b32 v255, 0xffff0000, v199
    s_waitcnt vmcnt(11)
    v_mfma_f32_16x16x32_bf16 v[16:19], a[192:195], v[128:131], 0
    v_mfma_f32_16x16x32_bf16 v[20:23], a[196:199], v[128:131], 0
    buffer_load_dwordx4 v[176:179], v2, s[52:55], s13 offen offset:0 sc1
    v_mfma_f32_16x16x32_bf16 v[24:27], a[200:203], v[128:131], 0
    v_mfma_f32_16x16x32_bf16 v[28:31], a[204:207], v[128:131], 0
    s_waitcnt vmcnt(11)
    v_mfma_f32_16x16x32_bf16 v[16:19], a[208:211], v[132:135], v[16:19]
    v_mfma_f32_16x16x32_bf16 v[20:23], a[212:215], v[132:135], v[20:23]
    buffer_load_dwordx4 v[180:183], v2, s[52:55], s13 offen offset:1024 sc1
    v_mfma_f32_16x16x32_bf16 v[24:27], a[216:219], v[132:135], v[24:27]
    v_mfma_f32_16x16x32_bf16 v[28:31], a[220:223], v[132:135], v[28:31]
    s_waitcnt vmcnt(11)
    v_mfma_f32_16x16x32_bf16 v[16:19], a[224:227], v[136:139], v[16:19]
    v_mfma_f32_16x16x32_bf16 v[20:23], a[228:231], v[136:139], v[20:23]
    buffer_load_dwordx4 v[184:187], v2, s[52:55], s13 offen offset:2048 sc1
    v_mfma_f32_16x16x32_bf16 v[24:27], a[232:235], v[136:139], v[24:27]
    v_mfma_f32_16x16x32_bf16 v[28:31], a[236:239], v[136:139], v[28:31]
    s_waitcnt vmcnt(11)
    v_mfma_f32_16x16x32_bf16 v[16:19], a[240:243], v[140:143], v[16:19]
    v_mfma_f32_16x16x32_bf16 v[20:23], a[244:247], v[140:143], v[20:23]
    buffer_load_dwordx4 v[188:191], v2, s[52:55], s13 offen offset:3072 sc1
    v_mfma_f32_16x16x32_bf16 v[24:27], a[248:251], v[140:143], v[24:27]
    buffer_load_dwordx4 a[0:3], v2, s[52:55], s101 offen offset:0 sc1
    v_mfma_f32_16x16x32_bf16 v[28:31], a[252:255], v[140:143], v[28:31]
    s_waitcnt vmcnt(12)
    v_mfma_f32_16x16x32_bf16 v[32:35], a[192:195], v[144:147], 0
    v_mfma_f32_16x16x32_bf16 v[36:39], a[196:199], v[144:147], 0
    buffer_load_dwordx4 a[4:7], v2, s[52:55], s101 offen offset:1024 sc1
    v_mfma_f32_16x16x32_bf16 v[40:43], a[200:203], v[144:147], 0
    buffer_load_dwordx4 a[8:11], v2, s[52:55], s101 offen offset:2048 sc1
    v_mfma_f32_16x16x32_bf16 v[44:47], a[204:207], v[144:147], 0
    ds_write_b128 v6, v[16:19] offset:0
    s_waitcnt vmcnt(13)
    v_mfma_f32_16x16x32_bf16 v[32:35], a[208:211], v[148:151], v[32:35]
    v_mfma_f32_16x16x32_bf16 v[36:39], a[212:215], v[148:151], v[36:39]
    buffer_load_dwordx4 a[12:15], v2, s[52:55], s101 offen offset:3072 sc1
    v_mfma_f32_16x16x32_bf16 v[40:43], a[216:219], v[148:151], v[40:43]
    s_add_u32 s101, s101, 4096
    buffer_load_dwordx4 a[16:19], v2, s[52:55], s101 offen offset:0 sc1
    ds_write_b128 v6, v[20:23] offset:1024
    v_mfma_f32_16x16x32_bf16 v[44:47], a[220:223], v[148:151], v[44:47]
    s_waitcnt vmcnt(14)
    v_mfma_f32_16x16x32_bf16 v[32:35], a[224:227], v[152:155], v[32:35]
    v_mfma_f32_16x16x32_bf16 v[36:39], a[228:231], v[152:155], v[36:39]
    buffer_load_dwordx4 a[20:23], v2, s[52:55], s101 offen offset:1024 sc1
    ds_write_b128 v6, v[24:27] offset:2048
    v_mfma_f32_16x16x32_bf16 v[40:43], a[232:235], v[152:155], v[40:43]
    buffer_load_dwordx4 a[24:27], v2, s[52:55], s101 offen offset:2048 sc1
    v_mfma_f32_16x16x32_bf16 v[44:47], a[236:239], v[152:155], v[44:47]
    s_waitcnt vmcnt(15)
    v_mfma_f32_16x16x32_bf16 v[32:35], a[240:243], v[156:159], v[32:35]
    ds_write_b128 v6, v[28:31] offset:3072
    v_mfma_f32_16x16x32_bf16 v[36:39], a[244:247], v[156:159], v[36:39]
    buffer_load_dwordx4 a[28:31], v2, s[52:55], s101 offen offset:3072 sc1
    v_mfma_f32_16x16x32_bf16 v[40:43], a[248:251], v[156:159], v[40:43]
    s_add_u32 s101, s101, 4096
    buffer_load_dwordx4 a[32:35], v2, s[52:55], s101 offen offset:0 sc1
    v_mfma_f32_16x16x32_bf16 v[44:47], a[252:255], v[156:159], v[44:47]
    s_waitcnt vmcnt(16)
    v_mfma_f32_16x16x32_bf16 v[112:115], a[192:195], v[160:163], 0
    v_mfma_f32_16x16x32_bf16 v[116:119], a[196:199], v[160:163], 0
    buffer_load_dwordx4 a[36:39], v2, s[52:55], s101 offen offset:1024 sc1
    v_mfma_f32_16x16x32_bf16 v[120:123], a[200:203], v[160:163], 0
    buffer_load_dwordx4 a[40:43], v2, s[52:55], s101 offen offset:2048 sc1
    v_mfma_f32_16x16x32_bf16 v[124:127], a[204:207], v[160:163], 0
    ds_write_b128 v7, v[32:35] offset:0
    s_waitcnt vmcnt(17) lgkmcnt(1)
    s_barrier
    v_mfma_f32_16x16x32_bf16 v[112:115], a[208:211], v[164:167], v[112:115]
    ds_read_b128 v[48:51], v9 offset:0
    v_mfma_f32_16x16x32_bf16 v[116:119], a[212:215], v[164:167], v[116:119]
    buffer_load_dwordx4 a[44:47], v2, s[52:55], s101 offen offset:3072 sc1
    ds_read_b128 v[52:55], v9 offset:1024
    v_mfma_f32_16x16x32_bf16 v[120:123], a[216:219], v[164:167], v[120:123]
    s_add_u32 s101, s101, 4096
    buffer_load_dwordx4 a[48:51], v2, s[52:55], s101 offen offset:0 sc1
    ds_write_b128 v7, v[36:39] offset:1024
    ds_read_b128 v[56:59], v9 offset:2048
    v_mfma_f32_16x16x32_bf16 v[124:127], a[220:223], v[164:167], v[124:127]
    ds_read_b128 v[60:63], v9 offset:3072
    s_waitcnt vmcnt(18)
    v_mfma_f32_16x16x32_bf16 v[112:115], a[224:227], v[168:171], v[112:115]
    v_mfma_f32_16x16x32_bf16 v[116:119], a[228:231], v[168:171], v[116:119]
    buffer_load_dwordx4 a[52:55], v2, s[52:55], s101 offen offset:1024 sc1
    ds_write_b128 v7, v[40:43] offset:2048
    v_mfma_f32_16x16x32_bf16 v[120:123], a[232:235], v[168:171], v[120:123]
    buffer_load_dwordx4 a[56:59], v2, s[52:55], s101 offen offset:2048 sc1
    ds_read_b128 v[80:83], v95 offset:0
    v_mfma_f32_16x16x32_bf16 v[124:127], a[236:239], v[168:171], v[124:127]
    ds_read_b128 v[84:87], v95 offset:16
    s_waitcnt vmcnt(19)
    v_mfma_f32_16x16x32_bf16 v[112:115], a[240:243], v[172:175], v[112:115]
    ds_write_b128 v7, v[44:47] offset:3072
    v_mfma_f32_16x16x32_bf16 v[116:119], a[244:247], v[172:175], v[116:119]
    buffer_load_dwordx4 a[60:63], v2, s[52:55], s101 offen offset:3072 sc1
    ds_read_b128 v[208:211], v5 offset:0
    v_mfma_f32_16x16x32_bf16 v[120:123], a[248:251], v[172:175], v[120:123]
    s_add_u32 s101, s101, 4096
    buffer_load_dwordx4 a[64:67], v2, s[52:55], s101 offen offset:0 sc1
    ds_read_b128 v[212:215], v5 offset:16
    v_mfma_f32_16x16x32_bf16 v[124:127], a[252:255], v[172:175], v[124:127]
    ds_read_b128 v[216:219], v5 offset:32
    s_waitcnt vmcnt(20) lgkmcnt(0)
    s_barrier
    v_mfma_f32_16x16x32_bf16 v[48:51], a[192:195], v[176:179], v[48:51]
    ds_read_b128 v[64:67], v9 offset:4096
    v_mfma_f32_16x16x32_bf16 v[52:55], a[196:199], v[176:179], v[52:55]
    buffer_load_dwordx4 a[68:71], v2, s[52:55], s101 offen offset:1024 sc1
    ds_read_b128 v[68:71], v9 offset:5120
    v_mfma_f32_16x16x32_bf16 v[56:59], a[200:203], v[176:179], v[56:59]
    buffer_load_dwordx4 a[72:75], v2, s[52:55], s101 offen offset:2048 sc1
    ds_read_b128 v[72:75], v9 offset:6144
    v_mfma_f32_16x16x32_bf16 v[60:63], a[204:207], v[176:179], v[60:63]
    ds_write_b128 v8, v[112:115] offset:0
    ds_read_b128 v[76:79], v9 offset:7168
    s_waitcnt vmcnt(21)
    v_mfma_f32_16x16x32_bf16 v[48:51], a[208:211], v[180:183], v[48:51]
    ds_read_b128 v[220:223], v5 offset:48
    v_mfma_f32_16x16x32_bf16 v[52:55], a[212:215], v[180:183], v[52:55]
    buffer_load_dwordx4 a[76:79], v2, s[52:55], s101 offen offset:3072 sc1
    v_lshlrev_b32 v224, 16, v80
    v_and_b32 v225, 0xffff0000, v80
    v_mfma_f32_16x16x32_bf16 v[56:59], a[216:219], v[180:183], v[56:59]
    s_add_u32 s101, s101, 4096
    buffer_load_dwordx4 a[80:83], v2, s[52:55], s101 offen offset:0 sc1
    ds_write_b128 v8, v[116:119] offset:1024
    v_lshlrev_b32 v226, 16, v81
    v_and_b32 v227, 0xffff0000, v81
    v_mfma_f32_16x16x32_bf16 v[60:63], a[220:223], v[180:183], v[60:63]
    v_lshlrev_b32 v228, 16, v82
    v_and_b32 v229, 0xffff0000, v82
    s_waitcnt vmcnt(22)
    v_mfma_f32_16x16x32_bf16 v[48:51], a[224:227], v[184:187], v[48:51]
    v_lshlrev_b32 v230, 16, v83
    v_and_b32 v231, 0xffff0000, v83
    v_mfma_f32_16x16x32_bf16 v[52:55], a[228:231], v[184:187], v[52:55]
    buffer_load_dwordx4 a[84:87], v2, s[52:55], s101 offen offset:1024 sc1
    ds_write_b128 v8, v[120:123] offset:2048
    v_lshlrev_b32 v232, 16, v84
    v_and_b32 v233, 0xffff0000, v84
    v_mfma_f32_16x16x32_bf16 v[56:59], a[232:235], v[184:187], v[56:59]
    buffer_load_dwordx4 a[88:91], v2, s[52:55], s101 offen offset:2048 sc1
    v_lshlrev_b32 v234, 16, v85
    v_and_b32 v235, 0xffff0000, v85
    v_mfma_f32_16x16x32_bf16 v[60:63], a[236:239], v[184:187], v[60:63]
    s_waitcnt vmcnt(23)
    v_mfma_f32_16x16x32_bf16 v[48:51], a[240:243], v[188:191], v[48:51]
    ds_write_b128 v8, v[124:127] offset:3072
    v_lshlrev_b32 v238, 16, v87
    v_and_b32 v239, 0xffff0000, v87
    v_mfma_f32_16x16x32_bf16 v[52:55], a[244:247], v[188:191], v[52:55]
    buffer_load_dwordx4 a[92:95], v2, s[52:55], s101 offen offset:3072 sc1
    v_mfma_f32_16x16x32_bf16 v[56:59], a[248:251], v[188:191], v[56:59]
    v_mfma_f32_16x16x32_bf16 v[60:63], a[252:255], v[188:191], v[60:63]
    v_lshlrev_b32 v236, 16, v86
    v_and_b32 v237, 0xffff0000, v86
    s_waitcnt lgkmcnt(0)
    s_barrier
    ds_read_b128 v[32:35], v9 offset:0
    ds_read_b128 v[36:39], v9 offset:1024
    ds_read_b128 v[40:43], v9 offset:2048
    ds_read_b128 v[44:47], v9 offset:3072
    v_pk_add_f32 v[48:49], v[48:49], v[64:65]
    v_pk_add_f32 v[50:51], v[50:51], v[66:67]
    v_pk_add_f32 v[52:53], v[52:53], v[68:69]
    v_pk_add_f32 v[54:55], v[54:55], v[70:71]
    v_pk_add_f32 v[56:57], v[56:57], v[72:73]
    v_pk_add_f32 v[58:59], v[58:59], v[74:75]
    v_pk_add_f32 v[60:61], v[60:61], v[76:77]
    v_pk_add_f32 v[62:63], v[62:63], v[78:79]
    s_waitcnt lgkmcnt(3)
    v_pk_add_f32 v[48:49], v[48:49], v[32:33]
    v_pk_add_f32 v[50:51], v[50:51], v[34:35]
    s_waitcnt lgkmcnt(2)
    v_pk_add_f32 v[52:53], v[52:53], v[36:37]
    v_pk_add_f32 v[54:55], v[54:55], v[38:39]
    s_waitcnt lgkmcnt(1)
    v_pk_add_f32 v[56:57], v[56:57], v[40:41]
    v_pk_add_f32 v[58:59], v[58:59], v[42:43]
    s_waitcnt lgkmcnt(0)
    v_pk_add_f32 v[60:61], v[60:61], v[44:45]
    v_pk_add_f32 v[62:63], v[62:63], v[46:47]
    v_pk_fma_f32 v[240:241], v[48:49], v[208:209], v[240:241]
    v_pk_fma_f32 v[242:243], v[50:51], v[210:211], v[242:243]
    v_pk_fma_f32 v[244:245], v[52:53], v[212:213], v[244:245]
    v_pk_fma_f32 v[246:247], v[54:55], v[214:215], v[246:247]
    v_pk_mul_f32 v[224:225], v[240:241], v[224:225]
    v_pk_mul_f32 v[226:227], v[242:243], v[226:227]
    v_pk_mul_f32 v[228:229], v[244:245], v[228:229]
    v_pk_mul_f32 v[230:231], v[246:247], v[230:231]
    v_cvt_pk_bf16_f32 v192, v224, v225
    v_cvt_pk_bf16_f32 v193, v226, v227
    v_cvt_pk_bf16_f32 v194, v228, v229
    v_cvt_pk_bf16_f32 v195, v230, v231
    buffer_store_dwordx4 v[192:195], v2, s[52:55], s22 offen offset:0 sc1
    v_pk_fma_f32 v[248:249], v[56:57], v[216:217], v[248:249]
    v_pk_fma_f32 v[250:251], v[58:59], v[218:219], v[250:251]
    v_pk_fma_f32 v[252:253], v[60:61], v[220:221], v[252:253]
    v_pk_fma_f32 v[254:255], v[62:63], v[222:223], v[254:255]
    v_pk_mul_f32 v[232:233], v[248:249], v[232:233]
    v_pk_mul_f32 v[234:235], v[250:251], v[234:235]
    v_pk_mul_f32 v[236:237], v[252:253], v[236:237]
    v_pk_mul_f32 v[238:239], v[254:255], v[238:239]
    v_cvt_pk_bf16_f32 v196, v232, v233
    v_cvt_pk_bf16_f32 v197, v234, v235
    v_cvt_pk_bf16_f32 v198, v236, v237
    v_cvt_pk_bf16_f32 v199, v238, v239
    buffer_store_dwordx4 v[196:199], v2, s[52:55], s22 offen offset:1024 sc1
    v_pk_add_f32 v[200:201], v[240:241], v[242:243]
    v_pk_mul_f32 v[202:203], v[240:241], v[240:241]
    v_pk_fma_f32 v[202:203], v[242:243], v[242:243], v[202:203]
    v_pk_add_f32 v[200:201], v[200:201], v[244:245]
    v_pk_fma_f32 v[202:203], v[244:245], v[244:245], v[202:203]
    v_pk_add_f32 v[200:201], v[200:201], v[246:247]
    v_pk_fma_f32 v[202:203], v[246:247], v[246:247], v[202:203]
    v_pk_add_f32 v[200:201], v[200:201], v[248:249]
    v_pk_fma_f32 v[202:203], v[248:249], v[248:249], v[202:203]
    v_pk_add_f32 v[200:201], v[200:201], v[250:251]
    v_pk_fma_f32 v[202:203], v[250:251], v[250:251], v[202:203]
    v_pk_add_f32 v[200:201], v[200:201], v[252:253]
    v_pk_fma_f32 v[202:203], v[252:253], v[252:253], v[202:203]
    v_pk_add_f32 v[200:201], v[200:201], v[254:255]
    v_pk_fma_f32 v[202:203], v[254:255], v[254:255], v[202:203]
    v_add_f32 v200, v200, v201
    v_add_f32 v202, v202, v203
    s_nop 1
    v_permlane32_swap_b32 v200, v202
    v_add_f32 v200, v200, v202
    v_mov_b32 v201, v200
    s_nop 1
    v_permlane16_swap_b32 v200, v201
    v_add_f32 v200, v200, v201
    buffer_store_dword v200, v105, s[52:55], s23 offen sc1
    s_lshl_b64 s[60:61], s[60:61], 16
    ds_read_b128 v[16:19], v92 offset:0
    ds_read_b64_tr_b16 v[20:21], v88 offset:0
    ds_read_b64_tr_b16 v[22:23], v88 offset:1792
    ds_read_b64_tr_b16 v[24:25], v90 offset:0
    ds_read_b64_tr_b16 v[26:27], v90 offset:1792
    ds_read_b128 v[28:31], v92 offset:16
    ds_read_b64_tr_b16 v[32:33], v88 offset:7168
    ds_read_b64_tr_b16 v[34:35], v88 offset:8960
    ds_read_b64_tr_b16 v[36:37], v90 offset:7168
    ds_read_b64_tr_b16 v[38:39], v90 offset:8960
    ds_read_b128 v[40:43], v92 offset:128
    ds_read_b64_tr_b16 v[44:45], v88 offset:14336
    ds_read_b64_tr_b16 v[46:47], v88 offset:16128
    ds_read_b64_tr_b16 v[48:49], v90 offset:14336
    ds_read_b64_tr_b16 v[50:51], v90 offset:16128
    s_add_u32 s101, s101, 4096
    buffer_load_dwordx4 a[96:99], v2, s[52:55], s101 offen offset:0 sc1
    buffer_load_dwordx4 a[100:103], v2, s[52:55], s101 offen offset:1024 sc1
    buffer_load_dwordx4 a[104:107], v2, s[52:55], s101 offen offset:2048 sc1
    buffer_load_dwordx4 a[108:111], v2, s[52:55], s101 offen offset:3072 sc1
    s_mov_b32 s81, 1
    s_waitcnt lgkmcnt(10)
    v_mfma_f32_16x16x32_bf16 v[96:99], v[20:23], v[16:19], 0
    ds_read_b128 v[52:55], v92 offset:144
    ds_read_b64_tr_b16 v[56:57], v88 offset:21504
    ds_read_b64_tr_b16 v[58:59], v88 offset:23296
    v_mfma_f32_16x16x32_bf16 v[204:207], v[24:27], v[16:19], 0
    ds_read_b64_tr_b16 v[60:61], v90 offset:21504
    ds_read_b64_tr_b16 v[62:63], v90 offset:23296
    s_waitcnt lgkmcnt(10)
    v_mfma_f32_16x16x32_bf16 v[96:99], v[32:35], v[28:31], v[96:99]
    ds_read_b128 v[16:19], v92 offset:256
    ds_read_b64_tr_b16 v[20:21], v88 offset:28672
    ds_read_b64_tr_b16 v[22:23], v88 offset:30464
    v_mfma_f32_16x16x32_bf16 v[204:207], v[36:39], v[28:31], v[204:207]
    ds_read_b64_tr_b16 v[24:25], v90 offset:28672
    ds_read_b64_tr_b16 v[26:27], v90 offset:30464
    s_waitcnt lgkmcnt(10)
    v_mfma_f32_16x16x32_bf16 v[96:99], v[44:47], v[40:43], v[96:99]
    ds_read_b128 v[28:31], v92 offset:272
    ds_read_b64_tr_b16 v[32:33], v88 offset:35840
    ds_read_b64_tr_b16 v[34:35], v88 offset:37632
    v_mfma_f32_16x16x32_bf16 v[204:207], v[48:51], v[40:43], v[204:207]
    ds_read_b64_tr_b16 v[36:37], v90 offset:35840
    ds_read_b64_tr_b16 v[38:39], v90 offset:37632
    s_waitcnt lgkmcnt(10)
    v_mfma_f32_16x16x32_bf16 v[96:99], v[56:59], v[52:55], v[96:99]
    ds_read_b128 v[40:43], v92 offset:384
    ds_read_b64_tr_b16 v[44:45], v88 offset:43008
    ds_read_b64_tr_b16 v[46:47], v88 offset:44800
    v_mfma_f32_16x16x32_bf16 v[204:207], v[60:63], v[52:55], v[204:207]
    ds_read_b64_tr_b16 v[48:49], v90 offset:43008
    ds_read_b64_tr_b16 v[50:51], v90 offset:44800
    s_waitcnt lgkmcnt(10)
    v_mfma_f32_16x16x32_bf16 v[96:99], v[20:23], v[16:19], v[96:99]
    ds_read_b128 v[52:55], v92 offset:400
    ds_read_b64_tr_b16 v[56:57], v88 offset:50176
    ds_read_b64_tr_b16 v[58:59], v88 offset:51968
    v_mfma_f32_16x16x32_bf16 v[204:207], v[24:27], v[16:19], v[204:207]
    ds_read_b64_tr_b16 v[60:61], v90 offset:50176
    ds_read_b64_tr_b16 v[62:63], v90 offset:51968
    s_waitcnt lgkmcnt(10)
    v_mfma_f32_16x16x32_bf16 v[96:99], v[32:35], v[28:31], v[96:99]
    ds_read_b128 v[16:19], v92 offset:512
    ds_read_b64_tr_b16 v[20:21], v89 offset:0
    ds_read_b64_tr_b16 v[22:23], v89 offset:1792
    v_mfma_f32_16x16x32_bf16 v[204:207], v[36:39], v[28:31], v[204:207]
    ds_read_b64_tr_b16 v[24:25], v91 offset:0
    ds_read_b64_tr_b16 v[26:27], v91 offset:1792
    s_waitcnt lgkmcnt(10)
    v_mfma_f32_16x16x32_bf16 v[96:99], v[44:47], v[40:43], v[96:99]
    ds_read_b128 v[28:31], v92 offset:528
    ds_read_b64_tr_b16 v[32:33], v89 offset:7168
    ds_read_b64_tr_b16 v[34:35], v89 offset:8960
    v_mfma_f32_16x16x32_bf16 v[204:207], v[48:51], v[40:43], v[204:207]
    ds_read_b64_tr_b16 v[36:37], v91 offset:7168
    ds_read_b64_tr_b16 v[38:39], v91 offset:8960
    s_waitcnt lgkmcnt(10)
    v_mfma_f32_16x16x32_bf16 v[96:99], v[56:59], v[52:55], v[96:99]
    ds_read_b128 v[40:43], v92 offset:640
    ds_read_b64_tr_b16 v[44:45], v89 offset:14336
    ds_read_b64_tr_b16 v[46:47], v89 offset:16128
    v_mfma_f32_16x16x32_bf16 v[204:207], v[60:63], v[52:55], v[204:207]
    ds_read_b64_tr_b16 v[48:49], v91 offset:14336
    ds_read_b64_tr_b16 v[50:51], v91 offset:16128
    s_waitcnt vmcnt(4)
    s_mov_b64 exec, 1
    buffer_store_dword v3, off, s[52:55], s14
    s_mov_b64 exec, -1
    s_add_u32 s101, s101, 4096
    buffer_load_dwordx4 a[112:115], v2, s[52:55], s101 offen offset:0 sc1
    buffer_load_dwordx4 a[116:119], v2, s[52:55], s101 offen offset:1024 sc1
    s_waitcnt lgkmcnt(10)
    v_mfma_f32_16x16x32_bf16 v[96:99], v[20:23], v[16:19], v[96:99]
    ds_read_b128 v[52:55], v92 offset:656
    ds_read_b64_tr_b16 v[56:57], v89 offset:21504
    ds_read_b64_tr_b16 v[58:59], v89 offset:23296
    v_mfma_f32_16x16x32_bf16 v[204:207], v[24:27], v[16:19], v[204:207]
    ds_read_b64_tr_b16 v[60:61], v91 offset:21504
    ds_read_b64_tr_b16 v[62:63], v91 offset:23296
    s_waitcnt lgkmcnt(10)
    v_mfma_f32_16x16x32_bf16 v[96:99], v[32:35], v[28:31], v[96:99]
    ds_read_b128 v[16:19], v92 offset:768
    ds_read_b64_tr_b16 v[20:21], v89 offset:28672
    ds_read_b64_tr_b16 v[22:23], v89 offset:30464
    v_mfma_f32_16x16x32_bf16 v[204:207], v[36:39], v[28:31], v[204:207]
    ds_read_b64_tr_b16 v[24:25], v91 offset:28672
    ds_read_b64_tr_b16 v[26:27], v91 offset:30464
    s_waitcnt lgkmcnt(10)
    v_mfma_f32_16x16x32_bf16 v[96:99], v[44:47], v[40:43], v[96:99]
    ds_read_b128 v[28:31], v92 offset:784
    ds_read_b64_tr_b16 v[32:33], v89 offset:35840
    ds_read_b64_tr_b16 v[34:35], v89 offset:37632
    v_mfma_f32_16x16x32_bf16 v[204:207], v[48:51], v[40:43], v[204:207]
    ds_read_b64_tr_b16 v[36:37], v91 offset:35840
    ds_read_b64_tr_b16 v[38:39], v91 offset:37632
    buffer_load_dword v15, v103, s[52:55], 0 offen offset:128 sc1
    buffer_load_dwordx4 a[120:123], v2, s[52:55], s101 offen offset:2048 sc1
    buffer_load_dwordx4 a[124:127], v2, s[52:55], s101 offen offset:3072 sc1
    s_add_u32 s101, s101, 4096
    buffer_load_dwordx4 a[128:131], v2, s[52:55], s101 offen offset:0 sc1
    buffer_load_dwordx4 a[132:135], v2, s[52:55], s101 offen offset:1024 sc1
    buffer_load_dwordx4 a[136:139], v2, s[52:55], s101 offen offset:2048 sc1
    buffer_load_dwordx4 a[140:143], v2, s[52:55], s101 offen offset:3072 sc1
    s_waitcnt lgkmcnt(10)
    v_mfma_f32_16x16x32_bf16 v[96:99], v[56:59], v[52:55], v[96:99]
    ds_read_b128 v[40:43], v92 offset:896
    ds_read_b64_tr_b16 v[44:45], v89 offset:43008
    ds_read_b64_tr_b16 v[46:47], v89 offset:44800
    v_mfma_f32_16x16x32_bf16 v[204:207], v[60:63], v[52:55], v[204:207]
    ds_read_b64_tr_b16 v[48:49], v91 offset:43008
    ds_read_b64_tr_b16 v[50:51], v91 offset:44800
    s_waitcnt lgkmcnt(10)
    v_mfma_f32_16x16x32_bf16 v[96:99], v[20:23], v[16:19], v[96:99]
    ds_read_b128 v[52:55], v92 offset:912
    ds_read_b64_tr_b16 v[56:57], v89 offset:50176
    ds_read_b64_tr_b16 v[58:59], v89 offset:51968
    v_mfma_f32_16x16x32_bf16 v[204:207], v[24:27], v[16:19], v[204:207]
    ds_read_b64_tr_b16 v[60:61], v91 offset:50176
    ds_read_b64_tr_b16 v[62:63], v91 offset:51968
    s_waitcnt lgkmcnt(10)
    v_mfma_f32_16x16x32_bf16 v[96:99], v[32:35], v[28:31], v[96:99]
    v_mfma_f32_16x16x32_bf16 v[204:207], v[36:39], v[28:31], v[204:207]
    s_waitcnt lgkmcnt(5)
    v_mfma_f32_16x16x32_bf16 v[96:99], v[44:47], v[40:43], v[96:99]
    ds_read_b64_tr_b16 v[72:73], v100 offset:0
    ds_read_b64_tr_b16 v[74:75], v100 offset:1792
    v_mfma_f32_16x16x32_bf16 v[204:207], v[48:51], v[40:43], v[204:207]
    ds_read_b64_tr_b16 v[76:77], v100 offset:32
    ds_read_b64_tr_b16 v[78:79], v100 offset:1824
    s_waitcnt lgkmcnt(4)
    v_mfma_f32_16x16x32_bf16 v[96:99], v[56:59], v[52:55], v[96:99]
    ds_read_b64_tr_b16 v[80:81], v100 offset:64
    ds_read_b64_tr_b16 v[82:83], v100 offset:1856
    v_mfma_f32_16x16x32_bf16 v[204:207], v[60:63], v[52:55], v[204:207]
    ds_read_b64_tr_b16 v[84:85], v100 offset:96
    ds_read_b64_tr_b16 v[86:87], v100 offset:1888
    s_waitcnt vmcnt(6)
    v_cmp_ne_u32 vcc, s68, v15
    s_nop 0
    s_and_b64 vcc, vcc, s[84:85]
    s_cbranch_scc1 L_ylate_27
    buffer_load_dwordx4 v[112:115], v2, s[52:55], s28 offen offset:0 sc1
    buffer_load_dwordx4 v[116:119], v2, s[52:55], s29 offen offset:0 sc1
    buffer_load_dwordx4 v[120:123], v2, s[52:55], s28 offen offset:1024 sc1
    buffer_load_dwordx4 v[124:127], v2, s[52:55], s29 offen offset:1024 sc1
    buffer_load_dwordx4 v[128:131], v2, s[52:55], s28 offen offset:2048 sc1
    buffer_load_dwordx4 v[132:135], v2, s[52:55], s29 offen offset:2048 sc1
    buffer_load_dwordx4 v[136:139], v2, s[52:55], s28 offen offset:3072 sc1
    buffer_load_dwordx4 v[140:143], v2, s[52:55], s29 offen offset:3072 sc1
    s_mov_b32 s81, 0
L_ylate_27:
    ds_write_b128 v93, v[96:99]
    ds_write_b128 v94, v[204:207]
    ds_read_b64_tr_b16 v[88:89], v100 offset:192
    ds_read_b64_tr_b16 v[90:91], v100 offset:1984
    s_cmp_eq_u32 s81, 0
    s_waitcnt lgkmcnt(2)
    s_barrier
    s_cbranch_scc1 L_yok_28
    s_mov_b32 s82, 0
L_py_29:
    buffer_load_dword v15, v103, s[52:55], 0 offen offset:128 sc1
    s_add_u32 s82, s82, 1
    s_waitcnt vmcnt(0)
    v_cmp_ne_u32 vcc, s68, v15
    s_nop 0
    s_and_b64 vcc, vcc, s[84:85]
    s_cbranch_scc0 L_dy_30
    s_cmp_lt_u32 s82, 131072
    s_cbranch_scc1 L_py_29
L_dy_30:
    buffer_load_dwordx4 v[112:115], v2, s[52:55], s28 offen offset:0 sc1
    buffer_load_dwordx4 v[116:119], v2, s[52:55], s29 offen offset:0 sc1
    buffer_load_dwordx4 v[120:123], v2, s[52:55], s28 offen offset:1024 sc1
    buffer_load_dwordx4 v[124:127], v2, s[52:55], s29 offen offset:1024 sc1
    buffer_load_dwordx4 v[128:131], v2, s[52:55], s28 offen offset:2048 sc1
    buffer_load_dwordx4 v[132:135], v2, s[52:55], s29 offen offset:2048 sc1
    buffer_load_dwordx4 v[136:139], v2, s[52:55], s28 offen offset:3072 sc1
    buffer_load_dwordx4 v[140:143], v2, s[52:55], s29 offen offset:3072 sc1
L_yok_28:
    s_add_u32 s28, s28, 4096
    buffer_load_dwordx4 v[144:147], v2, s[52:55], s28 offen offset:0 sc1
    s_add_u32 s29, s29, 4096
    buffer_load_dwordx4 v[148:151], v2, s[52:55], s29 offen offset:0 sc1
    s_waitcnt vmcnt(8)
    v_mfma_f32_16x16x32_bf16 v[16:19], v[72:75], v[112:115], 0
    ds_read_b64_tr_b16 v[92:93], v100 offset:7168
    v_mfma_f32_16x16x32_bf16 v[20:23], v[72:75], v[116:119], 0
    ds_read_b64_tr_b16 v[94:95], v100 offset:8960
    v_mfma_f32_16x16x32_bf16 v[28:31], v[76:79], v[116:119], 0
    ds_read_b64_tr_b16 v[72:73], v100 offset:7200
    buffer_load_dwordx4 v[152:155], v2, s[52:55], s28 offen offset:1024 sc1
    v_mfma_f32_16x16x32_bf16 v[24:27], v[76:79], v[112:115], 0
    ds_read_b64_tr_b16 v[74:75], v100 offset:8992
    v_mfma_f32_16x16x32_bf16 v[32:35], v[80:83], v[112:115], 0
    ds_read_b64_tr_b16 v[76:77], v100 offset:7232
    v_mfma_f32_16x16x32_bf16 v[36:39], v[80:83], v[116:119], 0
    ds_read_b64_tr_b16 v[78:79], v100 offset:9024
    v_mfma_f32_16x16x32_bf16 v[44:47], v[84:87], v[116:119], 0
    ds_read_b64_tr_b16 v[80:81], v100 offset:7264
    buffer_load_dwordx4 v[156:159], v2, s[52:55], s29 offen offset:1024 sc1
    v_mfma_f32_16x16x32_bf16 v[40:43], v[84:87], v[112:115], 0
    ds_read_b64_tr_b16 v[82:83], v100 offset:9056
    s_waitcnt lgkmcnt(8)
    v_mfma_f32_16x16x32_bf16 v[64:67], v[88:91], v[112:115], 0
    ds_read_b64_tr_b16 v[84:85], v100 offset:7360
    buffer_load_dwordx4 v[160:163], v2, s[52:55], s28 offen offset:2048 sc1
    v_mfma_f32_16x16x32_bf16 v[68:71], v[88:91], v[116:119], 0
    ds_read_b64_tr_b16 v[86:87], v100 offset:9152
    s_waitcnt vmcnt(9) lgkmcnt(6)
    v_mfma_f32_16x16x32_bf16 v[16:19], v[92:95], v[120:123], v[16:19]
    ds_read_b64_tr_b16 v[88:89], v100 offset:14336
    v_mfma_f32_16x16x32_bf16 v[20:23], v[92:95], v[124:127], v[20:23]
    ds_read_b64_tr_b16 v[90:91], v100 offset:16128
    v_mfma_f32_16x16x32_bf16 v[28:31], v[72:75], v[124:127], v[28:31]
    ds_read_b64_tr_b16 v[92:93], v100 offset:14368
    buffer_load_dwordx4 v[164:167], v2, s[52:55], s29 offen offset:2048 sc1
    v_mfma_f32_16x16x32_bf16 v[24:27], v[72:75], v[120:123], v[24:27]
    ds_read_b64_tr_b16 v[94:95], v100 offset:16160
    s_waitcnt lgkmcnt(6)
    v_mfma_f32_16x16x32_bf16 v[32:35], v[76:79], v[120:123], v[32:35]
    ds_read_b64_tr_b16 v[72:73], v100 offset:14400
    v_mfma_f32_16x16x32_bf16 v[36:39], v[76:79], v[124:127], v[36:39]
    ds_read_b64_tr_b16 v[74:75], v100 offset:16192
    v_mfma_f32_16x16x32_bf16 v[44:47], v[80:83], v[124:127], v[44:47]
    ds_read_b64_tr_b16 v[76:77], v100 offset:14432
    buffer_load_dwordx4 v[168:171], v2, s[52:55], s28 offen offset:3072 sc1
    v_mfma_f32_16x16x32_bf16 v[40:43], v[80:83], v[120:123], v[40:43]
    ds_read_b64_tr_b16 v[78:79], v100 offset:16224
    s_waitcnt lgkmcnt(8)
    v_mfma_f32_16x16x32_bf16 v[64:67], v[84:87], v[120:123], v[64:67]
    ds_read_b64_tr_b16 v[80:81], v100 offset:14528
    buffer_load_dwordx4 v[172:175], v2, s[52:55], s29 offen offset:3072 sc1
    v_mfma_f32_16x16x32_bf16 v[68:71], v[84:87], v[124:127], v[68:71]
    ds_read_b64_tr_b16 v[82:83], v100 offset:16320
    s_waitcnt vmcnt(10) lgkmcnt(6)
    v_mfma_f32_16x16x32_bf16 v[16:19], v[88:91], v[128:131], v[16:19]
    ds_read_b64_tr_b16 v[84:85], v100 offset:21504
    v_mfma_f32_16x16x32_bf16 v[20:23], v[88:91], v[132:135], v[20:23]
    ds_read_b64_tr_b16 v[86:87], v100 offset:23296
    v_mfma_f32_16x16x32_bf16 v[28:31], v[92:95], v[132:135], v[28:31]
    s_add_u32 s28, s28, 4096
    ds_read_b64_tr_b16 v[88:89], v100 offset:21536
    buffer_load_dwordx4 v[176:179], v2, s[52:55], s28 offen offset:0 sc1
    v_mfma_f32_16x16x32_bf16 v[24:27], v[92:95], v[128:131], v[24:27]
    ds_read_b64_tr_b16 v[90:91], v100 offset:23328
    s_waitcnt lgkmcnt(6)
    v_mfma_f32_16x16x32_bf16 v[32:35], v[72:75], v[128:131], v[32:35]
    ds_read_b64_tr_b16 v[92:93], v100 offset:21568
    v_mfma_f32_16x16x32_bf16 v[36:39], v[72:75], v[132:135], v[36:39]
    ds_read_b64_tr_b16 v[94:95], v100 offset:23360
    v_mfma_f32_16x16x32_bf16 v[44:47], v[76:79], v[132:135], v[44:47]
    s_add_u32 s29, s29, 4096
    ds_read_b64_tr_b16 v[72:73], v100 offset:21600
    buffer_load_dwordx4 v[180:183], v2, s[52:55], s29 offen offset:0 sc1
    v_mfma_f32_16x16x32_bf16 v[40:43], v[76:79], v[128:131], v[40:43]
    ds_read_b64_tr_b16 v[74:75], v100 offset:23392
    s_waitcnt lgkmcnt(8)
    v_mfma_f32_16x16x32_bf16 v[64:67], v[80:83], v[128:131], v[64:67]
    ds_read_b64_tr_b16 v[76:77], v100 offset:21696
    buffer_load_dword v48, v106, s[52:55], s30 offen offset:0 sc1
    v_mfma_f32_16x16x32_bf16 v[68:71], v[80:83], v[132:135], v[68:71]
    ds_read_b64_tr_b16 v[78:79], v100 offset:23488
    s_waitcnt vmcnt(11) lgkmcnt(6)
    v_mfma_f32_16x16x32_bf16 v[16:19], v[84:87], v[136:139], v[16:19]
    ds_read_b64_tr_b16 v[80:81], v100 offset:28672
    v_mfma_f32_16x16x32_bf16 v[20:23], v[84:87], v[140:143], v[20:23]
    ds_read_b64_tr_b16 v[82:83], v100 offset:30464
    v_mfma_f32_16x16x32_bf16 v[28:31], v[88:91], v[140:143], v[28:31]
    ds_read_b64_tr_b16 v[84:85], v100 offset:28704
    buffer_load_dword v49, v106, s[52:55], s30 offen offset:128 sc1
    v_mfma_f32_16x16x32_bf16 v[24:27], v[88:91], v[136:139], v[24:27]
    ds_read_b64_tr_b16 v[86:87], v100 offset:30496
    s_waitcnt lgkmcnt(6)
    v_mfma_f32_16x16x32_bf16 v[32:35], v[92:95], v[136:139], v[32:35]
    ds_read_b64_tr_b16 v[88:89], v100 offset:28736
    buffer_load_dword v50, v106, s[52:55], s30 offen offset:256 sc1
    v_mfma_f32_16x16x32_bf16 v[36:39], v[92:95], v[140:143], v[36:39]
    ds_read_b64_tr_b16 v[90:91], v100 offset:30528
    v_mfma_f32_16x16x32_bf16 v[44:47], v[72:75], v[140:143], v[44:47]
    ds_read_b64_tr_b16 v[92:93], v100 offset:28768
    buffer_load_dword v51, v106, s[52:55], s30 offen offset:384 sc1
    v_mfma_f32_16x16x32_bf16 v[40:43], v[72:75], v[136:139], v[40:43]
    ds_read_b64_tr_b16 v[94:95], v100 offset:30560
    s_waitcnt lgkmcnt(8)
    v_mfma_f32_16x16x32_bf16 v[64:67], v[76:79], v[136:139], v[64:67]
    ds_read_b64_tr_b16 v[72:73], v100 offset:28864
    buffer_load_dword v52, v106, s[52:55], s30 offen offset:512 sc1
    v_mfma_f32_16x16x32_bf16 v[68:71], v[76:79], v[140:143], v[68:71]
    ds_read_b64_tr_b16 v[74:75], v100 offset:30656
    s_waitcnt vmcnt(13) lgkmcnt(6)
    v_mfma_f32_16x16x32_bf16 v[16:19], v[80:83], v[144:147], v[16:19]
    ds_read_b64_tr_b16 v[76:77], v100 offset:35840
    v_mfma_f32_16x16x32_bf16 v[20:23], v[80:83], v[148:151], v[20:23]
    ds_read_b64_tr_b16 v[78:79], v100 offset:37632
    v_mfma_f32_16x16x32_bf16 v[28:31], v[84:87], v[148:151], v[28:31]
    ds_read_b64_tr_b16 v[80:81], v100 offset:35872
    buffer_load_dword v53, v106, s[52:55], s30 offen offset:640 sc1
    v_mfma_f32_16x16x32_bf16 v[24:27], v[84:87], v[144:147], v[24:27]
    ds_read_b64_tr_b16 v[82:83], v100 offset:37664
    s_waitcnt lgkmcnt(6)
    v_mfma_f32_16x16x32_bf16 v[32:35], v[88:91], v[144:147], v[32:35]
    ds_read_b64_tr_b16 v[84:85], v100 offset:35904
    buffer_load_dword v54, v106, s[52:55], s30 offen offset:768 sc1
    v_mfma_f32_16x16x32_bf16 v[36:39], v[88:91], v[148:151], v[36:39]
    ds_read_b64_tr_b16 v[86:87], v100 offset:37696
    v_mfma_f32_16x16x32_bf16 v[44:47], v[92:95], v[148:151], v[44:47]
    ds_read_b64_tr_b16 v[88:89], v100 offset:35936
    buffer_load_dword v55, v106, s[52:55], s30 offen offset:896 sc1
    v_mfma_f32_16x16x32_bf16 v[40:43], v[92:95], v[144:147], v[40:43]
    ds_read_b64_tr_b16 v[90:91], v100 offset:37728
    s_waitcnt lgkmcnt(8)
    v_mfma_f32_16x16x32_bf16 v[64:67], v[72:75], v[144:147], v[64:67]
    ds_read_b64_tr_b16 v[92:93], v100 offset:36032
    buffer_load_dwordx4 v[184:187], v2, s[52:55], s28 offen offset:1024 sc1
    v_mfma_f32_16x16x32_bf16 v[68:71], v[72:75], v[148:151], v[68:71]
    ds_read_b64_tr_b16 v[94:95], v100 offset:37824
    s_waitcnt vmcnt(15) lgkmcnt(6)
    v_mfma_f32_16x16x32_bf16 v[16:19], v[76:79], v[152:155], v[16:19]
    ds_read_b64_tr_b16 v[72:73], v100 offset:43008
    v_mfma_f32_16x16x32_bf16 v[20:23], v[76:79], v[156:159], v[20:23]
    ds_read_b64_tr_b16 v[74:75], v100 offset:44800
    v_mfma_f32_16x16x32_bf16 v[28:31], v[80:83], v[156:159], v[28:31]
    ds_read_b64_tr_b16 v[76:77], v100 offset:43040
    buffer_load_dwordx4 v[188:191], v2, s[52:55], s29 offen offset:1024 sc1
    v_mfma_f32_16x16x32_bf16 v[24:27], v[80:83], v[152:155], v[24:27]
    ds_read_b64_tr_b16 v[78:79], v100 offset:44832
    s_waitcnt lgkmcnt(6)
    v_mfma_f32_16x16x32_bf16 v[32:35], v[84:87], v[152:155], v[32:35]
    ds_read_b64_tr_b16 v[80:81], v100 offset:43072
    buffer_load_dwordx4 v[192:195], v2, s[52:55], s28 offen offset:2048 sc1
    v_mfma_f32_16x16x32_bf16 v[36:39], v[84:87], v[156:159], v[36:39]
    ds_read_b64_tr_b16 v[82:83], v100 offset:44864
    v_mfma_f32_16x16x32_bf16 v[44:47], v[88:91], v[156:159], v[44:47]
    ds_read_b64_tr_b16 v[84:85], v100 offset:43104
    buffer_load_dwordx4 v[196:199], v2, s[52:55], s29 offen offset:2048 sc1
    v_mfma_f32_16x16x32_bf16 v[40:43], v[88:91], v[152:155], v[40:43]
    ds_read_b64_tr_b16 v[86:87], v100 offset:44896
    s_waitcnt lgkmcnt(8)
    v_mfma_f32_16x16x32_bf16 v[64:67], v[92:95], v[152:155], v[64:67]
    ds_read_b64_tr_b16 v[88:89], v100 offset:43200
    buffer_load_dwordx4 v[200:203], v2, s[52:55], s28 offen offset:3072 sc1
    v_mfma_f32_16x16x32_bf16 v[68:71], v[92:95], v[156:159], v[68:71]
    ds_read_b64_tr_b16 v[90:91], v100 offset:44992
    s_waitcnt vmcnt(17) lgkmcnt(6)
    v_mfma_f32_16x16x32_bf16 v[16:19], v[72:75], v[160:163], v[16:19]
    ds_read_b64_tr_b16 v[92:93], v100 offset:50176
    v_mfma_f32_16x16x32_bf16 v[20:23], v[72:75], v[164:167], v[20:23]
    ds_read_b64_tr_b16 v[94:95], v100 offset:51968
    v_mfma_f32_16x16x32_bf16 v[28:31], v[76:79], v[164:167], v[28:31]
    ds_read_b64_tr_b16 v[72:73], v100 offset:50208
    buffer_load_dwordx4 v[204:207], v2, s[52:55], s29 offen offset:3072 sc1
    v_mfma_f32_16x16x32_bf16 v[24:27], v[76:79], v[160:163], v[24:27]
    ds_read_b64_tr_b16 v[74:75], v100 offset:52000
    s_waitcnt lgkmcnt(6)
    v_mfma_f32_16x16x32_bf16 v[32:35], v[80:83], v[160:163], v[32:35]
    ds_read_b64_tr_b16 v[76:77], v100 offset:50240
    v_mfma_f32_16x16x32_bf16 v[36:39], v[80:83], v[164:167], v[36:39]
    ds_read_b64_tr_b16 v[78:79], v100 offset:52032
    v_mfma_f32_16x16x32_bf16 v[44:47], v[84:87], v[164:167], v[44:47]
    s_add_u32 s28, s28, 4096
    ds_read_b64_tr_b16 v[80:81], v100 offset:50272
    buffer_load_dwordx4 v[208:211], v2, s[52:55], s28 offen offset:0 sc1
    v_mfma_f32_16x16x32_bf16 v[40:43], v[84:87], v[160:163], v[40:43]
    ds_read_b64_tr_b16 v[82:83], v100 offset:52064
    s_waitcnt lgkmcnt(8)
    v_mfma_f32_16x16x32_bf16 v[64:67], v[88:91], v[160:163], v[64:67]
    s_add_u32 s29, s29, 4096
    ds_read_b64_tr_b16 v[84:85], v100 offset:50368
    buffer_load_dwordx4 v[212:215], v2, s[52:55], s29 offen offset:0 sc1
    v_mfma_f32_16x16x32_bf16 v[68:71], v[88:91], v[164:167], v[68:71]
    ds_read_b64_tr_b16 v[86:87], v100 offset:52160
    s_waitcnt vmcnt(18) lgkmcnt(6)
    v_mfma_f32_16x16x32_bf16 v[16:19], v[92:95], v[168:171], v[16:19]
    ds_read_b64_tr_b16 v[88:89], v101 offset:0
    v_mfma_f32_16x16x32_bf16 v[20:23], v[92:95], v[172:175], v[20:23]
    ds_read_b64_tr_b16 v[90:91], v101 offset:1792
    v_mfma_f32_16x16x32_bf16 v[28:31], v[72:75], v[172:175], v[28:31]
    ds_read_b64_tr_b16 v[92:93], v101 offset:32
    buffer_load_dwordx4 v[216:219], v2, s[52:55], s28 offen offset:1024 sc1
    v_mfma_f32_16x16x32_bf16 v[24:27], v[72:75], v[168:171], v[24:27]
    ds_read_b64_tr_b16 v[94:95], v101 offset:1824
    s_waitcnt lgkmcnt(6)
    v_mfma_f32_16x16x32_bf16 v[32:35], v[76:79], v[168:171], v[32:35]
    ds_read_b64_tr_b16 v[72:73], v101 offset:64
    v_mfma_f32_16x16x32_bf16 v[36:39], v[76:79], v[172:175], v[36:39]
    ds_read_b64_tr_b16 v[74:75], v101 offset:1856
    v_mfma_f32_16x16x32_bf16 v[44:47], v[80:83], v[172:175], v[44:47]
    ds_read_b64_tr_b16 v[76:77], v101 offset:96
    buffer_load_dwordx4 v[220:223], v2, s[52:55], s29 offen offset:1024 sc1
    v_mfma_f32_16x16x32_bf16 v[40:43], v[80:83], v[168:171], v[40:43]
    ds_read_b64_tr_b16 v[78:79], v101 offset:1888
    s_waitcnt lgkmcnt(8)
    v_mfma_f32_16x16x32_bf16 v[64:67], v[84:87], v[168:171], v[64:67]
    ds_read_b64_tr_b16 v[80:81], v101 offset:192
    buffer_load_dwordx4 v[224:227], v2, s[52:55], s28 offen offset:2048 sc1
    v_mfma_f32_16x16x32_bf16 v[68:71], v[84:87], v[172:175], v[68:71]
    ds_read_b64_tr_b16 v[82:83], v101 offset:1984
    s_waitcnt vmcnt(19) lgkmcnt(6)
    v_mfma_f32_16x16x32_bf16 v[16:19], v[88:91], v[176:179], v[16:19]
    ds_read_b64_tr_b16 v[84:85], v101 offset:7168
    v_mfma_f32_16x16x32_bf16 v[20:23], v[88:91], v[180:183], v[20:23]
    ds_read_b64_tr_b16 v[86:87], v101 offset:8960
    v_mfma_f32_16x16x32_bf16 v[28:31], v[92:95], v[180:183], v[28:31]
    ds_read_b64_tr_b16 v[88:89], v101 offset:7200
    buffer_load_dwordx4 v[228:231], v2, s[52:55], s29 offen offset:2048 sc1
    v_mfma_f32_16x16x32_bf16 v[24:27], v[92:95], v[176:179], v[24:27]
    ds_read_b64_tr_b16 v[90:91], v101 offset:8992
    s_waitcnt lgkmcnt(6)
    v_mfma_f32_16x16x32_bf16 v[32:35], v[72:75], v[176:179], v[32:35]
    ds_read_b64_tr_b16 v[92:93], v101 offset:7232
    v_mfma_f32_16x16x32_bf16 v[36:39], v[72:75], v[180:183], v[36:39]
    ds_read_b64_tr_b16 v[94:95], v101 offset:9024
    v_mfma_f32_16x16x32_bf16 v[44:47], v[76:79], v[180:183], v[44:47]
    ds_read_b64_tr_b16 v[72:73], v101 offset:7264
    buffer_load_dwordx4 v[232:235], v2, s[52:55], s28 offen offset:3072 sc1
    v_mfma_f32_16x16x32_bf16 v[40:43], v[76:79], v[176:179], v[40:43]
    ds_read_b64_tr_b16 v[74:75], v101 offset:9056
    s_waitcnt lgkmcnt(8)
    v_mfma_f32_16x16x32_bf16 v[64:67], v[80:83], v[176:179], v[64:67]
    ds_read_b64_tr_b16 v[76:77], v101 offset:7360
    buffer_load_dwordx4 v[236:239], v2, s[52:55], s29 offen offset:3072 sc1
    v_mfma_f32_16x16x32_bf16 v[68:71], v[80:83], v[180:183], v[68:71]
    ds_read_b64_tr_b16 v[78:79], v101 offset:9152
    s_waitcnt vmcnt(12) lgkmcnt(6)
    v_mfma_f32_16x16x32_bf16 v[16:19], v[84:87], v[184:187], v[16:19]
    ds_read_b64_tr_b16 v[80:81], v101 offset:14336
    v_mfma_f32_16x16x32_bf16 v[20:23], v[84:87], v[188:191], v[20:23]
    ds_read_b64_tr_b16 v[82:83], v101 offset:16128
    v_mfma_f32_16x16x32_bf16 v[28:31], v[88:91], v[188:191], v[28:31]
    s_add_u32 s101, s101, 4096
    ds_read_b64_tr_b16 v[84:85], v101 offset:14368
    buffer_load_dwordx4 a[144:147], v2, s[52:55], s101 offen offset:0 sc1
    v_mfma_f32_16x16x32_bf16 v[24:27], v[88:91], v[184:187], v[24:27]
    ds_read_b64_tr_b16 v[86:87], v101 offset:16160
    s_waitcnt lgkmcnt(6)
    v_mfma_f32_16x16x32_bf16 v[32:35], v[92:95], v[184:187], v[32:35]
    ds_read_b64_tr_b16 v[88:89], v101 offset:14400
    v_mfma_f32_16x16x32_bf16 v[36:39], v[92:95], v[188:191], v[36:39]
    ds_read_b64_tr_b16 v[90:91], v101 offset:16192
    v_mfma_f32_16x16x32_bf16 v[44:47], v[72:75], v[188:191], v[44:47]
    ds_read_b64_tr_b16 v[92:93], v101 offset:14432
    buffer_load_dwordx4 a[148:151], v2, s[52:55], s101 offen offset:1024 sc1
    v_mfma_f32_16x16x32_bf16 v[40:43], v[72:75], v[184:187], v[40:43]
    ds_read_b64_tr_b16 v[94:95], v101 offset:16224
    s_waitcnt lgkmcnt(8)
    v_mfma_f32_16x16x32_bf16 v[64:67], v[76:79], v[184:187], v[64:67]
    ds_read_b64_tr_b16 v[72:73], v101 offset:14528
    buffer_load_dwordx4 a[152:155], v2, s[52:55], s101 offen offset:2048 sc1
    v_mfma_f32_16x16x32_bf16 v[68:71], v[76:79], v[188:191], v[68:71]
    ds_read_b64_tr_b16 v[74:75], v101 offset:16320
    s_waitcnt vmcnt(13) lgkmcnt(6)
    v_mfma_f32_16x16x32_bf16 v[16:19], v[80:83], v[192:195], v[16:19]
    ds_read_b64_tr_b16 v[76:77], v101 offset:21504
    v_mfma_f32_16x16x32_bf16 v[20:23], v[80:83], v[196:199], v[20:23]
    ds_read_b64_tr_b16 v[78:79], v101 offset:23296
    v_mfma_f32_16x16x32_bf16 v[28:31], v[84:87], v[196:199], v[28:31]
    ds_read_b64_tr_b16 v[80:81], v101 offset:21536
    buffer_load_dwordx4 a[156:159], v2, s[52:55], s101 offen offset:3072 sc1
    v_mfma_f32_16x16x32_bf16 v[24:27], v[84:87], v[192:195], v[24:27]
    ds_read_b64_tr_b16 v[82:83], v101 offset:23328
    s_waitcnt lgkmcnt(6)
    v_mfma_f32_16x16x32_bf16 v[32:35], v[88:91], v[192:195], v[32:35]
    ds_read_b64_tr_b16 v[84:85], v101 offset:21568
    v_mfma_f32_16x16x32_bf16 v[36:39], v[88:91], v[196:199], v[36:39]
    ds_read_b64_tr_b16 v[86:87], v101 offset:23360
    v_mfma_f32_16x16x32_bf16 v[44:47], v[92:95], v[196:199], v[44:47]
    s_add_u32 s101, s101, 4096
    ds_read_b64_tr_b16 v[88:89], v101 offset:21600
    buffer_load_dwordx4 a[160:163], v2, s[52:55], s101 offen offset:0 sc1
    v_mfma_f32_16x16x32_bf16 v[40:43], v[92:95], v[192:195], v[40:43]
    ds_read_b64_tr_b16 v[90:91], v101 offset:23392
    s_waitcnt lgkmcnt(8)
    v_mfma_f32_16x16x32_bf16 v[64:67], v[72:75], v[192:195], v[64:67]
    ds_read_b64_tr_b16 v[92:93], v101 offset:21696
    buffer_load_dwordx4 a[164:167], v2, s[52:55], s101 offen offset:1024 sc1
    v_mfma_f32_16x16x32_bf16 v[68:71], v[72:75], v[196:199], v[68:71]
    ds_read_b64_tr_b16 v[94:95], v101 offset:23488
    s_waitcnt vmcnt(14) lgkmcnt(6)
    v_mfma_f32_16x16x32_bf16 v[16:19], v[76:79], v[200:203], v[16:19]
    ds_read_b64_tr_b16 v[72:73], v101 offset:28672
    v_add_f32 v48, v48, v52
    v_mfma_f32_16x16x32_bf16 v[20:23], v[76:79], v[204:207], v[20:23]
    ds_read_b64_tr_b16 v[74:75], v101 offset:30464
    v_add_f32 v49, v49, v53
    v_mfma_f32_16x16x32_bf16 v[28:31], v[80:83], v[204:207], v[28:31]
    ds_read_b64_tr_b16 v[76:77], v101 offset:28704
    v_add_f32 v50, v50, v54
    v_mfma_f32_16x16x32_bf16 v[24:27], v[80:83], v[200:203], v[24:27]
    ds_read_b64_tr_b16 v[78:79], v101 offset:30496
    s_waitcnt lgkmcnt(6)
    v_mfma_f32_16x16x32_bf16 v[32:35], v[84:87], v[200:203], v[32:35]
    ds_read_b64_tr_b16 v[80:81], v101 offset:28736
    buffer_load_dwordx4 a[168:171], v2, s[52:55], s101 offen offset:2048 sc1
    v_mfma_f32_16x16x32_bf16 v[36:39], v[84:87], v[204:207], v[36:39]
    ds_read_b64_tr_b16 v[82:83], v101 offset:30528
    v_add_f32 v51, v51, v55
    v_mfma_f32_16x16x32_bf16 v[44:47], v[88:91], v[204:207], v[44:47]
    ds_read_b64_tr_b16 v[84:85], v101 offset:28768
    v_add_f32 v48, v48, v50
    v_mfma_f32_16x16x32_bf16 v[40:43], v[88:91], v[200:203], v[40:43]
    ds_read_b64_tr_b16 v[86:87], v101 offset:30560
    s_waitcnt lgkmcnt(8)
    v_mfma_f32_16x16x32_bf16 v[64:67], v[92:95], v[200:203], v[64:67]
    ds_read_b64_tr_b16 v[88:89], v101 offset:28864
    buffer_load_dwordx4 a[172:175], v2, s[52:55], s101 offen offset:3072 sc1
    v_mfma_f32_16x16x32_bf16 v[68:71], v[92:95], v[204:207], v[68:71]
    ds_read_b64_tr_b16 v[90:91], v101 offset:30656
    s_waitcnt vmcnt(14) lgkmcnt(6)
    v_mfma_f32_16x16x32_bf16 v[16:19], v[72:75], v[208:211], v[16:19]
    ds_read_b64_tr_b16 v[92:93], v101 offset:35840
    v_add_f32 v49, v49, v51
    v_mfma_f32_16x16x32_bf16 v[20:23], v[72:75], v[212:215], v[20:23]
    ds_read_b64_tr_b16 v[94:95], v101 offset:37632
    v_add_f32 v48, v48, v49
    v_mfma_f32_16x16x32_bf16 v[28:31], v[76:79], v[212:215], v[28:31]
    ds_read_b64_tr_b16 v[72:73], v101 offset:35872
    v_mul_f32 v48, 0x3b000000, v48
    v_mfma_f32_16x16x32_bf16 v[24:27], v[76:79], v[208:211], v[24:27]
    ds_read_b64_tr_b16 v[74:75], v101 offset:37664
    s_waitcnt lgkmcnt(6)
    v_mfma_f32_16x16x32_bf16 v[32:35], v[80:83], v[208:211], v[32:35]
    s_add_u32 s101, s101, 4096
    ds_read_b64_tr_b16 v[76:77], v101 offset:35904
    buffer_load_dwordx4 a[176:179], v2, s[52:55], s101 offen offset:0 sc1
    v_mfma_f32_16x16x32_bf16 v[36:39], v[80:83], v[212:215], v[36:39]
    ds_read_b64_tr_b16 v[78:79], v101 offset:37696
    v_mov_b32 v49, v48
    v_mfma_f32_16x16x32_bf16 v[44:47], v[84:87], v[212:215], v[44:47]
    ds_read_b64_tr_b16 v[80:81], v101 offset:35936
    v_permlane32_swap_b32 v48, v49
    v_mfma_f32_16x16x32_bf16 v[40:43], v[84:87], v[208:211], v[40:43]
    ds_read_b64_tr_b16 v[82:83], v101 offset:37728
    s_waitcnt lgkmcnt(8)
    v_mfma_f32_16x16x32_bf16 v[64:67], v[88:91], v[208:211], v[64:67]
    ds_read_b64_tr_b16 v[84:85], v101 offset:36032
    buffer_load_dwordx4 a[180:183], v2, s[52:55], s101 offen offset:1024 sc1
    v_mfma_f32_16x16x32_bf16 v[68:71], v[88:91], v[212:215], v[68:71]
    ds_read_b64_tr_b16 v[86:87], v101 offset:37824
    s_waitcnt vmcnt(14) lgkmcnt(6)
    v_mfma_f32_16x16x32_bf16 v[16:19], v[92:95], v[216:219], v[16:19]
    ds_read_b64_tr_b16 v[88:89], v101 offset:43008
    v_fma_f32 v49, -v48, v48, v49
    v_mfma_f32_16x16x32_bf16 v[20:23], v[92:95], v[220:223], v[20:23]
    ds_read_b64_tr_b16 v[90:91], v101 offset:44800
    v_max_f32 v49, 0, v49
    v_mfma_f32_16x16x32_bf16 v[28:31], v[72:75], v[220:223], v[28:31]
    ds_read_b64_tr_b16 v[92:93], v101 offset:43040
    v_add_f32 v49, 0x3727c5ac, v49
    v_mfma_f32_16x16x32_bf16 v[24:27], v[72:75], v[216:219], v[24:27]
    ds_read_b64_tr_b16 v[94:95], v101 offset:44832
    s_waitcnt lgkmcnt(6)
    v_mfma_f32_16x16x32_bf16 v[32:35], v[76:79], v[216:219], v[32:35]
    ds_read_b64_tr_b16 v[72:73], v101 offset:43072
    buffer_load_dwordx4 a[184:187], v2, s[52:55], s101 offen offset:2048 sc1
    v_mfma_f32_16x16x32_bf16 v[36:39], v[76:79], v[220:223], v[36:39]
    ds_read_b64_tr_b16 v[74:75], v101 offset:44864
    v_rsq_f32 v10, v49
    v_mfma_f32_16x16x32_bf16 v[44:47], v[80:83], v[220:223], v[44:47]
    ds_read_b64_tr_b16 v[76:77], v101 offset:43104
    v_mul_f32 v11, -v48, v10
    v_mfma_f32_16x16x32_bf16 v[40:43], v[80:83], v[216:219], v[40:43]
    ds_read_b64_tr_b16 v[78:79], v101 offset:44896
    s_waitcnt lgkmcnt(8)
    v_mfma_f32_16x16x32_bf16 v[64:67], v[84:87], v[216:219], v[64:67]
    ds_read_b64_tr_b16 v[80:81], v101 offset:43200
    buffer_load_dwordx4 a[188:191], v2, s[52:55], s101 offen offset:3072 sc1
    v_mfma_f32_16x16x32_bf16 v[68:71], v[84:87], v[220:223], v[68:71]
    ds_read_b64_tr_b16 v[82:83], v101 offset:44992
    s_waitcnt vmcnt(14) lgkmcnt(6)
    v_mfma_f32_16x16x32_bf16 v[16:19], v[88:91], v[224:227], v[16:19]
    ds_read_b64_tr_b16 v[84:85], v101 offset:50176
    v_mov_b32 v12, v10
    v_mfma_f32_16x16x32_bf16 v[20:23], v[88:91], v[228:231], v[20:23]
    ds_read_b64_tr_b16 v[86:87], v101 offset:51968
    v_mov_b32 v13, v11
    v_mfma_f32_16x16x32_bf16 v[28:31], v[92:95], v[228:231], v[28:31]
    ds_read_b64_tr_b16 v[88:89], v101 offset:50208
    v_permlane16_swap_b32 v10, v12
    v_mfma_f32_16x16x32_bf16 v[24:27], v[92:95], v[224:227], v[24:27]
    ds_read_b64_tr_b16 v[90:91], v101 offset:52000
    s_waitcnt lgkmcnt(6)
    v_mfma_f32_16x16x32_bf16 v[32:35], v[72:75], v[224:227], v[32:35]
    s_add_u32 s101, s101, 4096
    ds_read_b64_tr_b16 v[92:93], v101 offset:50240
    buffer_load_dwordx4 a[192:195], v2, s[52:55], s101 offen offset:0 sc1
    v_mfma_f32_16x16x32_bf16 v[36:39], v[72:75], v[228:231], v[36:39]
    ds_read_b64_tr_b16 v[94:95], v101 offset:52032
    v_permlane16_swap_b32 v11, v13
    v_mfma_f32_16x16x32_bf16 v[44:47], v[76:79], v[228:231], v[44:47]
    ds_read_b64_tr_b16 v[72:73], v101 offset:50272
    v_mfma_f32_16x16x32_bf16 v[40:43], v[76:79], v[224:227], v[40:43]
    ds_read_b64_tr_b16 v[74:75], v101 offset:52064
    s_waitcnt lgkmcnt(8)
    v_mfma_f32_16x16x32_bf16 v[64:67], v[80:83], v[224:227], v[64:67]
    ds_read_b64_tr_b16 v[76:77], v101 offset:50368
    buffer_load_dwordx4 a[196:199], v2, s[52:55], s101 offen offset:1024 sc1
    v_mfma_f32_16x16x32_bf16 v[68:71], v[80:83], v[228:231], v[68:71]
    ds_read_b64_tr_b16 v[78:79], v101 offset:52160
    s_waitcnt vmcnt(14) lgkmcnt(6)
    v_mfma_f32_16x16x32_bf16 v[16:19], v[84:87], v[232:235], v[16:19]
    ds_read_b64_tr_b16 v[80:81], v100 offset:128
    v_mfma_f32_16x16x32_bf16 v[20:23], v[84:87], v[236:239], v[20:23]
    ds_read_b64_tr_b16 v[82:83], v100 offset:1920
    v_mfma_f32_16x16x32_bf16 v[28:31], v[88:91], v[236:239], v[28:31]
    ds_read_b64_tr_b16 v[84:85], v100 offset:160
    v_mfma_f32_16x16x32_bf16 v[24:27], v[88:91], v[232:235], v[24:27]
    ds_read_b64_tr_b16 v[86:87], v100 offset:1952
    s_waitcnt lgkmcnt(6)
    v_mfma_f32_16x16x32_bf16 v[32:35], v[92:95], v[232:235], v[32:35]
    ds_read_b64_tr_b16 v[88:89], v100 offset:7296
    buffer_load_dwordx4 a[200:203], v2, s[52:55], s101 offen offset:2048 sc1
    v_mfma_f32_16x16x32_bf16 v[36:39], v[92:95], v[236:239], v[36:39]
    ds_read_b64_tr_b16 v[90:91], v100 offset:9088
    v_mfma_f32_16x16x32_bf16 v[44:47], v[72:75], v[236:239], v[44:47]
    ds_read_b64_tr_b16 v[92:93], v100 offset:7328
    v_mfma_f32_16x16x32_bf16 v[40:43], v[72:75], v[232:235], v[40:43]
    ds_read_b64_tr_b16 v[94:95], v100 offset:9120
    s_waitcnt lgkmcnt(8)
    v_mfma_f32_16x16x32_bf16 v[64:67], v[76:79], v[232:235], v[64:67]
    ds_read_b64_tr_b16 v[72:73], v100 offset:14464
    buffer_load_dwordx4 a[204:207], v2, s[52:55], s101 offen offset:3072 sc1
    v_mfma_f32_16x16x32_bf16 v[68:71], v[76:79], v[236:239], v[68:71]
    ds_read_b64_tr_b16 v[74:75], v100 offset:16256
    ds_read_b128 v[48:51], v102 offset:0
    ds_read_b128 v[52:55], v102 offset:512
    ds_read_b128 v[56:59], v102 offset:64
    ds_read_b128 v[60:63], v102 offset:576
    s_waitcnt lgkmcnt(2)
    v_pk_fma_f32 v[96:97], v[48:49], v[10:11], v[52:53] op_sel:[0,1,0] op_sel_hi:[1,1,1]
    v_pk_fma_f32 v[98:99], v[50:51], v[10:11], v[54:55] op_sel:[0,1,0] op_sel_hi:[1,1,1]
    v_pk_fma_f32 v[96:97], v[16:17], v[10:11], v[96:97] op_sel:[0,0,0] op_sel_hi:[1,0,1]
    v_pk_fma_f32 v[98:99], v[18:19], v[10:11], v[98:99] op_sel:[0,0,0] op_sel_hi:[1,0,1]
    v_cvt_pk_bf16_f32 v16, v96, v97
    v_cvt_pk_bf16_f32 v17, v98, v99
    v_pk_max_i16 v16, v16, 0
    v_pk_max_i16 v17, v17, 0
    v_pk_fma_f32 v[96:97], v[48:49], v[12:13], v[52:53] op_sel:[0,1,0] op_sel_hi:[1,1,1]
    v_pk_fma_f32 v[98:99], v[50:51], v[12:13], v[54:55] op_sel:[0,1,0] op_sel_hi:[1,1,1]
    v_pk_fma_f32 v[96:97], v[20:21], v[12:13], v[96:97] op_sel:[0,0,0] op_sel_hi:[1,0,1]
    v_pk_fma_f32 v[98:99], v[22:23], v[12:13], v[98:99] op_sel:[0,0,0] op_sel_hi:[1,0,1]
    ds_read_b128 v[48:51], v102 offset:128
    ds_read_b128 v[52:55], v102 offset:640
    v_cvt_pk_bf16_f32 v20, v96, v97
    v_cvt_pk_bf16_f32 v21, v98, v99
    v_pk_max_i16 v20, v20, 0
    v_pk_max_i16 v21, v21, 0
    s_waitcnt lgkmcnt(2)
    v_pk_fma_f32 v[96:97], v[56:57], v[10:11], v[60:61] op_sel:[0,1,0] op_sel_hi:[1,1,1]
    v_pk_fma_f32 v[98:99], v[58:59], v[10:11], v[62:63] op_sel:[0,1,0] op_sel_hi:[1,1,1]
    v_pk_fma_f32 v[96:97], v[24:25], v[10:11], v[96:97] op_sel:[0,0,0] op_sel_hi:[1,0,1]
    v_pk_fma_f32 v[98:99], v[26:27], v[10:11], v[98:99] op_sel:[0,0,0] op_sel_hi:[1,0,1]
    v_cvt_pk_bf16_f32 v18, v96, v97
    v_cvt_pk_bf16_f32 v19, v98, v99
    v_pk_max_i16 v18, v18, 0
    v_pk_max_i16 v19, v19, 0
    buffer_store_dwordx4 v[16:19], v107, s[52:55], s26 offen offset:0 sc1
    v_pk_fma_f32 v[96:97], v[56:57], v[12:13], v[60:61] op_sel:[0,1,0] op_sel_hi:[1,1,1]
    v_pk_fma_f32 v[98:99], v[58:59], v[12:13], v[62:63] op_sel:[0,1,0] op_sel_hi:[1,1,1]
    v_pk_fma_f32 v[96:97], v[28:29], v[12:13], v[96:97] op_sel:[0,0,0] op_sel_hi:[1,0,1]
    v_pk_fma_f32 v[98:99], v[30:31], v[12:13], v[98:99] op_sel:[0,0,0] op_sel_hi:[1,0,1]
    ds_read_b128 v[56:59], v102 offset:192
    ds_read_b128 v[60:63], v102 offset:704
    v_cvt_pk_bf16_f32 v22, v96, v97
    v_cvt_pk_bf16_f32 v23, v98, v99
    v_pk_max_i16 v22, v22, 0
    v_pk_max_i16 v23, v23, 0
    buffer_store_dwordx4 v[20:23], v107, s[52:55], s27 offen offset:0 sc1
    s_waitcnt lgkmcnt(2)
    v_pk_fma_f32 v[96:97], v[48:49], v[10:11], v[52:53] op_sel:[0,1,0] op_sel_hi:[1,1,1]
    v_pk_fma_f32 v[98:99], v[50:51], v[10:11], v[54:55] op_sel:[0,1,0] op_sel_hi:[1,1,1]
    v_pk_fma_f32 v[96:97], v[32:33], v[10:11], v[96:97] op_sel:[0,0,0] op_sel_hi:[1,0,1]
    v_pk_fma_f32 v[98:99], v[34:35], v[10:11], v[98:99] op_sel:[0,0,0] op_sel_hi:[1,0,1]
    v_cvt_pk_bf16_f32 v32, v96, v97
    v_cvt_pk_bf16_f32 v33, v98, v99
    v_pk_max_i16 v32, v32, 0
    v_pk_max_i16 v33, v33, 0
    v_pk_fma_f32 v[96:97], v[48:49], v[12:13], v[52:53] op_sel:[0,1,0] op_sel_hi:[1,1,1]
    v_pk_fma_f32 v[98:99], v[50:51], v[12:13], v[54:55] op_sel:[0,1,0] op_sel_hi:[1,1,1]
    v_pk_fma_f32 v[96:97], v[36:37], v[12:13], v[96:97] op_sel:[0,0,0] op_sel_hi:[1,0,1]
    v_pk_fma_f32 v[98:99], v[38:39], v[12:13], v[98:99] op_sel:[0,0,0] op_sel_hi:[1,0,1]
    ds_read_b128 v[48:51], v102 offset:384
    ds_read_b128 v[52:55], v102 offset:896
    v_cvt_pk_bf16_f32 v36, v96, v97
    v_cvt_pk_bf16_f32 v37, v98, v99
    v_pk_max_i16 v36, v36, 0
    v_pk_max_i16 v37, v37, 0
    s_waitcnt lgkmcnt(2)
    v_pk_fma_f32 v[96:97], v[56:57], v[10:11], v[60:61] op_sel:[0,1,0] op_sel_hi:[1,1,1]
    v_pk_fma_f32 v[98:99], v[58:59], v[10:11], v[62:63] op_sel:[0,1,0] op_sel_hi:[1,1,1]
    v_pk_fma_f32 v[96:97], v[40:41], v[10:11], v[96:97] op_sel:[0,0,0] op_sel_hi:[1,0,1]
    v_pk_fma_f32 v[98:99], v[42:43], v[10:11], v[98:99] op_sel:[0,0,0] op_sel_hi:[1,0,1]
    v_cvt_pk_bf16_f32 v34, v96, v97
    v_cvt_pk_bf16_f32 v35, v98, v99
    v_pk_max_i16 v34, v34, 0
    v_pk_max_i16 v35, v35, 0
    buffer_store_dwordx4 v[32:35], v107, s[52:55], s26 offen offset:1024 sc1
    v_pk_fma_f32 v[96:97], v[56:57], v[12:13], v[60:61] op_sel:[0,1,0] op_sel_hi:[1,1,1]
    v_pk_fma_f32 v[98:99], v[58:59], v[12:13], v[62:63] op_sel:[0,1,0] op_sel_hi:[1,1,1]
    v_pk_fma_f32 v[96:97], v[44:45], v[12:13], v[96:97] op_sel:[0,0,0] op_sel_hi:[1,0,1]
    v_pk_fma_f32 v[98:99], v[46:47], v[12:13], v[98:99] op_sel:[0,0,0] op_sel_hi:[1,0,1]
    v_cvt_pk_bf16_f32 v38, v96, v97
    v_cvt_pk_bf16_f32 v39, v98, v99
    v_pk_max_i16 v38, v38, 0
    v_pk_max_i16 v39, v39, 0
    buffer_store_dwordx4 v[36:39], v107, s[52:55], s27 offen offset:1024 sc1
    s_waitcnt lgkmcnt(0)
    v_pk_fma_f32 v[96:97], v[48:49], v[10:11], v[52:53] op_sel:[0,1,0] op_sel_hi:[1,1,1]
    v_pk_fma_f32 v[98:99], v[50:51], v[10:11], v[54:55] op_sel:[0,1,0] op_sel_hi:[1,1,1]
    v_pk_fma_f32 v[96:97], v[64:65], v[10:11], v[96:97] op_sel:[0,0,0] op_sel_hi:[1,0,1]
    v_pk_fma_f32 v[98:99], v[66:67], v[10:11], v[98:99] op_sel:[0,0,0] op_sel_hi:[1,0,1]
    v_cvt_pk_bf16_f32 v64, v96, v97
    v_cvt_pk_bf16_f32 v65, v98, v99
    v_pk_max_i16 v64, v64, 0
    v_pk_max_i16 v65, v65, 0
    buffer_store_dword v64, v108, s[52:55], s26 offen offset:3072 sc1
    buffer_store_dword v65, v108, s[52:55], s26 offen offset:3328 sc1
    v_pk_fma_f32 v[96:97], v[48:49], v[12:13], v[52:53] op_sel:[0,1,0] op_sel_hi:[1,1,1]
    v_pk_fma_f32 v[98:99], v[50:51], v[12:13], v[54:55] op_sel:[0,1,0] op_sel_hi:[1,1,1]
    v_pk_fma_f32 v[96:97], v[68:69], v[12:13], v[96:97] op_sel:[0,0,0] op_sel_hi:[1,0,1]
    v_pk_fma_f32 v[98:99], v[70:71], v[12:13], v[98:99] op_sel:[0,0,0] op_sel_hi:[1,0,1]
    v_cvt_pk_bf16_f32 v68, v96, v97
    v_cvt_pk_bf16_f32 v69, v98, v99
    v_pk_max_i16 v68, v68, 0
    v_pk_max_i16 v69, v69, 0
    buffer_store_dword v68, v108, s[52:55], s27 offen offset:3072 sc1
    buffer_store_dword v69, v108, s[52:55], s27 offen offset:3328 sc1
    v_mfma_f32_16x16x32_bf16 v[48:51], v[80:83], v[112:115], 0
    ds_read_b64_tr_b16 v[76:77], v100 offset:14496
    v_mfma_f32_16x16x32_bf16 v[52:55], v[80:83], v[116:119], 0
    ds_read_b64_tr_b16 v[78:79], v100 offset:16288
    v_mfma_f32_16x16x32_bf16 v[60:63], v[84:87], v[116:119], 0
    s_add_u32 s101, s101, 4096
    ds_read_b64_tr_b16 v[80:81], v100 offset:21632
    buffer_load_dwordx4 a[208:211], v2, s[52:55], s101 offen offset:0 sc1
    v_mfma_f32_16x16x32_bf16 v[56:59], v[84:87], v[112:115], 0
    ds_read_b64_tr_b16 v[82:83], v100 offset:23424
    v_mfma_f32_16x16x32_bf16 v[48:51], v[88:91], v[120:123], v[48:51]
    ds_read_b64_tr_b16 v[84:85], v100 offset:21664
    v_mfma_f32_16x16x32_bf16 v[52:55], v[88:91], v[124:127], v[52:55]
    ds_read_b64_tr_b16 v[86:87], v100 offset:23456
    v_mfma_f32_16x16x32_bf16 v[60:63], v[92:95], v[124:127], v[60:63]
    ds_read_b64_tr_b16 v[88:89], v100 offset:28800
    buffer_load_dwordx4 a[212:215], v2, s[52:55], s101 offen offset:1024 sc1
    v_mfma_f32_16x16x32_bf16 v[56:59], v[92:95], v[120:123], v[56:59]
    ds_read_b64_tr_b16 v[90:91], v100 offset:30592
    s_waitcnt lgkmcnt(6)
    v_mfma_f32_16x16x32_bf16 v[48:51], v[72:75], v[128:131], v[48:51]
    ds_read_b64_tr_b16 v[92:93], v100 offset:28832
    v_mfma_f32_16x16x32_bf16 v[52:55], v[72:75], v[132:135], v[52:55]
    ds_read_b64_tr_b16 v[94:95], v100 offset:30624
    v_mfma_f32_16x16x32_bf16 v[60:63], v[76:79], v[132:135], v[60:63]
    ds_read_b64_tr_b16 v[72:73], v100 offset:35968
    v_mfma_f32_16x16x32_bf16 v[56:59], v[76:79], v[128:131], v[56:59]
    ds_read_b64_tr_b16 v[74:75], v100 offset:37760
    s_waitcnt lgkmcnt(6)
    v_mfma_f32_16x16x32_bf16 v[48:51], v[80:83], v[136:139], v[48:51]
    ds_read_b64_tr_b16 v[76:77], v100 offset:36000
    v_mfma_f32_16x16x32_bf16 v[52:55], v[80:83], v[140:143], v[52:55]
    ds_read_b64_tr_b16 v[78:79], v100 offset:37792
    v_mfma_f32_16x16x32_bf16 v[60:63], v[84:87], v[140:143], v[60:63]
    ds_read_b64_tr_b16 v[80:81], v100 offset:43136
    v_mfma_f32_16x16x32_bf16 v[56:59], v[84:87], v[136:139], v[56:59]
    ds_read_b64_tr_b16 v[82:83], v100 offset:44928
    s_waitcnt lgkmcnt(6)
    v_mfma_f32_16x16x32_bf16 v[48:51], v[88:91], v[144:147], v[48:51]
    ds_read_b64_tr_b16 v[84:85], v100 offset:43168
    v_mfma_f32_16x16x32_bf16 v[52:55], v[88:91], v[148:151], v[52:55]
    ds_read_b64_tr_b16 v[86:87], v100 offset:44960
    v_mfma_f32_16x16x32_bf16 v[60:63], v[92:95], v[148:151], v[60:63]
    ds_read_b64_tr_b16 v[88:89], v100 offset:50304
    v_mfma_f32_16x16x32_bf16 v[56:59], v[92:95], v[144:147], v[56:59]
    ds_read_b64_tr_b16 v[90:91], v100 offset:52096
    s_waitcnt lgkmcnt(6)
    v_mfma_f32_16x16x32_bf16 v[48:51], v[72:75], v[152:155], v[48:51]
    ds_read_b64_tr_b16 v[92:93], v100 offset:50336
    v_mfma_f32_16x16x32_bf16 v[52:55], v[72:75], v[156:159], v[52:55]
    ds_read_b64_tr_b16 v[94:95], v100 offset:52128
    v_mfma_f32_16x16x32_bf16 v[60:63], v[76:79], v[156:159], v[60:63]
    ds_read_b64_tr_b16 v[72:73], v101 offset:128
    v_mfma_f32_16x16x32_bf16 v[56:59], v[76:79], v[152:155], v[56:59]
    ds_read_b64_tr_b16 v[74:75], v101 offset:1920
    s_waitcnt lgkmcnt(6)
    v_mfma_f32_16x16x32_bf16 v[48:51], v[80:83], v[160:163], v[48:51]
    ds_read_b64_tr_b16 v[76:77], v101 offset:160
    v_mfma_f32_16x16x32_bf16 v[52:55], v[80:83], v[164:167], v[52:55]
    ds_read_b64_tr_b16 v[78:79], v101 offset:1952
    v_mfma_f32_16x16x32_bf16 v[60:63], v[84:87], v[164:167], v[60:63]
    ds_read_b64_tr_b16 v[80:81], v101 offset:7296
    v_mfma_f32_16x16x32_bf16 v[56:59], v[84:87], v[160:163], v[56:59]
    ds_read_b64_tr_b16 v[82:83], v101 offset:9088
    s_waitcnt lgkmcnt(6)
    v_mfma_f32_16x16x32_bf16 v[48:51], v[88:91], v[168:171], v[48:51]
    ds_read_b64_tr_b16 v[84:85], v101 offset:7328
    v_mfma_f32_16x16x32_bf16 v[52:55], v[88:91], v[172:175], v[52:55]
    ds_read_b64_tr_b16 v[86:87], v101 offset:9120
    v_mfma_f32_16x16x32_bf16 v[60:63], v[92:95], v[172:175], v[60:63]
    ds_read_b64_tr_b16 v[88:89], v101 offset:14464
    v_mfma_f32_16x16x32_bf16 v[56:59], v[92:95], v[168:171], v[56:59]
    ds_read_b64_tr_b16 v[90:91], v101 offset:16256
    s_waitcnt lgkmcnt(6)
    v_mfma_f32_16x16x32_bf16 v[48:51], v[72:75], v[176:179], v[48:51]
    ds_read_b64_tr_b16 v[92:93], v101 offset:14496
    v_mfma_f32_16x16x32_bf16 v[52:55], v[72:75], v[180:183], v[52:55]
    ds_read_b64_tr_b16 v[94:95], v101 offset:16288
    v_mfma_f32_16x16x32_bf16 v[60:63], v[76:79], v[180:183], v[60:63]
    ds_read_b64_tr_b16 v[72:73], v101 offset:21632
    v_mfma_f32_16x16x32_bf16 v[56:59], v[76:79], v[176:179], v[56:59]
    ds_read_b64_tr_b16 v[74:75], v101 offset:23424
    s_waitcnt lgkmcnt(6)
    v_mfma_f32_16x16x32_bf16 v[48:51], v[80:83], v[184:187], v[48:51]
    ds_read_b64_tr_b16 v[76:77], v101 offset:21664
    v_mfma_f32_16x16x32_bf16 v[52:55], v[80:83], v[188:191], v[52:55]
    ds_read_b64_tr_b16 v[78:79], v101 offset:23456
    v_mfma_f32_16x16x32_bf16 v[60:63], v[84:87], v[188:191], v[60:63]
    ds_read_b64_tr_b16 v[80:81], v101 offset:28800
    v_mfma_f32_16x16x32_bf16 v[56:59], v[84:87], v[184:187], v[56:59]
    ds_read_b64_tr_b16 v[82:83], v101 offset:30592
    s_waitcnt lgkmcnt(6)
    v_mfma_f32_16x16x32_bf16 v[48:51], v[88:91], v[192:195], v[48:51]
    ds_read_b64_tr_b16 v[84:85], v101 offset:28832
    v_mfma_f32_16x16x32_bf16 v[52:55], v[88:91], v[196:199], v[52:55]
    ds_read_b64_tr_b16 v[86:87], v101 offset:30624
    v_mfma_f32_16x16x32_bf16 v[60:63], v[92:95], v[196:199], v[60:63]
    ds_read_b64_tr_b16 v[88:89], v101 offset:35968
    v_mfma_f32_16x16x32_bf16 v[56:59], v[92:95], v[192:195], v[56:59]
    ds_read_b64_tr_b16 v[90:91], v101 offset:37760
    s_waitcnt lgkmcnt(6)
    v_mfma_f32_16x16x32_bf16 v[48:51], v[72:75], v[200:203], v[48:51]
    ds_read_b64_tr_b16 v[92:93], v101 offset:36000
    v_mfma_f32_16x16x32_bf16 v[52:55], v[72:75], v[204:207], v[52:55]
    ds_read_b64_tr_b16 v[94:95], v101 offset:37792
    v_mfma_f32_16x16x32_bf16 v[60:63], v[76:79], v[204:207], v[60:63]
    ds_read_b64_tr_b16 v[72:73], v101 offset:43136
    v_mfma_f32_16x16x32_bf16 v[56:59], v[76:79], v[200:203], v[56:59]
    ds_read_b64_tr_b16 v[74:75], v101 offset:44928
    s_waitcnt lgkmcnt(6)
    v_mfma_f32_16x16x32_bf16 v[48:51], v[80:83], v[208:211], v[48:51]
    ds_read_b64_tr_b16 v[76:77], v101 offset:43168
    v_mfma_f32_16x16x32_bf16 v[52:55], v[80:83], v[212:215], v[52:55]
    ds_read_b64_tr_b16 v[78:79], v101 offset:44960
    v_mfma_f32_16x16x32_bf16 v[60:63], v[84:87], v[212:215], v[60:63]
    ds_read_b64_tr_b16 v[80:81], v101 offset:50304
    v_mfma_f32_16x16x32_bf16 v[56:59], v[84:87], v[208:211], v[56:59]
    ds_read_b64_tr_b16 v[82:83], v101 offset:52096
    s_waitcnt lgkmcnt(6)
    v_mfma_f32_16x16x32_bf16 v[48:51], v[88:91], v[216:219], v[48:51]
    ds_read_b64_tr_b16 v[84:85], v101 offset:50336
    v_mfma_f32_16x16x32_bf16 v[52:55], v[88:91], v[220:223], v[52:55]
    ds_read_b64_tr_b16 v[86:87], v101 offset:52128
    v_mfma_f32_16x16x32_bf16 v[60:63], v[92:95], v[220:223], v[60:63]
    v_mfma_f32_16x16x32_bf16 v[56:59], v[92:95], v[216:219], v[56:59]
    s_waitcnt lgkmcnt(4)
    v_mfma_f32_16x16x32_bf16 v[48:51], v[72:75], v[224:227], v[48:51]
    v_mfma_f32_16x16x32_bf16 v[52:55], v[72:75], v[228:231], v[52:55]
    v_mfma_f32_16x16x32_bf16 v[60:63], v[76:79], v[228:231], v[60:63]
    v_mfma_f32_16x16x32_bf16 v[56:59], v[76:79], v[224:227], v[56:59]
    s_waitcnt vmcnt(2)
    s_mov_b64 exec, 1
    buffer_store_dword v3, off, s[52:55], s15
    s_mov_b64 exec, -1
    s_waitcnt lgkmcnt(0)
    v_mfma_f32_16x16x32_bf16 v[48:51], v[80:83], v[232:235], v[48:51]
    ds_read_b128 v[176:179], v102 offset:256
    v_mfma_f32_16x16x32_bf16 v[52:55], v[80:83], v[236:239], v[52:55]
    ds_read_b128 v[180:183], v102 offset:768
    v_mfma_f32_16x16x32_bf16 v[60:63], v[84:87], v[236:239], v[60:63]
    ds_read_b128 v[184:187], v102 offset:320
    v_mfma_f32_16x16x32_bf16 v[56:59], v[84:87], v[232:235], v[56:59]
    ds_read_b128 v[188:191], v102 offset:832
    buffer_load_dword v15, v104, s[52:55], 0 offen offset:128 sc1
    buffer_load_dwordx4 a[216:219], v2, s[52:55], s101 offen offset:2048 sc1
    buffer_load_dwordx4 a[220:223], v2, s[52:55], s101 offen offset:3072 sc1
    s_waitcnt lgkmcnt(2)
    v_pk_fma_f32 v[96:97], v[176:177], v[10:11], v[180:181] op_sel:[0,1,0] op_sel_hi:[1,1,1]
    v_pk_fma_f32 v[98:99], v[178:179], v[10:11], v[182:183] op_sel:[0,1,0] op_sel_hi:[1,1,1]
    v_pk_fma_f32 v[96:97], v[48:49], v[10:11], v[96:97] op_sel:[0,0,0] op_sel_hi:[1,0,1]
    v_pk_fma_f32 v[98:99], v[50:51], v[10:11], v[98:99] op_sel:[0,0,0] op_sel_hi:[1,0,1]
    v_cvt_pk_bf16_f32 v48, v96, v97
    v_cvt_pk_bf16_f32 v49, v98, v99
    v_pk_max_i16 v48, v48, 0
    v_pk_max_i16 v49, v49, 0
    v_pk_fma_f32 v[96:97], v[176:177], v[12:13], v[180:181] op_sel:[0,1,0] op_sel_hi:[1,1,1]
    v_pk_fma_f32 v[98:99], v[178:179], v[12:13], v[182:183] op_sel:[0,1,0] op_sel_hi:[1,1,1]
    v_pk_fma_f32 v[96:97], v[52:53], v[12:13], v[96:97] op_sel:[0,0,0] op_sel_hi:[1,0,1]
    v_pk_fma_f32 v[98:99], v[54:55], v[12:13], v[98:99] op_sel:[0,0,0] op_sel_hi:[1,0,1]
    v_cvt_pk_bf16_f32 v52, v96, v97
    v_cvt_pk_bf16_f32 v53, v98, v99
    v_pk_max_i16 v52, v52, 0
    v_pk_max_i16 v53, v53, 0
    s_waitcnt lgkmcnt(0)
    v_pk_fma_f32 v[96:97], v[184:185], v[10:11], v[188:189] op_sel:[0,1,0] op_sel_hi:[1,1,1]
    v_pk_fma_f32 v[98:99], v[186:187], v[10:11], v[190:191] op_sel:[0,1,0] op_sel_hi:[1,1,1]
    v_pk_fma_f32 v[96:97], v[56:57], v[10:11], v[96:97] op_sel:[0,0,0] op_sel_hi:[1,0,1]
    v_pk_fma_f32 v[98:99], v[58:59], v[10:11], v[98:99] op_sel:[0,0,0] op_sel_hi:[1,0,1]
    v_cvt_pk_bf16_f32 v50, v96, v97
    v_cvt_pk_bf16_f32 v51, v98, v99
    v_pk_max_i16 v50, v50, 0
    v_pk_max_i16 v51, v51, 0
    v_pk_fma_f32 v[96:97], v[184:185], v[12:13], v[188:189] op_sel:[0,1,0] op_sel_hi:[1,1,1]
    v_pk_fma_f32 v[98:99], v[186:187], v[12:13], v[190:191] op_sel:[0,1,0] op_sel_hi:[1,1,1]
    v_pk_fma_f32 v[96:97], v[60:61], v[12:13], v[96:97] op_sel:[0,0,0] op_sel_hi:[1,0,1]
    v_pk_fma_f32 v[98:99], v[62:63], v[12:13], v[98:99] op_sel:[0,0,0] op_sel_hi:[1,0,1]
    v_cvt_pk_bf16_f32 v54, v96, v97
    v_cvt_pk_bf16_f32 v55, v98, v99
    v_pk_max_i16 v54, v54, 0
    v_pk_max_i16 v55, v55, 0
    ds_read_b128 v[80:83], v5 offset:256
    ds_read_b128 v[84:87], v5 offset:272
    ds_read_b128 v[88:91], v5 offset:288
    ds_read_b128 v[92:95], v5 offset:304
    v_add_u32 v12, 1, v3
    s_waitcnt vmcnt(2)
    v_subrev_u32 v15, s68, v15
    v_cmp_lt_u32 vcc, 1, v15
    s_nop 0
    s_and_b64 vcc, vcc, s[60:61]
    s_cbranch_scc0 L_hida_31
    s_mov_b32 s82, 0
L_phid_32:
    buffer_load_dword v15, v104, s[52:55], 0 offen offset:128 sc1
    s_add_u32 s82, s82, 1
    s_waitcnt vmcnt(0)
    v_subrev_u32 v15, s68, v15
    v_cmp_lt_u32 vcc, 1, v15
    s_nop 0
    s_and_b64 vcc, vcc, s[60:61]
    s_cbranch_scc0 L_dhid_33
    s_cmp_lt_u32 s82, 131072
    s_cbranch_scc1 L_phid_32
L_dhid_33:
L_hida_31:
    buffer_load_dwordx4 v[112:115], v2, s[52:55], s16 offen offset:0 sc1
    buffer_load_dwordx4 v[116:119], v2, s[52:55], s16 offen offset:1024 sc1
    buffer_load_dword v120, v109, s[52:55], s16 offen offset:3072 sc1
    buffer_load_dword v121, v109, s[52:55], s16 offen offset:3328 sc1
    buffer_load_dword v122, v109, s[52:55], s16 offen offset:3584 sc1
    buffer_load_dword v123, v109, s[52:55], s16 offen offset:3840 sc1
    s_add_u32 s78, s16, 4096
    buffer_load_dwordx4 v[124:127], v2, s[52:55], s78 offen offset:0 sc1
    buffer_load_dwordx4 v[128:131], v2, s[52:55], s78 offen offset:1024 sc1
    buffer_load_dwordx4 v[132:135], v2, s[52:55], s78 offen offset:3072 sc1
    s_add_u32 s78, s16, 8192
    buffer_load_dwordx4 v[136:139], v2, s[52:55], s78 offen offset:0 sc1
    buffer_load_dword v140, v109, s[52:55], s78 offen offset:2048 sc1
    buffer_load_dword v141, v109, s[52:55], s78 offen offset:2304 sc1
    buffer_load_dword v142, v109, s[52:55], s78 offen offset:2560 sc1
    buffer_load_dword v143, v109, s[52:55], s78 offen offset:2816 sc1
    buffer_store_dwordx4 v[48:51], v107, s[52:55], s26 offen offset:2048 sc1
    buffer_store_dwordx4 v[52:55], v107, s[52:55], s27 offen offset:2048 sc1
    s_lshl_b32 s76, s5, 13
    s_add_u32 s76, s76, 126976
    s_mov_b32 s77, 8192
    v_and_b32 v13, 15, v1
    v_lshrrev_b32 v14, 3, v1
    v_and_b32 v14, 6, v14
    v_xor_b32 v14, v14, v13
    v_and_b32 v14, 7, v14
    v_lshl_add_u32 v13, v13, 7, s76
    v_lshl_add_u32 v13, v14, 4, v13
    v_xor_b32 v14, 16, v13
    v_subrev_u32 v8, 40960, v8
    v_subrev_u32 v11, 40960, v9
    s_waitcnt vmcnt(15)
    v_mfma_f32_16x16x32_bf16 v[16:19], a[0:3], v[112:115], 0
    v_mfma_f32_16x16x32_bf16 v[20:23], a[4:7], v[112:115], 0
    buffer_load_dwordx4 v[144:147], v2, s[52:55], s78 offen offset:3072 sc1
    v_mfma_f32_16x16x32_bf16 v[24:27], a[8:11], v[112:115], 0
    v_mfma_f32_16x16x32_bf16 v[28:31], a[12:15], v[112:115], 0
    s_waitcnt vmcnt(15)
    v_mfma_f32_16x16x32_bf16 v[16:19], a[16:19], v[116:119], v[16:19]
    s_add_u32 s78, s16, 12288
    v_mfma_f32_16x16x32_bf16 v[20:23], a[20:23], v[116:119], v[20:23]
    buffer_load_dwordx4 v[148:151], v2, s[52:55], s78 offen offset:0 sc1
    v_mfma_f32_16x16x32_bf16 v[24:27], a[24:27], v[116:119], v[24:27]
    v_mfma_f32_16x16x32_bf16 v[28:31], a[28:31], v[116:119], v[28:31]
    s_waitcnt vmcnt(12)
    v_mfma_f32_16x16x32_bf16 v[16:19], a[48:51], v[120:123], v[16:19]
    v_mfma_f32_16x16x32_bf16 v[20:23], a[52:55], v[120:123], v[20:23]
    buffer_load_dwordx4 v[152:155], v2, s[52:55], s17 offen offset:0 sc1
    v_mfma_f32_16x16x32_bf16 v[24:27], a[56:59], v[120:123], v[24:27]
    v_mfma_f32_16x16x32_bf16 v[28:31], a[60:63], v[120:123], v[28:31]
    s_waitcnt vmcnt(12)
    v_mfma_f32_16x16x32_bf16 v[16:19], a[64:67], v[124:127], v[16:19]
    v_mfma_f32_16x16x32_bf16 v[20:23], a[68:71], v[124:127], v[20:23]
    buffer_load_dwordx4 v[156:159], v2, s[52:55], s17 offen offset:1024 sc1
    v_mfma_f32_16x16x32_bf16 v[24:27], a[72:75], v[124:127], v[24:27]
    v_mfma_f32_16x16x32_bf16 v[28:31], a[76:79], v[124:127], v[28:31]
    s_waitcnt vmcnt(12)
    v_mfma_f32_16x16x32_bf16 v[16:19], a[80:83], v[128:131], v[16:19]
    v_mfma_f32_16x16x32_bf16 v[20:23], a[84:87], v[128:131], v[20:23]
    buffer_load_dword v160, v109, s[52:55], s17 offen offset:3072 sc1
    buffer_load_dword v161, v109, s[52:55], s17 offen offset:3328 sc1
    buffer_load_dword v162, v109, s[52:55], s17 offen offset:3584 sc1
    buffer_load_dword v163, v109, s[52:55], s17 offen offset:3840 sc1
    v_mfma_f32_16x16x32_bf16 v[24:27], a[88:91], v[128:131], v[24:27]
    v_mfma_f32_16x16x32_bf16 v[28:31], a[92:95], v[128:131], v[28:31]
    s_waitcnt vmcnt(15)
    v_mfma_f32_16x16x32_bf16 v[16:19], a[112:115], v[132:135], v[16:19]
    s_add_u32 s78, s17, 4096
    v_mfma_f32_16x16x32_bf16 v[20:23], a[116:119], v[132:135], v[20:23]
    buffer_load_dwordx4 v[164:167], v2, s[52:55], s78 offen offset:0 sc1
    v_mfma_f32_16x16x32_bf16 v[24:27], a[120:123], v[132:135], v[24:27]
    v_mfma_f32_16x16x32_bf16 v[28:31], a[124:127], v[132:135], v[28:31]
    s_waitcnt vmcnt(15)
    v_mfma_f32_16x16x32_bf16 v[16:19], a[128:131], v[136:139], v[16:19]
    v_mfma_f32_16x16x32_bf16 v[20:23], a[132:135], v[136:139], v[20:23]
    buffer_load_dwordx4 v[168:171], v2, s[52:55], s78 offen offset:1024 sc1
    v_mfma_f32_16x16x32_bf16 v[24:27], a[136:139], v[136:139], v[24:27]
    v_mfma_f32_16x16x32_bf16 v[28:31], a[140:143], v[136:139], v[28:31]
    s_waitcnt vmcnt(12)
    v_mfma_f32_16x16x32_bf16 v[16:19], a[160:163], v[140:143], v[16:19]
    v_mfma_f32_16x16x32_bf16 v[20:23], a[164:167], v[140:143], v[20:23]
    buffer_load_dwordx4 v[172:175], v2, s[52:55], s78 offen offset:3072 sc1
    v_mfma_f32_16x16x32_bf16 v[24:27], a[168:171], v[140:143], v[24:27]
    v_mfma_f32_16x16x32_bf16 v[28:31], a[172:175], v[140:143], v[28:31]
    s_waitcnt vmcnt(10)
    s_mov_b64 exec, 1
    buffer_store_dword v12, off, s[52:55], s15
    s_mov_b64 exec, -1
    v_mfma_f32_16x16x32_bf16 v[16:19], a[176:179], v[144:147], v[16:19]
    s_add_u32 s78, s17, 8192
    v_mfma_f32_16x16x32_bf16 v[20:23], a[180:183], v[144:147], v[20:23]
    buffer_load_dwordx4 v[112:115], v2, s[52:55], s78 offen offset:0 sc1
    v_mfma_f32_16x16x32_bf16 v[24:27], a[184:187], v[144:147], v[24:27]
    v_mfma_f32_16x16x32_bf16 v[28:31], a[188:191], v[144:147], v[28:31]
    s_waitcnt vmcnt(11)
    v_mfma_f32_16x16x32_bf16 v[16:19], a[192:195], v[148:151], v[16:19]
    v_mfma_f32_16x16x32_bf16 v[20:23], a[196:199], v[148:151], v[20:23]
    buffer_load_dword v116, v109, s[52:55], s78 offen offset:2048 sc1
    buffer_load_dword v117, v109, s[52:55], s78 offen offset:2304 sc1
    buffer_load_dword v118, v109, s[52:55], s78 offen offset:2560 sc1
    buffer_load_dword v119, v109, s[52:55], s78 offen offset:2816 sc1
    v_mfma_f32_16x16x32_bf16 v[24:27], a[200:203], v[148:151], v[24:27]
    v_mfma_f32_16x16x32_bf16 v[28:31], a[204:207], v[148:151], v[28:31]
    s_waitcnt vmcnt(14)
    v_mfma_f32_16x16x32_bf16 v[32:35], a[0:3], v[152:155], 0
    v_mfma_f32_16x16x32_bf16 v[36:39], a[4:7], v[152:155], 0
    buffer_load_dwordx4 v[120:123], v2, s[52:55], s78 offen offset:3072 sc1
    v_mfma_f32_16x16x32_bf16 v[40:43], a[8:11], v[152:155], 0
    v_mfma_f32_16x16x32_bf16 v[44:47], a[12:15], v[152:155], 0
    s_waitcnt vmcnt(14)
    v_mfma_f32_16x16x32_bf16 v[32:35], a[16:19], v[156:159], v[32:35]
    s_add_u32 s78, s17, 12288
    v_mfma_f32_16x16x32_bf16 v[36:39], a[20:23], v[156:159], v[36:39]
    buffer_load_dwordx4 v[124:127], v2, s[52:55], s78 offen offset:0 sc1
    v_mfma_f32_16x16x32_bf16 v[40:43], a[24:27], v[156:159], v[40:43]
    v_mfma_f32_16x16x32_bf16 v[44:47], a[28:31], v[156:159], v[44:47]
    s_waitcnt vmcnt(11)
    v_mfma_f32_16x16x32_bf16 v[32:35], a[48:51], v[160:163], v[32:35]
    v_mfma_f32_16x16x32_bf16 v[36:39], a[52:55], v[160:163], v[36:39]
    buffer_load_dwordx4 v[128:131], v2, s[52:55], s18 offen offset:0 sc1
    v_mfma_f32_16x16x32_bf16 v[40:43], a[56:59], v[160:163], v[40:43]
    v_mfma_f32_16x16x32_bf16 v[44:47], a[60:63], v[160:163], v[44:47]
    s_waitcnt vmcnt(11)
    v_mfma_f32_16x16x32_bf16 v[32:35], a[64:67], v[164:167], v[32:35]
    v_mfma_f32_16x16x32_bf16 v[36:39], a[68:71], v[164:167], v[36:39]
    buffer_load_dwordx4 v[132:135], v2, s[52:55], s18 offen offset:1024 sc1
    v_mfma_f32_16x16x32_bf16 v[40:43], a[72:75], v[164:167], v[40:43]
    v_mfma_f32_16x16x32_bf16 v[44:47], a[76:79], v[164:167], v[44:47]
    s_waitcnt vmcnt(11)
    v_mfma_f32_16x16x32_bf16 v[32:35], a[80:83], v[168:171], v[32:35]
    v_mfma_f32_16x16x32_bf16 v[36:39], a[84:87], v[168:171], v[36:39]
    buffer_load_dword v136, v109, s[52:55], s18 offen offset:3072 sc1
    buffer_load_dword v137, v109, s[52:55], s18 offen offset:3328 sc1
    buffer_load_dword v138, v109, s[52:55], s18 offen offset:3584 sc1
    buffer_load_dword v139, v109, s[52:55], s18 offen offset:3840 sc1
    v_mfma_f32_16x16x32_bf16 v[40:43], a[88:91], v[168:171], v[40:43]
    v_mfma_f32_16x16x32_bf16 v[44:47], a[92:95], v[168:171], v[44:47]
    s_waitcnt vmcnt(14)
    v_mfma_f32_16x16x32_bf16 v[32:35], a[112:115], v[172:175], v[32:35]
    s_add_u32 s78, s18, 4096
    v_mfma_f32_16x16x32_bf16 v[36:39], a[116:119], v[172:175], v[36:39]
    buffer_load_dwordx4 v[140:143], v2, s[52:55], s78 offen offset:0 sc1
    v_mfma_f32_16x16x32_bf16 v[40:43], a[120:123], v[172:175], v[40:43]
    v_mfma_f32_16x16x32_bf16 v[44:47], a[124:127], v[172:175], v[44:47]
    s_waitcnt vmcnt(13)
    v_mfma_f32_16x16x32_bf16 v[32:35], a[128:131], v[112:115], v[32:35]
    v_mfma_f32_16x16x32_bf16 v[36:39], a[132:135], v[112:115], v[36:39]
    buffer_load_dwordx4 v[144:147], v2, s[52:55], s78 offen offset:1024 sc1
    v_mfma_f32_16x16x32_bf16 v[40:43], a[136:139], v[112:115], v[40:43]
    buffer_load_dword v15, v104, s[52:55], 0 offen offset:128 sc1
    v_mfma_f32_16x16x32_bf16 v[44:47], a[140:143], v[112:115], v[44:47]
    s_waitcnt vmcnt(11)
    v_mfma_f32_16x16x32_bf16 v[32:35], a[160:163], v[116:119], v[32:35]
    v_mfma_f32_16x16x32_bf16 v[36:39], a[164:167], v[116:119], v[36:39]
    buffer_load_dwordx4 v[148:151], v2, s[52:55], s78 offen offset:3072 sc1
    v_mfma_f32_16x16x32_bf16 v[40:43], a[168:171], v[116:119], v[40:43]
    v_mfma_f32_16x16x32_bf16 v[44:47], a[172:175], v[116:119], v[44:47]
    s_waitcnt vmcnt(11)
    v_mfma_f32_16x16x32_bf16 v[32:35], a[176:179], v[120:123], v[32:35]
    s_add_u32 s78, s18, 8192
    v_mfma_f32_16x16x32_bf16 v[36:39], a[180:183], v[120:123], v[36:39]
    buffer_load_dwordx4 v[152:155], v2, s[52:55], s78 offen offset:0 sc1
    v_mfma_f32_16x16x32_bf16 v[40:43], a[184:187], v[120:123], v[40:43]
    v_mfma_f32_16x16x32_bf16 v[44:47], a[188:191], v[120:123], v[44:47]
    s_waitcnt vmcnt(11)
    v_mfma_f32_16x16x32_bf16 v[32:35], a[192:195], v[124:127], v[32:35]
    v_mfma_f32_16x16x32_bf16 v[36:39], a[196:199], v[124:127], v[36:39]
    buffer_load_dword v156, v109, s[52:55], s78 offen offset:2048 sc1
    buffer_load_dword v157, v109, s[52:55], s78 offen offset:2304 sc1
    buffer_load_dword v158, v109, s[52:55], s78 offen offset:2560 sc1
    buffer_load_dword v159, v109, s[52:55], s78 offen offset:2816 sc1
    v_mfma_f32_16x16x32_bf16 v[40:43], a[200:203], v[124:127], v[40:43]
    v_mfma_f32_16x16x32_bf16 v[44:47], a[204:207], v[124:127], v[44:47]
    s_waitcnt vmcnt(14)
    v_mfma_f32_16x16x32_bf16 v[64:67], a[0:3], v[128:131], 0
    v_mfma_f32_16x16x32_bf16 v[68:71], a[4:7], v[128:131], 0
    buffer_load_dwordx4 v[160:163], v2, s[52:55], s78 offen offset:3072 sc1
    v_mfma_f32_16x16x32_bf16 v[72:75], a[8:11], v[128:131], 0
    v_mfma_f32_16x16x32_bf16 v[76:79], a[12:15], v[128:131], 0
    s_waitcnt vmcnt(14)
    v_mfma_f32_16x16x32_bf16 v[64:67], a[16:19], v[132:135], v[64:67]
    s_add_u32 s78, s18, 12288
    v_mfma_f32_16x16x32_bf16 v[68:71], a[20:23], v[132:135], v[68:71]
    buffer_load_dwordx4 v[164:167], v2, s[52:55], s78 offen offset:0 sc1
    v_mfma_f32_16x16x32_bf16 v[72:75], a[24:27], v[132:135], v[72:75]
    v_mfma_f32_16x16x32_bf16 v[76:79], a[28:31], v[132:135], v[76:79]
    s_waitcnt vmcnt(11)
    v_mfma_f32_16x16x32_bf16 v[64:67], a[48:51], v[136:139], v[64:67]
    v_mfma_f32_16x16x32_bf16 v[68:71], a[52:55], v[136:139], v[68:71]
    buffer_load_dwordx4 v[168:171], v2, s[52:55], s19 offen offset:0 sc1
    v_mfma_f32_16x16x32_bf16 v[72:75], a[56:59], v[136:139], v[72:75]
    v_mfma_f32_16x16x32_bf16 v[76:79], a[60:63], v[136:139], v[76:79]
    s_waitcnt vmcnt(11)
    v_mfma_f32_16x16x32_bf16 v[64:67], a[64:67], v[140:143], v[64:67]
    v_mfma_f32_16x16x32_bf16 v[68:71], a[68:71], v[140:143], v[68:71]
    buffer_load_dwordx4 v[172:175], v2, s[52:55], s19 offen offset:1024 sc1
    v_mfma_f32_16x16x32_bf16 v[72:75], a[72:75], v[140:143], v[72:75]
    v_mfma_f32_16x16x32_bf16 v[76:79], a[76:79], v[140:143], v[76:79]
    s_waitcnt vmcnt(10)
    v_subrev_u32 v15, s68, v15
    v_cmp_ne_u32 vcc, 1, v15
    s_nop 0
    s_and_b64 vcc, vcc, s[60:61]
    s_cbranch_scc0 L_hidb_34
    s_mov_b32 s82, 0
L_phb_35:
    buffer_load_dword v15, v104, s[52:55], 0 offen offset:128 sc1
    s_add_u32 s82, s82, 1
    s_waitcnt vmcnt(0)
    v_subrev_u32 v15, s68, v15
    v_cmp_ne_u32 vcc, 1, v15
    s_nop 0
    s_and_b64 vcc, vcc, s[60:61]
    s_cbranch_scc0 L_dhb_36
    s_cmp_lt_u32 s82, 131072
    s_cbranch_scc1 L_phb_35
L_dhb_36:
L_hidb_34:
    v_mfma_f32_16x16x32_bf16 v[64:67], a[80:83], v[144:147], v[64:67]
    v_mfma_f32_16x16x32_bf16 v[68:71], a[84:87], v[144:147], v[68:71]
    buffer_load_dwordx4 v[112:115], v2, s[52:55], s16 offen offset:2048 sc1
    v_mfma_f32_16x16x32_bf16 v[72:75], a[88:91], v[144:147], v[72:75]
    v_mfma_f32_16x16x32_bf16 v[76:79], a[92:95], v[144:147], v[76:79]
    s_waitcnt vmcnt(10)
    v_mfma_f32_16x16x32_bf16 v[64:67], a[112:115], v[148:151], v[64:67]
    s_add_u32 s78, s16, 4096
    v_mfma_f32_16x16x32_bf16 v[68:71], a[116:119], v[148:151], v[68:71]
    buffer_load_dwordx4 v[116:119], v2, s[52:55], s78 offen offset:2048 sc1
    v_mfma_f32_16x16x32_bf16 v[72:75], a[120:123], v[148:151], v[72:75]
    v_mfma_f32_16x16x32_bf16 v[76:79], a[124:127], v[148:151], v[76:79]
    s_waitcnt vmcnt(10)
    v_mfma_f32_16x16x32_bf16 v[64:67], a[128:131], v[152:155], v[64:67]
    s_add_u32 s78, s16, 8192
    v_mfma_f32_16x16x32_bf16 v[68:71], a[132:135], v[152:155], v[68:71]
    buffer_load_dwordx4 v[120:123], v2, s[52:55], s78 offen offset:1024 sc1
    v_mfma_f32_16x16x32_bf16 v[72:75], a[136:139], v[152:155], v[72:75]
    v_mfma_f32_16x16x32_bf16 v[76:79], a[140:143], v[152:155], v[76:79]
    s_waitcnt vmcnt(7)
    v_mfma_f32_16x16x32_bf16 v[64:67], a[160:163], v[156:159], v[64:67]
    s_add_u32 s78, s16, 12288
    v_mfma_f32_16x16x32_bf16 v[68:71], a[164:167], v[156:159], v[68:71]
    buffer_load_dwordx4 v[124:127], v2, s[52:55], s78 offen offset:1024 sc1
    v_mfma_f32_16x16x32_bf16 v[72:75], a[168:171], v[156:159], v[72:75]
    v_mfma_f32_16x16x32_bf16 v[76:79], a[172:175], v[156:159], v[76:79]
    s_waitcnt vmcnt(7)
    v_mfma_f32_16x16x32_bf16 v[64:67], a[176:179], v[160:163], v[64:67]
    v_mfma_f32_16x16x32_bf16 v[68:71], a[180:183], v[160:163], v[68:71]
    buffer_load_dwordx4 v[128:131], v2, s[52:55], s17 offen offset:2048 sc1
    v_mfma_f32_16x16x32_bf16 v[72:75], a[184:187], v[160:163], v[72:75]
    v_mfma_f32_16x16x32_bf16 v[76:79], a[188:191], v[160:163], v[76:79]
    s_waitcnt vmcnt(7)
    v_mfma_f32_16x16x32_bf16 v[64:67], a[192:195], v[164:167], v[64:67]
    s_add_u32 s78, s17, 4096
    v_mfma_f32_16x16x32_bf16 v[68:71], a[196:199], v[164:167], v[68:71]
    buffer_load_dwordx4 v[132:135], v2, s[52:55], s78 offen offset:2048 sc1
    v_mfma_f32_16x16x32_bf16 v[72:75], a[200:203], v[164:167], v[72:75]
    v_mfma_f32_16x16x32_bf16 v[76:79], a[204:207], v[164:167], v[76:79]
    s_waitcnt vmcnt(7)
    v_mfma_f32_16x16x32_bf16 v[48:51], a[0:3], v[168:171], 0
    s_add_u32 s78, s17, 8192
    v_mfma_f32_16x16x32_bf16 v[52:55], a[4:7], v[168:171], 0
    buffer_load_dwordx4 v[136:139], v2, s[52:55], s78 offen offset:1024 sc1
    v_mfma_f32_16x16x32_bf16 v[56:59], a[8:11], v[168:171], 0
    v_mfma_f32_16x16x32_bf16 v[60:63], a[12:15], v[168:171], 0
    s_waitcnt vmcnt(7)
    v_mfma_f32_16x16x32_bf16 v[48:51], a[16:19], v[172:175], v[48:51]
    s_add_u32 s78, s17, 12288
    v_mfma_f32_16x16x32_bf16 v[52:55], a[20:23], v[172:175], v[52:55]
    buffer_load_dwordx4 v[140:143], v2, s[52:55], s78 offen offset:1024 sc1
    v_mfma_f32_16x16x32_bf16 v[56:59], a[24:27], v[172:175], v[56:59]
    v_mfma_f32_16x16x32_bf16 v[60:63], a[28:31], v[172:175], v[60:63]
    s_barrier
    s_waitcnt vmcnt(7)
    v_mfma_f32_16x16x32_bf16 v[16:19], a[32:35], v[112:115], v[16:19]
    v_mfma_f32_16x16x32_bf16 v[20:23], a[36:39], v[112:115], v[20:23]
    buffer_load_dwordx4 v[144:147], v2, s[52:55], s18 offen offset:2048 sc1
    v_mfma_f32_16x16x32_bf16 v[24:27], a[40:43], v[112:115], v[24:27]
    v_mfma_f32_16x16x32_bf16 v[28:31], a[44:47], v[112:115], v[28:31]
    s_waitcnt vmcnt(7)
    v_mfma_f32_16x16x32_bf16 v[16:19], a[96:99], v[116:119], v[16:19]
    s_add_u32 s78, s18, 4096
    v_mfma_f32_16x16x32_bf16 v[20:23], a[100:103], v[116:119], v[20:23]
    buffer_load_dwordx4 v[148:151], v2, s[52:55], s78 offen offset:2048 sc1
    v_mfma_f32_16x16x32_bf16 v[24:27], a[104:107], v[116:119], v[24:27]
    v_mfma_f32_16x16x32_bf16 v[28:31], a[108:111], v[116:119], v[28:31]
    s_waitcnt vmcnt(7)
    v_mfma_f32_16x16x32_bf16 v[16:19], a[144:147], v[120:123], v[16:19]
    s_add_u32 s78, s18, 8192
    v_mfma_f32_16x16x32_bf16 v[20:23], a[148:151], v[120:123], v[20:23]
    buffer_load_dwordx4 v[152:155], v2, s[52:55], s78 offen offset:1024 sc1
    v_mfma_f32_16x16x32_bf16 v[24:27], a[152:155], v[120:123], v[24:27]
    v_mfma_f32_16x16x32_bf16 v[28:31], a[156:159], v[120:123], v[28:31]
    s_waitcnt vmcnt(7)
    v_mfma_f32_16x16x32_bf16 v[16:19], a[208:211], v[124:127], v[16:19]
    s_add_u32 s78, s18, 12288
    v_mfma_f32_16x16x32_bf16 v[20:23], a[212:215], v[124:127], v[20:23]
    buffer_load_dwordx4 v[156:159], v2, s[52:55], s78 offen offset:1024 sc1
    v_mfma_f32_16x16x32_bf16 v[24:27], a[216:219], v[124:127], v[24:27]
    v_mfma_f32_16x16x32_bf16 v[28:31], a[220:223], v[124:127], v[28:31]
    s_waitcnt vmcnt(7)
    v_mfma_f32_16x16x32_bf16 v[32:35], a[32:35], v[128:131], v[32:35]
    v_mfma_f32_16x16x32_bf16 v[36:39], a[36:39], v[128:131], v[36:39]
    buffer_load_dword v160, v109, s[52:55], s19 offen offset:3072 sc1
    buffer_load_dword v161, v109, s[52:55], s19 offen offset:3328 sc1
    buffer_load_dword v162, v109, s[52:55], s19 offen offset:3584 sc1
    buffer_load_dword v163, v109, s[52:55], s19 offen offset:3840 sc1
    v_mfma_f32_16x16x32_bf16 v[40:43], a[40:43], v[128:131], v[40:43]
    v_mfma_f32_16x16x32_bf16 v[44:47], a[44:47], v[128:131], v[44:47]
    ds_write_b128 v6, v[16:19] offset:0
    s_waitcnt vmcnt(10)
    v_mfma_f32_16x16x32_bf16 v[32:35], a[96:99], v[132:135], v[32:35]
    s_add_u32 s78, s19, 4096
    v_mfma_f32_16x16x32_bf16 v[36:39], a[100:103], v[132:135], v[36:39]
    buffer_load_dwordx4 v[164:167], v2, s[52:55], s78 offen offset:0 sc1
    v_mfma_f32_16x16x32_bf16 v[40:43], a[104:107], v[132:135], v[40:43]
    v_mfma_f32_16x16x32_bf16 v[44:47], a[108:111], v[132:135], v[44:47]
    ds_write_b128 v6, v[20:23] offset:1024
    s_waitcnt vmcnt(10)
    v_mfma_f32_16x16x32_bf16 v[32:35], a[144:147], v[136:139], v[32:35]
    v_mfma_f32_16x16x32_bf16 v[36:39], a[148:151], v[136:139], v[36:39]
    buffer_load_dwordx4 v[168:171], v2, s[52:55], s78 offen offset:1024 sc1
    v_mfma_f32_16x16x32_bf16 v[40:43], a[152:155], v[136:139], v[40:43]
    v_mfma_f32_16x16x32_bf16 v[44:47], a[156:159], v[136:139], v[44:47]
    ds_write_b128 v6, v[24:27] offset:2048
    s_waitcnt vmcnt(10)
    v_mfma_f32_16x16x32_bf16 v[32:35], a[208:211], v[140:143], v[32:35]
    v_mfma_f32_16x16x32_bf16 v[36:39], a[212:215], v[140:143], v[36:39]
    buffer_load_dwordx4 v[172:175], v2, s[52:55], s78 offen offset:3072 sc1
    v_mfma_f32_16x16x32_bf16 v[40:43], a[216:219], v[140:143], v[40:43]
    v_mfma_f32_16x16x32_bf16 v[44:47], a[220:223], v[140:143], v[44:47]
    ds_write_b128 v6, v[28:31] offset:3072
    s_waitcnt vmcnt(10)
    v_mfma_f32_16x16x32_bf16 v[64:67], a[32:35], v[144:147], v[64:67]
    s_add_u32 s78, s19, 8192
    v_mfma_f32_16x16x32_bf16 v[68:71], a[36:39], v[144:147], v[68:71]
    buffer_load_dwordx4 v[112:115], v2, s[52:55], s78 offen offset:0 sc1
    v_mfma_f32_16x16x32_bf16 v[72:75], a[40:43], v[144:147], v[72:75]
    v_mfma_f32_16x16x32_bf16 v[76:79], a[44:47], v[144:147], v[76:79]
    ds_write_b128 v7, v[32:35] offset:0
    s_waitcnt vmcnt(10)
    v_mfma_f32_16x16x32_bf16 v[64:67], a[96:99], v[148:151], v[64:67]
    v_mfma_f32_16x16x32_bf16 v[68:71], a[100:103], v[148:151], v[68:71]
    buffer_load_dword v116, v109, s[52:55], s78 offen offset:2048 sc1
    buffer_load_dword v117, v109, s[52:55], s78 offen offset:2304 sc1
    buffer_load_dword v118, v109, s[52:55], s78 offen offset:2560 sc1
    buffer_load_dword v119, v109, s[52:55], s78 offen offset:2816 sc1
    v_mfma_f32_16x16x32_bf16 v[72:75], a[104:107], v[148:151], v[72:75]
    v_mfma_f32_16x16x32_bf16 v[76:79], a[108:111], v[148:151], v[76:79]
    ds_write_b128 v7, v[36:39] offset:1024
    s_waitcnt vmcnt(13)
    v_mfma_f32_16x16x32_bf16 v[64:67], a[144:147], v[152:155], v[64:67]
    v_mfma_f32_16x16x32_bf16 v[68:71], a[148:151], v[152:155], v[68:71]
    buffer_load_dwordx4 v[120:123], v2, s[52:55], s78 offen offset:3072 sc1
    v_mfma_f32_16x16x32_bf16 v[72:75], a[152:155], v[152:155], v[72:75]
    v_mfma_f32_16x16x32_bf16 v[76:79], a[156:159], v[152:155], v[76:79]
    ds_write_b128 v7, v[40:43] offset:2048
    s_waitcnt vmcnt(13)
    v_mfma_f32_16x16x32_bf16 v[64:67], a[208:211], v[156:159], v[64:67]
    s_add_u32 s78, s19, 12288
    v_mfma_f32_16x16x32_bf16 v[68:71], a[212:215], v[156:159], v[68:71]
    buffer_load_dwordx4 v[124:127], v2, s[52:55], s78 offen offset:0 sc1
    v_mfma_f32_16x16x32_bf16 v[72:75], a[216:219], v[156:159], v[72:75]
    v_mfma_f32_16x16x32_bf16 v[76:79], a[220:223], v[156:159], v[76:79]
    ds_write_b128 v7, v[44:47] offset:3072
    s_waitcnt vmcnt(10)
    v_mfma_f32_16x16x32_bf16 v[48:51], a[48:51], v[160:163], v[48:51]
    v_mfma_f32_16x16x32_bf16 v[52:55], a[52:55], v[160:163], v[52:55]
    buffer_load_dwordx4 v[128:131], v2, s[52:55], s19 offen offset:2048 sc1
    v_mfma_f32_16x16x32_bf16 v[56:59], a[56:59], v[160:163], v[56:59]
    v_mfma_f32_16x16x32_bf16 v[60:63], a[60:63], v[160:163], v[60:63]
    ds_write_b128 v8, v[64:67] offset:0
    s_waitcnt vmcnt(10)
    v_mfma_f32_16x16x32_bf16 v[48:51], a[64:67], v[164:167], v[48:51]
    s_add_u32 s78, s19, 4096
    v_mfma_f32_16x16x32_bf16 v[52:55], a[68:71], v[164:167], v[52:55]
    buffer_load_dwordx4 v[132:135], v2, s[52:55], s78 offen offset:2048 sc1
    v_mfma_f32_16x16x32_bf16 v[56:59], a[72:75], v[164:167], v[56:59]
    v_mfma_f32_16x16x32_bf16 v[60:63], a[76:79], v[164:167], v[60:63]
    ds_write_b128 v8, v[68:71] offset:1024
    s_waitcnt vmcnt(10)
    v_mfma_f32_16x16x32_bf16 v[48:51], a[80:83], v[168:171], v[48:51]
    s_add_u32 s78, s19, 8192
    v_mfma_f32_16x16x32_bf16 v[52:55], a[84:87], v[168:171], v[52:55]
    buffer_load_dwordx4 v[136:139], v2, s[52:55], s78 offen offset:1024 sc1
    v_mfma_f32_16x16x32_bf16 v[56:59], a[88:91], v[168:171], v[56:59]
    v_mfma_f32_16x16x32_bf16 v[60:63], a[92:95], v[168:171], v[60:63]
    ds_write_b128 v8, v[72:75] offset:2048
    s_waitcnt vmcnt(10)
    v_mfma_f32_16x16x32_bf16 v[48:51], a[112:115], v[172:175], v[48:51]
    s_add_u32 s78, s19, 12288
    v_mfma_f32_16x16x32_bf16 v[52:55], a[116:119], v[172:175], v[52:55]
    buffer_load_dwordx4 v[140:143], v2, s[52:55], s78 offen offset:1024 sc1
    v_mfma_f32_16x16x32_bf16 v[56:59], a[120:123], v[172:175], v[56:59]
    v_mfma_f32_16x16x32_bf16 v[60:63], a[124:127], v[172:175], v[60:63]
    ds_write_b128 v8, v[76:79] offset:3072
    s_waitcnt vmcnt(10)
    v_mfma_f32_16x16x32_bf16 v[48:51], a[128:131], v[112:115], v[48:51]
    v_mfma_f32_16x16x32_bf16 v[52:55], a[132:135], v[112:115], v[52:55]
    v_mfma_f32_16x16x32_bf16 v[56:59], a[136:139], v[112:115], v[56:59]
    v_mfma_f32_16x16x32_bf16 v[60:63], a[140:143], v[112:115], v[60:63]
    s_waitcnt vmcnt(6) lgkmcnt(0)
    s_barrier
    v_mfma_f32_16x16x32_bf16 v[48:51], a[160:163], v[116:119], v[48:51]
    ds_read_b128 v[16:19], v9 offset:0
    v_mfma_f32_16x16x32_bf16 v[52:55], a[164:167], v[116:119], v[52:55]
    ds_read_b128 v[20:23], v9 offset:1024
    v_mfma_f32_16x16x32_bf16 v[56:59], a[168:171], v[116:119], v[56:59]
    ds_read_b128 v[24:27], v9 offset:2048
    v_mfma_f32_16x16x32_bf16 v[60:63], a[172:175], v[116:119], v[60:63]
    ds_read_b128 v[28:31], v9 offset:3072
    s_waitcnt vmcnt(5)
    v_mfma_f32_16x16x32_bf16 v[48:51], a[176:179], v[120:123], v[48:51]
    ds_read_b128 v[32:35], v9 offset:4096
    v_mfma_f32_16x16x32_bf16 v[52:55], a[180:183], v[120:123], v[52:55]
    ds_read_b128 v[36:39], v9 offset:5120
    v_mfma_f32_16x16x32_bf16 v[56:59], a[184:187], v[120:123], v[56:59]
    ds_read_b128 v[40:43], v9 offset:6144
    v_mfma_f32_16x16x32_bf16 v[60:63], a[188:191], v[120:123], v[60:63]
    ds_read_b128 v[44:47], v9 offset:7168
    s_waitcnt vmcnt(4)
    v_mfma_f32_16x16x32_bf16 v[48:51], a[192:195], v[124:127], v[48:51]
    ds_read_b128 v[64:67], v11 offset:0
    v_mfma_f32_16x16x32_bf16 v[52:55], a[196:199], v[124:127], v[52:55]
    ds_read_b128 v[68:71], v11 offset:1024
    v_mfma_f32_16x16x32_bf16 v[56:59], a[200:203], v[124:127], v[56:59]
    ds_read_b128 v[72:75], v11 offset:2048
    v_mfma_f32_16x16x32_bf16 v[60:63], a[204:207], v[124:127], v[60:63]
    ds_read_b128 v[76:79], v11 offset:3072
    s_waitcnt vmcnt(3) lgkmcnt(4)
    v_mfma_f32_16x16x32_bf16 v[48:51], a[32:35], v[128:131], v[48:51]
    v_add_f32 v16, v16, v32
    v_add_f32 v17, v17, v33
    v_mfma_f32_16x16x32_bf16 v[52:55], a[36:39], v[128:131], v[52:55]
    v_add_f32 v18, v18, v34
    v_add_f32 v19, v19, v35
    v_mfma_f32_16x16x32_bf16 v[56:59], a[40:43], v[128:131], v[56:59]
    v_add_f32 v20, v20, v36
    v_add_f32 v21, v21, v37
    v_mfma_f32_16x16x32_bf16 v[60:63], a[44:47], v[128:131], v[60:63]
    v_add_f32 v22, v22, v38
    v_add_f32 v23, v23, v39
    s_waitcnt vmcnt(2)
    v_mfma_f32_16x16x32_bf16 v[48:51], a[96:99], v[132:135], v[48:51]
    v_add_f32 v24, v24, v40
    v_add_f32 v25, v25, v41
    v_mfma_f32_16x16x32_bf16 v[52:55], a[100:103], v[132:135], v[52:55]
    v_add_f32 v26, v26, v42
    v_add_f32 v27, v27, v43
    v_mfma_f32_16x16x32_bf16 v[56:59], a[104:107], v[132:135], v[56:59]
    v_add_f32 v28, v28, v44
    v_add_f32 v29, v29, v45
    v_mfma_f32_16x16x32_bf16 v[60:63], a[108:111], v[132:135], v[60:63]
    v_add_f32 v30, v30, v46
    v_add_f32 v31, v31, v47
    s_waitcnt vmcnt(1) lgkmcnt(0)
    v_mfma_f32_16x16x32_bf16 v[48:51], a[144:147], v[136:139], v[48:51]
    v_add_f32 v16, v16, v64
    v_add_f32 v17, v17, v65
    v_mfma_f32_16x16x32_bf16 v[52:55], a[148:151], v[136:139], v[52:55]
    v_add_f32 v18, v18, v66
    v_add_f32 v19, v19, v67
    v_mfma_f32_16x16x32_bf16 v[56:59], a[152:155], v[136:139], v[56:59]
    v_add_f32 v20, v20, v68
    v_add_f32 v21, v21, v69
    v_mfma_f32_16x16x32_bf16 v[60:63], a[156:159], v[136:139], v[60:63]
    v_add_f32 v22, v22, v70
    v_add_f32 v23, v23, v71
    s_waitcnt vmcnt(0)
    v_mfma_f32_16x16x32_bf16 v[48:51], a[208:211], v[140:143], v[48:51]
    v_add_f32 v24, v24, v72
    v_add_f32 v25, v25, v73
    v_mfma_f32_16x16x32_bf16 v[52:55], a[212:215], v[140:143], v[52:55]
    v_add_f32 v26, v26, v74
    v_add_f32 v27, v27, v75
    v_mfma_f32_16x16x32_bf16 v[56:59], a[216:219], v[140:143], v[56:59]
    v_add_f32 v28, v28, v76
    v_add_f32 v29, v29, v77
    v_mfma_f32_16x16x32_bf16 v[60:63], a[220:223], v[140:143], v[60:63]
    v_add_f32 v30, v30, v78
    v_add_f32 v31, v31, v79
    v_fmac_f32 v240, v16, v80
    v_fmac_f32 v241, v17, v81
    v_fmac_f32 v242, v18, v82
    v_fmac_f32 v243, v19, v83
    v_fmac_f32 v244, v20, v84
    v_fmac_f32 v245, v21, v85
    v_fmac_f32 v246, v22, v86
    v_fmac_f32 v247, v23, v87
    v_fmac_f32 v248, v24, v88
    v_fmac_f32 v249, v25, v89
    v_fmac_f32 v250, v26, v90
    v_fmac_f32 v251, v27, v91
    v_fmac_f32 v252, v28, v92
    v_fmac_f32 v253, v29, v93
    v_fmac_f32 v254, v30, v94
    v_fmac_f32 v255, v31, v95
    v_pk_fma_f32 v[240:241], v[48:49], v[80:81], v[240:241]
    v_pk_fma_f32 v[242:243], v[50:51], v[82:83], v[242:243]
    v_pk_fma_f32 v[244:245], v[52:53], v[84:85], v[244:245]
    v_pk_fma_f32 v[246:247], v[54:55], v[86:87], v[246:247]
    v_cvt_pk_bf16_f32 v16, v240, v241
    v_cvt_pk_bf16_f32 v17, v242, v243
    v_cvt_pk_bf16_f32 v18, v244, v245
    v_cvt_pk_bf16_f32 v19, v246, v247
    ds_write_b128 v13, v[16:19]
    v_pk_fma_f32 v[248:249], v[56:57], v[88:89], v[248:249]
    v_pk_fma_f32 v[250:251], v[58:59], v[90:91], v[250:251]
    v_pk_fma_f32 v[252:253], v[60:61], v[92:93], v[252:253]
    v_pk_fma_f32 v[254:255], v[62:63], v[94:95], v[254:255]
    v_cvt_pk_bf16_f32 v20, v248, v249
    v_cvt_pk_bf16_f32 v21, v250, v251
    v_cvt_pk_bf16_f32 v22, v252, v253
    v_cvt_pk_bf16_f32 v23, v254, v255
    ds_write_b128 v14, v[20:23]
    ds_read_b128 v[24:27], v9 offset:4096
    ds_read_b128 v[28:31], v9 offset:5120
    s_waitcnt lgkmcnt(1)
    buffer_store_dwordx4 v[24:27], v4, s[56:59], 0 offen sc1
    s_waitcnt lgkmcnt(0)
    buffer_store_dwordx4 v[28:31], v4, s[56:59], s77 offen sc1
    s_or_b32 s76, s75, s5
    s_cbranch_scc1 L_noep_37
    s_mov_b32 s78, 0
    s_mov_b64 exec, 1
    buffer_store_dword v3, off, s[52:55], s78
    s_mov_b64 exec, -1
L_noep_37:
L_exit:
    s_endpgm
L_localend:
L_fpretry_15:
    s_cselect_b32 s66, 1, 0
    s_mov_b32 s82, 0
L_pfp_38:
    buffer_load_dword v15, v126, s[52:55], 0 offen offset:0 sc1
    s_add_u32 s82, s82, 1
    s_waitcnt vmcnt(0)
    v_cmp_ne_u32 vcc, s68, v15
    s_nop 0
    s_and_b64 vcc, vcc, -1
    s_cbranch_scc0 L_dfp_39
    s_cmp_lt_u32 s82, 131072
    s_cbranch_scc1 L_pfp_38
L_dfp_39:
    s_cmp_lg_u32 s66, 0
    s_branch L_fpback_16
L_fb_19:
    s_min_u32 s79, s6, 8
    s_mov_b32 s92, 0x00110011
    s_mov_b32 s93, 0x00110011
    v_mov_b32 v10, 0x3f803f80
    v_cndmask_b32 v136, 0, v10, s[92:93]
    v_mov_b32 v137, v136
    v_mov_b32 v138, v136
    v_mov_b32 v139, v136
    v_mov_b32 v140, v136
    v_mov_b32 v141, v136
    v_mov_b32 v142, v136
    v_mov_b32 v143, v136
    v_mov_b32 v144, v136
    v_mov_b32 v145, v136
    v_mov_b32 v146, v136
    v_mov_b32 v147, v136
    v_mov_b32 v148, v136
    v_mov_b32 v149, v136
    v_mov_b32 v150, v136
    v_mov_b32 v151, v136
    s_mov_b32 s80, 0
    v_add_u32 v10, 32768, v119
    v_mov_b32 v11, 0xff800000
L_fl_40:
    ds_read_b128 v[128:131], v10 offset:0
    s_waitcnt lgkmcnt(0)
    v_mfma_f32_32x32x16_bf16 v[160:175], v[128:131], v[48:51], 0
    s_nop 15
    s_cmp_lg_u32 s80, 0
    s_cbranch_scc1 L_fnd_41
    v_add_f32 v160, v160, v16
    v_add_f32 v161, v161, v17
    v_add_f32 v162, v162, v18
    v_add_f32 v163, v163, v19
    v_add_f32 v164, v164, v20
    v_add_f32 v165, v165, v21
    v_add_f32 v166, v166, v22
    v_add_f32 v167, v167, v23
    v_add_f32 v168, v168, v24
    v_add_f32 v169, v169, v25
    v_add_f32 v170, v170, v26
    v_add_f32 v171, v171, v27
    v_add_f32 v172, v172, v28
    v_add_f32 v173, v173, v29
    v_add_f32 v174, v174, v30
    v_add_f32 v175, v175, v31
L_fnd_41:
    s_cmp_lg_u32 s80, 8
    s_cbranch_scc1 L_fnf_42
    v_add_f32 v160, v160, v32
    v_add_f32 v161, v161, v33
    v_add_f32 v162, v162, v34
    v_add_f32 v163, v163, v35
    v_add_f32 v164, v164, v36
    v_add_f32 v165, v165, v37
    v_add_f32 v166, v166, v38
    v_add_f32 v167, v167, v39
    v_add_f32 v168, v168, v40
    v_add_f32 v169, v169, v41
    v_add_f32 v170, v170, v42
    v_add_f32 v171, v171, v43
    v_add_f32 v172, v172, v44
    v_add_f32 v173, v173, v45
    v_add_f32 v174, v174, v46
    v_add_f32 v175, v175, v47
L_fnf_42:
    v_max3_f32 v11, v11, v160, v161
    v_max3_f32 v11, v11, v162, v163
    v_max3_f32 v11, v11, v164, v165
    v_max3_f32 v11, v11, v166, v167
    v_max3_f32 v11, v11, v168, v169
    v_max3_f32 v11, v11, v170, v171
    v_max3_f32 v11, v11, v172, v173
    v_max3_f32 v11, v11, v174, v175
    v_subrev_u32 v10, 4096, v10
    s_add_u32 s80, s80, 1
    s_cmp_le_u32 s80, s79
    s_cbranch_scc1 L_fl_40
    v_mov_b32 v12, v11
    s_nop 1
    v_permlane32_swap_b32 v11, v12
    v_max_f32 v11, v11, v12
    s_mov_b32 s80, 0
    v_add_u32 v10, 32768, v119
    v_mov_b32 v208, 0
    v_mov_b32 v209, 0
    v_mov_b32 v210, 0
    v_mov_b32 v211, 0
    v_mov_b32 v212, 0
    v_mov_b32 v213, 0
    v_mov_b32 v214, 0
    v_mov_b32 v215, 0
    v_mov_b32 v216, 0
    v_mov_b32 v217, 0
    v_mov_b32 v218, 0
    v_mov_b32 v219, 0
    v_mov_b32 v220, 0
    v_mov_b32 v221, 0
    v_mov_b32 v222, 0
    v_mov_b32 v223, 0
L_fl_43:
    ds_read_b128 v[128:131], v10 offset:0
    s_mov_b64 exec, s[86:87]
    ds_read_b128 v[136:139], v10 offset:2048
    ds_read_b128 v[140:143], v10 offset:3072
    s_mov_b64 exec, -1
    s_waitcnt lgkmcnt(0)
    v_mfma_f32_32x32x16_bf16 v[160:175], v[128:131], v[48:51], 0
    s_nop 15
    s_cmp_lg_u32 s80, 0
    s_cbranch_scc1 L_fnd_44
    v_add_f32 v160, v160, v16
    v_add_f32 v161, v161, v17
    v_add_f32 v162, v162, v18
    v_add_f32 v163, v163, v19
    v_add_f32 v164, v164, v20
    v_add_f32 v165, v165, v21
    v_add_f32 v166, v166, v22
    v_add_f32 v167, v167, v23
    v_add_f32 v168, v168, v24
    v_add_f32 v169, v169, v25
    v_add_f32 v170, v170, v26
    v_add_f32 v171, v171, v27
    v_add_f32 v172, v172, v28
    v_add_f32 v173, v173, v29
    v_add_f32 v174, v174, v30
    v_add_f32 v175, v175, v31
L_fnd_44:
    s_cmp_lg_u32 s80, 8
    s_cbranch_scc1 L_fnf_45
    v_add_f32 v160, v160, v32
    v_add_f32 v161, v161, v33
    v_add_f32 v162, v162, v34
    v_add_f32 v163, v163, v35
    v_add_f32 v164, v164, v36
    v_add_f32 v165, v165, v37
    v_add_f32 v166, v166, v38
    v_add_f32 v167, v167, v39
    v_add_f32 v168, v168, v40
    v_add_f32 v169, v169, v41
    v_add_f32 v170, v170, v42
    v_add_f32 v171, v171, v43
    v_add_f32 v172, v172, v44
    v_add_f32 v173, v173, v45
    v_add_f32 v174, v174, v46
    v_add_f32 v175, v175, v47
L_fnf_45:
    v_sub_f32 v160, v160, v11
    v_sub_f32 v161, v161, v11
    v_sub_f32 v162, v162, v11
    v_sub_f32 v163, v163, v11
    v_sub_f32 v164, v164, v11
    v_sub_f32 v165, v165, v11
    v_sub_f32 v166, v166, v11
    v_sub_f32 v167, v167, v11
    v_sub_f32 v168, v168, v11
    v_sub_f32 v169, v169, v11
    v_sub_f32 v170, v170, v11
    v_sub_f32 v171, v171, v11
    v_sub_f32 v172, v172, v11
    v_sub_f32 v173, v173, v11
    v_sub_f32 v174, v174, v11
    v_sub_f32 v175, v175, v11
    v_exp_f32 v160, v160
    v_exp_f32 v161, v161
    v_exp_f32 v162, v162
    v_exp_f32 v163, v163
    v_exp_f32 v164, v164
    v_exp_f32 v165, v165
    v_exp_f32 v166, v166
    v_exp_f32 v167, v167
    v_exp_f32 v168, v168
    v_exp_f32 v169, v169
    v_exp_f32 v170, v170
    v_exp_f32 v171, v171
    v_exp_f32 v172, v172
    v_exp_f32 v173, v173
    v_exp_f32 v174, v174
    v_exp_f32 v175, v175
    v_cvt_pk_bf16_f32 v192, v160, v161
    v_cvt_pk_bf16_f32 v193, v162, v163
    v_cvt_pk_bf16_f32 v194, v164, v165
    v_cvt_pk_bf16_f32 v195, v166, v167
    v_cvt_pk_bf16_f32 v196, v168, v169
    v_cvt_pk_bf16_f32 v197, v170, v171
    v_cvt_pk_bf16_f32 v198, v172, v173
    v_cvt_pk_bf16_f32 v199, v174, v175
    v_mfma_f32_32x32x16_bf16 v[208:223], v[136:139], v[192:195], v[208:223]
    s_nop 0
    v_mfma_f32_32x32x16_bf16 v[208:223], v[140:143], v[196:199], v[208:223]
    s_nop 15
    v_subrev_u32 v10, 4096, v10
    s_add_u32 s80, s80, 1
    s_cmp_le_u32 s80, s79
    s_cbranch_scc1 L_fl_43
    s_mov_b32 s80, 0
    v_add_u32 v10, 32768, v119
    v_mov_b32 v11, 0xff800000
L_fl_46:
    ds_read_b128 v[128:131], v10 offset:1024
    s_waitcnt lgkmcnt(0)
    v_mfma_f32_32x32x16_bf16 v[160:175], v[128:131], v[52:55], 0
    s_nop 15
    s_cmp_lg_u32 s80, 0
    s_cbranch_scc1 L_fnd_47
    v_add_f32 v160, v160, v16
    v_add_f32 v161, v161, v17
    v_add_f32 v162, v162, v18
    v_add_f32 v163, v163, v19
    v_add_f32 v164, v164, v20
    v_add_f32 v165, v165, v21
    v_add_f32 v166, v166, v22
    v_add_f32 v167, v167, v23
    v_add_f32 v168, v168, v24
    v_add_f32 v169, v169, v25
    v_add_f32 v170, v170, v26
    v_add_f32 v171, v171, v27
    v_add_f32 v172, v172, v28
    v_add_f32 v173, v173, v29
    v_add_f32 v174, v174, v30
    v_add_f32 v175, v175, v31
L_fnd_47:
    s_cmp_lg_u32 s80, 8
    s_cbranch_scc1 L_fnf_48
    v_add_f32 v160, v160, v32
    v_add_f32 v161, v161, v33
    v_add_f32 v162, v162, v34
    v_add_f32 v163, v163, v35
    v_add_f32 v164, v164, v36
    v_add_f32 v165, v165, v37
    v_add_f32 v166, v166, v38
    v_add_f32 v167, v167, v39
    v_add_f32 v168, v168, v40
    v_add_f32 v169, v169, v41
    v_add_f32 v170, v170, v42
    v_add_f32 v171, v171, v43
    v_add_f32 v172, v172, v44
    v_add_f32 v173, v173, v45
    v_add_f32 v174, v174, v46
    v_add_f32 v175, v175, v47
L_fnf_48:
    v_max3_f32 v11, v11, v160, v161
    v_max3_f32 v11, v11, v162, v163
    v_max3_f32 v11, v11, v164, v165
    v_max3_f32 v11, v11, v166, v167
    v_max3_f32 v11, v11, v168, v169
    v_max3_f32 v11, v11, v170, v171
    v_max3_f32 v11, v11, v172, v173
    v_max3_f32 v11, v11, v174, v175
    v_subrev_u32 v10, 4096, v10
    s_add_u32 s80, s80, 1
    s_cmp_le_u32 s80, s79
    s_cbranch_scc1 L_fl_46
    v_mov_b32 v12, v11
    s_nop 1
    v_permlane32_swap_b32 v11, v12
    v_max_f32 v11, v11, v12
    s_mov_b32 s80, 0
    v_add_u32 v10, 32768, v119
    v_mov_b32 v224, 0
    v_mov_b32 v225, 0
    v_mov_b32 v226, 0
    v_mov_b32 v227, 0
    v_mov_b32 v228, 0
    v_mov_b32 v229, 0
    v_mov_b32 v230, 0
    v_mov_b32 v231, 0
    v_mov_b32 v232, 0
    v_mov_b32 v233, 0
    v_mov_b32 v234, 0
    v_mov_b32 v235, 0
    v_mov_b32 v236, 0
    v_mov_b32 v237, 0
    v_mov_b32 v238, 0
    v_mov_b32 v239, 0
L_fl_49:
    ds_read_b128 v[128:131], v10 offset:1024
    s_mov_b64 exec, s[88:89]
    ds_read_b128 v[144:147], v10 offset:2048
    ds_read_b128 v[148:151], v10 offset:3072
    s_mov_b64 exec, -1
    s_waitcnt lgkmcnt(0)
    v_mfma_f32_32x32x16_bf16 v[160:175], v[128:131], v[52:55], 0
    s_nop 15
    s_cmp_lg_u32 s80, 0
    s_cbranch_scc1 L_fnd_50
    v_add_f32 v160, v160, v16
    v_add_f32 v161, v161, v17
    v_add_f32 v162, v162, v18
    v_add_f32 v163, v163, v19
    v_add_f32 v164, v164, v20
    v_add_f32 v165, v165, v21
    v_add_f32 v166, v166, v22
    v_add_f32 v167, v167, v23
    v_add_f32 v168, v168, v24
    v_add_f32 v169, v169, v25
    v_add_f32 v170, v170, v26
    v_add_f32 v171, v171, v27
    v_add_f32 v172, v172, v28
    v_add_f32 v173, v173, v29
    v_add_f32 v174, v174, v30
    v_add_f32 v175, v175, v31
L_fnd_50:
    s_cmp_lg_u32 s80, 8
    s_cbranch_scc1 L_fnf_51
    v_add_f32 v160, v160, v32
    v_add_f32 v161, v161, v33
    v_add_f32 v162, v162, v34
    v_add_f32 v163, v163, v35
    v_add_f32 v164, v164, v36
    v_add_f32 v165, v165, v37
    v_add_f32 v166, v166, v38
    v_add_f32 v167, v167, v39
    v_add_f32 v168, v168, v40
    v_add_f32 v169, v169, v41
    v_add_f32 v170, v170, v42
    v_add_f32 v171, v171, v43
    v_add_f32 v172, v172, v44
    v_add_f32 v173, v173, v45
    v_add_f32 v174, v174, v46
    v_add_f32 v175, v175, v47
L_fnf_51:
    v_sub_f32 v160, v160, v11
    v_sub_f32 v161, v161, v11
    v_sub_f32 v162, v162, v11
    v_sub_f32 v163, v163, v11
    v_sub_f32 v164, v164, v11
    v_sub_f32 v165, v165, v11
    v_sub_f32 v166, v166, v11
    v_sub_f32 v167, v167, v11
    v_sub_f32 v168, v168, v11
    v_sub_f32 v169, v169, v11
    v_sub_f32 v170, v170, v11
    v_sub_f32 v171, v171, v11
    v_sub_f32 v172, v172, v11
    v_sub_f32 v173, v173, v11
    v_sub_f32 v174, v174, v11
    v_sub_f32 v175, v175, v11
    v_exp_f32 v160, v160
    v_exp_f32 v161, v161
    v_exp_f32 v162, v162
    v_exp_f32 v163, v163
    v_exp_f32 v164, v164
    v_exp_f32 v165, v165
    v_exp_f32 v166, v166
    v_exp_f32 v167, v167
    v_exp_f32 v168, v168
    v_exp_f32 v169, v169
    v_exp_f32 v170, v170
    v_exp_f32 v171, v171
    v_exp_f32 v172, v172
    v_exp_f32 v173, v173
    v_exp_f32 v174, v174
    v_exp_f32 v175, v175
    v_cvt_pk_bf16_f32 v192, v160, v161
    v_cvt_pk_bf16_f32 v193, v162, v163
    v_cvt_pk_bf16_f32 v194, v164, v165
    v_cvt_pk_bf16_f32 v195, v166, v167
    v_cvt_pk_bf16_f32 v196, v168, v169
    v_cvt_pk_bf16_f32 v197, v170, v171
    v_cvt_pk_bf16_f32 v198, v172, v173
    v_cvt_pk_bf16_f32 v199, v174, v175
    v_mfma_f32_32x32x16_bf16 v[224:239], v[144:147], v[192:195], v[224:239]
    s_nop 0
    v_mfma_f32_32x32x16_bf16 v[224:239], v[148:151], v[196:199], v[224:239]
    s_nop 15
    v_subrev_u32 v10, 4096, v10
    s_add_u32 s80, s80, 1
    s_cmp_le_u32 s80, s79
    s_cbranch_scc1 L_fl_49
    v_rcp_f32 v10, v216
    v_rcp_f32 v12, v224
    s_nop 1
    s_branch L_attok_20
L_xcslow:
    s_mov_b32 s82, 0
L_xc1:
    buffer_load_dword v58, v157, s[52:55], 0 offen sc1
    s_add_u32 s82, s82, 1
    s_waitcnt vmcnt(0)
    v_cmp_ne_u32 vcc, s83, v58
    s_cbranch_vccz L_local
    s_cmp_lt_u32 s82, 32
    s_cbranch_scc1 L_xc1
    s_lshl_b32 s76, s75, 6
    s_add_u32 s76, s76, 32768
    s_mov_b64 exec, 1
    buffer_store_dword v147, off, s[52:55], s76 sc1
    s_mov_b64 exec, -1
    s_lshl_b32 s76, s3, 11
    s_add_u32 s76, s76, 32768
    v_lshl_add_u32 v59, v151, 6, s76
    buffer_load_dword v57, v59, s[52:55], 0 offen sc1
    s_waitcnt vmcnt(0)
    v_cmp_ne_u32 vcc, s83, v57
    s_cbranch_vccz L_local
    s_add_u32 s76, s68, 1
    v_subrev_u32 v56, s76, v57
    v_cmp_le_u32 vcc, 16, v56
    s_cbranch_vccz L_remote
    s_cmp_lt_u32 s82, 131072
    s_cbranch_scc1 L_xc1
L_remote:
    ds_write_b128 v158, v[44:47]
    s_add_u32 s79, s100, 4096
    s_waitcnt lgkmcnt(0)
    ds_read_b128 v[64:67], v159 offset:0
    ds_read_b128 v[68:71], v159 offset:512
    ds_read_b128 v[72:75], v159 offset:16
    ds_read_b128 v[76:79], v159 offset:528
    ds_read_b128 v[80:83], v159 offset:256
    ds_read_b128 v[84:87], v159 offset:768
    ds_read_b128 v[88:91], v159 offset:272
    ds_read_b128 v[92:95], v159 offset:784
    s_waitcnt lgkmcnt(6)
    v_pk_fma_f32 v[24:25], v[24:25], v[68:69], v[64:65]
    v_pk_fma_f32 v[26:27], v[26:27], v[70:71], v[66:67]
    v_cvt_pk_bf16_f32 v16, v24, v25
    v_cvt_pk_bf16_f32 v17, v26, v27
    s_waitcnt lgkmcnt(4)
    v_pk_fma_f32 v[28:29], v[28:29], v[76:77], v[72:73]
    v_pk_fma_f32 v[30:31], v[30:31], v[78:79], v[74:75]
    v_cvt_pk_bf16_f32 v18, v28, v29
    v_cvt_pk_bf16_f32 v19, v30, v31
    buffer_store_dwordx4 v[16:19], v146, s[52:55], s100 offen sc1
    s_waitcnt lgkmcnt(2)
    v_pk_fma_f32 v[32:33], v[32:33], v[84:85], v[80:81]
    v_pk_fma_f32 v[34:35], v[34:35], v[86:87], v[82:83]
    v_cvt_pk_bf16_f32 v20, v32, v33
    v_cvt_pk_bf16_f32 v21, v34, v35
    s_waitcnt lgkmcnt(0)
    v_pk_fma_f32 v[36:37], v[36:37], v[92:93], v[88:89]
    v_pk_fma_f32 v[38:39], v[38:39], v[94:95], v[90:91]
    v_cvt_pk_bf16_f32 v22, v36, v37
    v_cvt_pk_bf16_f32 v23, v38, v39
    buffer_store_dwordx4 v[20:23], v146, s[52:55], s79 offen sc1
    s_add_u32 m0, s1, 1024
    s_add_u32 s0, s0, 49152
    buffer_load_dwordx4 v96, s[36:39], s0 offen lds
    s_add_u32 m0, s1, 2048
    s_add_u32 s0, s0, 49152
    buffer_load_dwordx4 v96, s[36:39], s0 offen lds
    s_add_u32 m0, s1, 3072
    s_add_u32 s0, s0, 49152
    buffer_load_dwordx4 v96, s[36:39], s0 offen lds
    s_lshl4_add_u32 s76, s6, s7
    s_lshl_b32 s77, s76, 6
    s_add_u32 s8, s77, 65536
    s_lshl_b32 s77, s76, 12
    s_add_u32 s20, s77, 10485760
    s_sub_u32 s24, s76, 64
    s_max_i32 s24, s24, 0
    s_sub_u32 s25, s76, 128
    s_max_i32 s25, s25, 0
    v_mov_b32 v120, s24
    v_writelane_b32 v120, s25, 1
    v_lshlrev_b32 v120, 6, v120
    v_add_u32 v120, 65536, v120
    s_lshl_b32 s24, s24, 12
    s_add_u32 s24, s24, 10485760
    s_lshl_b32 s25, s25, 12
    s_add_u32 s25, s25, 10485760
    s_cmp_ge_u32 s6, 4
    s_cselect_b32 s98, 1, 0
    s_cselect_b32 s77, 0, 0x40000000
    v_add_u32 v121, s77, v2
    s_cmp_ge_u32 s6, 8
    s_cselect_b32 s98, 3, s98
    s_cselect_b32 s77, 0, 0x40000000
    v_add_u32 v122, s77, v2
    s_mov_b32 s99, 0
    s_lshl_b32 s77, s6, 6
    s_add_u32 s77, s77, s7
    s_lshl2_add_u32 s9, s77, 4160
    s_add_u32 s15, s9, 128
    s_lshr_b32 s77, s73, 1
    s_lshl_b32 s77, s77, 5
    s_add_u32 s77, s77, s70
    s_and_b32 s78, s73, 1
    s_lshl1_add_u32 s77, s77, s78
    s_lshl2_add_u32 s14, s77, 4224
    s_lshl_b32 s77, s6, 15
    s_add_u32 s28, s77, 8388608
    s_add_u32 s29, s77, 8404992
    s_lshl_b32 s78, s7, 10
    s_add_u32 s77, s77, s78
    s_add_u32 s21, s77, 6291456
    s_lshl3_add_u32 s77, s73, s70
    s_lshl_b32 s78, s77, 11
    s_add_u32 s22, s78, 8388608
    s_lshl_b32 s78, s77, 7
    s_add_u32 s23, s78, 524288
    s_lshl_b32 s78, s6, 11
    s_add_u32 s30, s78, 524288
    s_lshr_b32 s77, s7, 1
    s_lshl4_add_u32 s77, s6, s77
    s_mul_i32 s77, s77, 7168
    s_add_u32 s26, s77, 14680064
    s_add_u32 s27, s77, 14737408
    s_lshl3_add_u32 s77, s74, s5
    s_waitcnt vmcnt(3)
    s_mov_b64 exec, 1
    buffer_store_dword v3, off, s[52:55], s80 sc1
    s_mov_b64 exec, -1
    s_bitcmp1_b32 s64, 31
    s_cbranch_scc1 L_norole_52
    s_lshl_b32 s65, s5, 12
    s_add_u32 m0, s65, 98304
    s_nop 0
    buffer_load_dwordx4 v97, s[48:51], s2 offen nt lds
    s_lshl_b32 s65, s5, 12
    s_add_u32 m0, s65, 99328
    s_add_u32 s2, s2, 8192
    buffer_load_dwordx4 v97, s[48:51], s2 offen nt lds
    s_lshl_b32 s65, s5, 12
    s_add_u32 m0, s65, 100352
    s_add_u32 s2, s2, 8192
    buffer_load_dwordx4 v97, s[48:51], s2 offen nt lds
    s_lshl_b32 s65, s5, 12
    s_add_u32 m0, s65, 101376
    s_add_u32 s2, s2, 8192
    buffer_load_dwordx4 v97, s[48:51], s2 offen nt lds
L_norole_52:
    s_add_u32 s78, s72, 1
    s_and_b32 s78, s78, 3
    s_lshl2_add_u32 s78, s78, s77
    s_lshl_b32 s79, s78, 12
    s_add_u32 s10, s79, 6291456
    s_mul_i32 s79, s78, 14336
    s_add_u32 s16, s79, 14680064
    s_add_u32 s78, s72, 2
    s_and_b32 s78, s78, 3
    s_lshl2_add_u32 s78, s78, s77
    s_lshl_b32 s79, s78, 12
    s_add_u32 s11, s79, 6291456
    s_mul_i32 s79, s78, 14336
    s_add_u32 s17, s79, 14680064
    s_add_u32 s78, s72, 3
    s_and_b32 s78, s78, 3
    s_lshl2_add_u32 s78, s78, s77
    s_lshl_b32 s79, s78, 12
    s_add_u32 s12, s79, 6291456
    s_mul_i32 s79, s78, 14336
    s_add_u32 s18, s79, 14680064
    s_add_u32 s78, s72, 4
    s_and_b32 s78, s78, 3
    s_lshl2_add_u32 s78, s78, s77
    s_lshl_b32 s79, s78, 12
    s_add_u32 s13, s79, 6291456
    s_mul_i32 s79, s78, 14336
    s_add_u32 s19, s79, 14680064
    s_lshl2_add_u32 s77, s70, s5
    s_lshl_b32 s78, s77, 14
    s_add_u32 s96, s78, 1048576
    s_mul_i32 s78, s77, 57344
    s_add_u32 s101, s78, 2097152
    s_lshr_b32 s77, s5, 1
    s_and_b32 s78, s5, 1
    s_lshl3_add_u32 s77, s77, s78
    s_lshl_b32 s77, s77, 7
    s_add_u32 s77, s77, s7
    s_mul_i32 s62, s77, 224
    s_mul_i32 s63, s5, 7168
    s_lshl_b32 s77, s5, 2
    s_lshl_b32 s60, 15, s77
    s_mov_b32 s61, s60
    s_lshl_b32 s77, s5, 12
    s_add_u32 s77, s77, 114688
    v_add_u32 v119, s77, v2
    v_writelane_b32 v10, s8, 33
    v_writelane_b32 v10, s67, 34
    s_mov_b32 exec_lo, 0x0
    s_mov_b32 exec_hi, 0x6
    buffer_load_dword v154, v10, s[52:55], 0 offen sc1
    s_mov_b64 exec, -1
    v_and_b32 v12, 15, v1
    v_lshrrev_b32 v15, 4, v1
    s_lshl_b32 s76, s73, 14
    s_lshl_b32 s77, s70, 7
    s_add_u32 s76, s76, s77
    v_lshrrev_b32 v11, 3, v1
    v_lshl_add_u32 v10, v11, 10, s76
    v_xor_b32 v11, v11, v148
    v_lshl_add_u32 v4, v11, 4, v10
    s_add_u32 s77, s77, 115712
    v_lshl_add_u32 v127, v15, 5, s77
    s_mov_b32 s77, 116736
    v_lshl_add_u32 v5, v15, 6, s77
    s_mov_b32 s77, 118784
    v_lshl_add_u32 v102, v15, 4, s77
    s_lshl_b32 s76, s5, 10
    s_add_u32 s77, s76, 333824
    v_add_u32 v124, s77, v2
    s_lshr_b32 s76, s76, 1
    s_add_u32 s77, s76, 114688
    v_lshl_add_u32 v110, v1, 3, s77
    v_bfe_u32 v11, v1, 3, 1
    v_lshl_add_u32 v10, v15, 1, v11
    v_mul_u32_u24 v10, 6144, v10
    v_lshl_add_u32 v10, v148, 4, v10
    s_and_b32 s76, s5, 1
    s_lshl1_add_u32 s77, s70, s76
    s_lshl_b32 s77, s77, 7
    s_add_u32 s77, s77, 331776
    v_add_u32 v125, s77, v10
    s_lshl_b32 s76, s76, 7
    s_add_u32 s76, s76, 116736
    v_lshl_add_u32 v10, v11, 8, s76
    v_lshl_add_u32 v10, v148, 4, v10
    v_lshrrev_b32 v11, 5, v1
    v_lshl_add_u32 v10, v11, 2, v10
    v_and_b32 v15, 1, v15
    v_lshl_add_u32 v111, v15, 3, v10
    v_lshlrev_b32 v10, 4, v12
    v_lshl_add_u32 v10, v15, 14, v10
    v_lshl_add_u32 v123, v11, 8, v10
    v_lshlrev_b32 v10, 2, v12
    v_lshl_add_u32 v105, v11, 6, v10
    v_lshl_add_u32 v106, v15, 10, v105
    s_lshl_b32 s76, s74, 8
    s_add_u32 s76, s76, 4096
    v_lshl_add_u32 v10, v11, 7, s76
    v_lshl_add_u32 v104, v1, 2, v10
    v_bfe_u32 v10, v1, 2, 3
    v_lshl_add_u32 v10, v11, 4, v10
    v_mul_u32_u24 v10, 224, v10
    v_and_b32 v11, 3, v1
    v_lshl_add_u32 v100, v11, 3, v10
    v_add_u32 v101, 57344, v100
    s_and_b32 s76, s7, 1
    s_lshl_b32 s77, s76, 12
    v_add_u32 v107, s77, v2
    s_lshl_b32 s77, s76, 9
    v_lshlrev_b32 v109, 2, v1
    v_add_u32 v108, s77, v109
    s_add_u32 s76, s5, 1
    s_and_b32 s76, s76, 3
    s_lshl_b32 s76, s76, 13
    s_add_u32 s76, s76, 122880
    v_add_u32 v6, s76, v2
    s_add_u32 s76, s5, 2
    s_and_b32 s76, s76, 3
    s_lshl_b32 s76, s76, 13
    s_add_u32 s76, s76, 126976
    v_add_u32 v7, s76, v2
    s_add_u32 s76, s5, 3
    s_and_b32 s76, s76, 3
    s_lshl_b32 s76, s76, 13
    s_add_u32 s76, s76, 122880
    v_add_u32 v8, s76, v2
    s_add_u32 s76, s5, 4
    s_and_b32 s76, s76, 3
    s_lshl_b32 s76, s76, 13
    s_add_u32 s76, s76, 122880
    v_add_u32 v9, s76, v2
    s_mul_i32 s76, s5, 14
    v_min_u32 v10, 13, v12
    v_add_u32 v10, s76, v10
    s_lshl2_add_u32 s76, s5, 56
    v_and_b32 v11, 3, v1
    v_add_u32 v11, s76, v11
    v_cndmask_b32 v10, v11, v10, s[84:85]
    s_lshl_b32 s76, s70, 13
    s_add_u32 s76, s76, 196608
    v_lshl_add_u32 v10, v10, 6, s76
    s_mov_b32 s76, 65536
    v_lshl_add_u32 v11, v148, 13, s76
    s_or_b32 s76, s75, s5
    s_min_u32 s76, s76, 1
    s_sub_u32 s76, s76, 1
    s_and_b32 s93, s76, 0xff
    s_mov_b32 s92, 0
    v_cndmask_b32 v126, v10, v11, s[92:93]
    s_and_b32 s80, s7, 1
    s_lshl_b32 s80, s80, 1
    buffer_load_dword v15, v103, s[52:55], 0 offen offset:0 sc1
    s_lshl3_add_u32 s65, s5, s69
    s_mul_i32 s0, s65, 49152
    s_lshl_b32 s1, s65, 10
    s_add_u32 s1, s1, 65536
    s_add_u32 m0, s1, 0
    s_nop 0
    buffer_load_dwordx4 v96, s[36:39], s0 offen lds
    s_add_u32 m0, s1, 1024
    s_add_u32 s0, s0, 49152
    buffer_load_dwordx4 v96, s[36:39], s0 offen lds
    s_waitcnt vmcnt(2)
    v_cmp_ne_u32 vcc, s68, v15
    s_nop 0
    s_and_b64 vcc, vcc, s[84:85]
    s_cbranch_scc0 L_qh_54
    s_mov_b32 s82, 0
L_ph_55:
    buffer_load_dword v15, v103, s[52:55], 0 offen offset:0 sc1
    s_add_u32 s82, s82, 1
    s_waitcnt vmcnt(0)
    v_cmp_ne_u32 vcc, s68, v15
    s_nop 0
    s_and_b64 vcc, vcc, s[84:85]
    s_cbranch_scc0 L_dh_56
    s_cmp_lt_u32 s82, 131072
    s_cbranch_scc1 L_ph_55
L_dh_56:
L_qh_54:
    buffer_load_dwordx4 v[128:131], v2, s[52:55], s31 offen offset:0 sc1
    buffer_load_dwordx4 v[132:135], v2, s[52:55], s31 offen offset:1024 sc1
    buffer_load_dwordx4 v[136:139], v2, s[52:55], s31 offen offset:2048 sc1
    buffer_load_dwordx4 v[140:143], v2, s[52:55], s31 offen offset:3072 sc1
    s_add_u32 s31, s31, 4096
    buffer_load_dwordx4 v[144:147], v2, s[52:55], s31 offen offset:0 sc1
    buffer_load_dwordx4 v[148:151], v2, s[52:55], s31 offen offset:1024 sc1
    buffer_load_dwordx4 v[152:155], v2, s[52:55], s31 offen offset:2048 sc1
    buffer_load_dwordx4 v[156:159], v2, s[52:55], s31 offen offset:3072 sc1
    s_add_u32 s31, s31, 4096
    buffer_load_dwordx4 v[160:163], v2, s[52:55], s31 offen offset:0 sc1
    buffer_load_dwordx4 v[164:167], v2, s[52:55], s31 offen offset:1024 sc1
    s_barrier
    ds_read_b64_tr_b16 v[64:65], v13 offset:0
    ds_read_b64_tr_b16 v[66:67], v13 offset:256
    ds_read_b64_tr_b16 v[68:69], v13 offset:32768
    ds_read_b64_tr_b16 v[70:71], v13 offset:33024
    ds_read_b64_tr_b16 v[72:73], v13 offset:1024
    ds_read_b64_tr_b16 v[74:75], v13 offset:1280
    ds_read_b64_tr_b16 v[76:77], v13 offset:33792
    ds_read_b64_tr_b16 v[78:79], v13 offset:34048
    ds_read_b64_tr_b16 v[80:81], v13 offset:2048
    ds_read_b64_tr_b16 v[82:83], v13 offset:2304
    ds_read_b64_tr_b16 v[84:85], v13 offset:34816
    ds_read_b64_tr_b16 v[86:87], v13 offset:35072
    v_add_u32 v10, 0, v1
    v_mul_u32_u24 v11, 4682, v10
    v_lshrrev_b32 v11, 16, v11
    v_mad_i32_i24 v10, v11, -14, v10
    v_add_u32 v10, s80, v10
    v_subrev_u32 v12, 14, v10
    v_min_u32 v10, v10, v12
    v_and_b32 v12, 4, v11
    v_mad_u32_u24 v12, v12, 3, v11
    v_and_b32 v15, 16, v11
    v_add_u32 v12, v12, v15
    v_bfe_u32 v15, v11, 3, 1
    s_waitcnt vmcnt(9) lgkmcnt(8)
    v_mfma_f32_32x32x16_bf16 v[16:31], v[64:67], v[128:131], 0
    buffer_load_dwordx4 v[168:171], v2, s[52:55], s31 offen offset:2048 sc1
    ds_read_b64_tr_b16 v[88:89], v13 offset:3072
    ds_read_b64_tr_b16 v[90:91], v13 offset:3328
    v_mad_i32_i24 v12, v15, -4, v12
    v_mfma_f32_32x32x16_bf16 v[32:47], v[128:131], v[68:71], 0
    ds_read_b64_tr_b16 v[92:93], v13 offset:35840
    ds_read_b64_tr_b16 v[94:95], v13 offset:36096
    v_mul_u32_u24 v12, 3584, v12
    v_lshl_add_u32 v112, v10, 4, v12
    s_waitcnt vmcnt(9) lgkmcnt(8)
    v_mfma_f32_32x32x16_bf16 v[16:31], v[72:75], v[132:135], v[16:31]
    buffer_load_dwordx4 v[172:175], v2, s[52:55], s31 offen offset:3072 sc1
    ds_read_b64_tr_b16 v[64:65], v13 offset:4096
    ds_read_b64_tr_b16 v[66:67], v13 offset:4352
    v_add_u32 v10, 64, v1
    v_mfma_f32_32x32x16_bf16 v[32:47], v[132:135], v[76:79], v[32:47]
    ds_read_b64_tr_b16 v[68:69], v13 offset:36864
    ds_read_b64_tr_b16 v[70:71], v13 offset:37120
    v_mul_u32_u24 v11, 4682, v10
    v_lshrrev_b32 v11, 16, v11
    s_waitcnt vmcnt(9) lgkmcnt(8)
    v_mfma_f32_32x32x16_bf16 v[16:31], v[80:83], v[136:139], v[16:31]
    s_add_u32 s31, s31, 4096
    buffer_load_dwordx4 v[176:179], v2, s[52:55], s31 offen offset:0 sc1
    ds_read_b64_tr_b16 v[72:73], v13 offset:5120
    ds_read_b64_tr_b16 v[74:75], v13 offset:5376
    v_mad_i32_i24 v10, v11, -14, v10
    v_mfma_f32_32x32x16_bf16 v[32:47], v[136:139], v[84:87], v[32:47]
    ds_read_b64_tr_b16 v[76:77], v13 offset:37888
    ds_read_b64_tr_b16 v[78:79], v13 offset:38144
    v_add_u32 v10, s80, v10
    v_subrev_u32 v12, 14, v10
    s_waitcnt vmcnt(9) lgkmcnt(8)
    v_mfma_f32_32x32x16_bf16 v[16:31], v[88:91], v[140:143], v[16:31]
    buffer_load_dwordx4 v[180:183], v2, s[52:55], s31 offen offset:1024 sc1
    ds_read_b64_tr_b16 v[80:81], v13 offset:6144
    ds_read_b64_tr_b16 v[82:83], v13 offset:6400
    v_min_u32 v10, v10, v12
    v_mfma_f32_32x32x16_bf16 v[32:47], v[140:143], v[92:95], v[32:47]
    ds_read_b64_tr_b16 v[84:85], v13 offset:38912
    ds_read_b64_tr_b16 v[86:87], v13 offset:39168
    v_and_b32 v12, 4, v11
    v_mad_u32_u24 v12, v12, 3, v11
    s_waitcnt vmcnt(9) lgkmcnt(8)
    v_mfma_f32_32x32x16_bf16 v[16:31], v[64:67], v[144:147], v[16:31]
    buffer_load_dwordx4 v[184:187], v2, s[52:55], s31 offen offset:2048 sc1
    ds_read_b64_tr_b16 v[88:89], v13 offset:7168
    ds_read_b64_tr_b16 v[90:91], v13 offset:7424
    v_and_b32 v15, 16, v11
    v_mfma_f32_32x32x16_bf16 v[32:47], v[144:147], v[68:71], v[32:47]
    ds_read_b64_tr_b16 v[92:93], v13 offset:39936
    ds_read_b64_tr_b16 v[94:95], v13 offset:40192
    v_add_u32 v12, v12, v15
    v_bfe_u32 v15, v11, 3, 1
    s_waitcnt vmcnt(9) lgkmcnt(8)
    v_mfma_f32_32x32x16_bf16 v[16:31], v[72:75], v[148:151], v[16:31]
    buffer_load_dwordx4 v[188:191], v2, s[52:55], s31 offen offset:3072 sc1
    ds_read_b64_tr_b16 v[64:65], v13 offset:8192
    ds_read_b64_tr_b16 v[66:67], v13 offset:8448
    v_mad_i32_i24 v12, v15, -4, v12
    v_mfma_f32_32x32x16_bf16 v[32:47], v[148:151], v[76:79], v[32:47]
    ds_read_b64_tr_b16 v[68:69], v13 offset:40960
    ds_read_b64_tr_b16 v[70:71], v13 offset:41216
    v_mul_u32_u24 v12, 3584, v12
    v_lshl_add_u32 v113, v10, 4, v12
    s_waitcnt vmcnt(9) lgkmcnt(8)
    v_mfma_f32_32x32x16_bf16 v[16:31], v[80:83], v[152:155], v[16:31]
    s_add_u32 s31, s31, 4096
    buffer_load_dwordx4 v[192:195], v2, s[52:55], s31 offen offset:0 sc1
    ds_read_b64_tr_b16 v[72:73], v13 offset:9216
    ds_read_b64_tr_b16 v[74:75], v13 offset:9472
    v_add_u32 v10, 128, v1
    v_mfma_f32_32x32x16_bf16 v[32:47], v[152:155], v[84:87], v[32:47]
    ds_read_b64_tr_b16 v[76:77], v13 offset:41984
    ds_read_b64_tr_b16 v[78:79], v13 offset:42240
    v_mul_u32_u24 v11, 4682, v10
    v_lshrrev_b32 v11, 16, v11
    s_waitcnt vmcnt(9) lgkmcnt(8)
    v_mfma_f32_32x32x16_bf16 v[16:31], v[88:91], v[156:159], v[16:31]
    buffer_load_dwordx4 v[196:199], v2, s[52:55], s31 offen offset:1024 sc1
    ds_read_b64_tr_b16 v[80:81], v13 offset:10240
    ds_read_b64_tr_b16 v[82:83], v13 offset:10496
    v_mad_i32_i24 v10, v11, -14, v10
    v_mfma_f32_32x32x16_bf16 v[32:47], v[156:159], v[92:95], v[32:47]
    ds_read_b64_tr_b16 v[84:85], v13 offset:43008
    ds_read_b64_tr_b16 v[86:87], v13 offset:43264
    v_add_u32 v10, s80, v10
    v_subrev_u32 v12, 14, v10
    s_waitcnt vmcnt(9) lgkmcnt(8)
    v_mfma_f32_32x32x16_bf16 v[16:31], v[64:67], v[160:163], v[16:31]
    buffer_load_dwordx4 v[200:203], v2, s[52:55], s31 offen offset:2048 sc1
    ds_read_b64_tr_b16 v[88:89], v13 offset:11264
    ds_read_b64_tr_b16 v[90:91], v13 offset:11520
    v_min_u32 v10, v10, v12
    v_mfma_f32_32x32x16_bf16 v[32:47], v[160:163], v[68:71], v[32:47]
    ds_read_b64_tr_b16 v[92:93], v13 offset:44032
    ds_read_b64_tr_b16 v[94:95], v13 offset:44288
    v_and_b32 v12, 4, v11
    v_mad_u32_u24 v12, v12, 3, v11
    s_waitcnt vmcnt(9) lgkmcnt(8)
    v_mfma_f32_32x32x16_bf16 v[16:31], v[72:75], v[164:167], v[16:31]
    buffer_load_dwordx4 v[204:207], v2, s[52:55], s31 offen offset:3072 sc1
    ds_read_b64_tr_b16 v[64:65], v13 offset:12288
    ds_read_b64_tr_b16 v[66:67], v13 offset:12544
    v_and_b32 v15, 16, v11
    v_mfma_f32_32x32x16_bf16 v[32:47], v[164:167], v[76:79], v[32:47]
    ds_read_b64_tr_b16 v[68:69], v13 offset:45056
    ds_read_b64_tr_b16 v[70:71], v13 offset:45312
    v_add_u32 v12, v12, v15
    v_bfe_u32 v15, v11, 3, 1
    s_waitcnt vmcnt(9) lgkmcnt(8)
    v_mfma_f32_32x32x16_bf16 v[16:31], v[80:83], v[168:171], v[16:31]
    s_add_u32 s31, s31, 4096
    buffer_load_dwordx4 v[208:211], v2, s[52:55], s31 offen offset:0 sc1
    ds_read_b64_tr_b16 v[72:73], v13 offset:13312
    ds_read_b64_tr_b16 v[74:75], v13 offset:13568
    v_mad_i32_i24 v12, v15, -4, v12
    v_mfma_f32_32x32x16_bf16 v[32:47], v[168:171], v[84:87], v[32:47]
    ds_read_b64_tr_b16 v[76:77], v13 offset:46080
    ds_read_b64_tr_b16 v[78:79], v13 offset:46336
    v_mul_u32_u24 v12, 3584, v12
    v_lshl_add_u32 v114, v10, 4, v12
    s_waitcnt vmcnt(9) lgkmcnt(8)
    v_mfma_f32_32x32x16_bf16 v[16:31], v[88:91], v[172:175], v[16:31]
    buffer_load_dwordx4 v[212:215], v2, s[52:55], s31 offen offset:1024 sc1
    ds_read_b64_tr_b16 v[80:81], v13 offset:14336
    ds_read_b64_tr_b16 v[82:83], v13 offset:14592
    v_add_u32 v10, 192, v1
    v_mfma_f32_32x32x16_bf16 v[32:47], v[172:175], v[92:95], v[32:47]
    ds_read_b64_tr_b16 v[84:85], v13 offset:47104
    ds_read_b64_tr_b16 v[86:87], v13 offset:47360
    v_mul_u32_u24 v11, 4682, v10
    v_lshrrev_b32 v11, 16, v11
    s_waitcnt vmcnt(9) lgkmcnt(8)
    v_mfma_f32_32x32x16_bf16 v[16:31], v[64:67], v[176:179], v[16:31]
    buffer_load_dwordx4 v[216:219], v2, s[52:55], s31 offen offset:2048 sc1
    ds_read_b64_tr_b16 v[88:89], v13 offset:15360
    ds_read_b64_tr_b16 v[90:91], v13 offset:15616
    v_mad_i32_i24 v10, v11, -14, v10
    v_mfma_f32_32x32x16_bf16 v[32:47], v[176:179], v[68:71], v[32:47]
    ds_read_b64_tr_b16 v[92:93], v13 offset:48128
    ds_read_b64_tr_b16 v[94:95], v13 offset:48384
    v_add_u32 v10, s80, v10
    v_subrev_u32 v12, 14, v10
    s_waitcnt vmcnt(9) lgkmcnt(8)
    v_mfma_f32_32x32x16_bf16 v[16:31], v[72:75], v[180:183], v[16:31]
    buffer_load_dwordx4 v[220:223], v2, s[52:55], s31 offen offset:3072 sc1
    ds_read_b64_tr_b16 v[64:65], v13 offset:16384
    ds_read_b64_tr_b16 v[66:67], v13 offset:16640
    v_min_u32 v10, v10, v12
    v_mfma_f32_32x32x16_bf16 v[32:47], v[180:183], v[76:79], v[32:47]
    ds_read_b64_tr_b16 v[68:69], v13 offset:49152
    ds_read_b64_tr_b16 v[70:71], v13 offset:49408
    v_and_b32 v12, 4, v11
    v_mad_u32_u24 v12, v12, 3, v11
    s_waitcnt vmcnt(9) lgkmcnt(8)
    v_mfma_f32_32x32x16_bf16 v[16:31], v[80:83], v[184:187], v[16:31]
    s_add_u32 s31, s31, 4096
    buffer_load_dwordx4 v[224:227], v2, s[52:55], s31 offen offset:0 sc1
    ds_read_b64_tr_b16 v[72:73], v13 offset:17408
    ds_read_b64_tr_b16 v[74:75], v13 offset:17664
    v_and_b32 v15, 16, v11
    v_mfma_f32_32x32x16_bf16 v[32:47], v[184:187], v[84:87], v[32:47]
    ds_read_b64_tr_b16 v[76:77], v13 offset:50176
    ds_read_b64_tr_b16 v[78:79], v13 offset:50432
    v_add_u32 v12, v12, v15
    v_bfe_u32 v15, v11, 3, 1
    s_waitcnt vmcnt(9) lgkmcnt(8)
    v_mfma_f32_32x32x16_bf16 v[16:31], v[88:91], v[188:191], v[16:31]
    buffer_load_dwordx4 v[228:231], v2, s[52:55], s31 offen offset:1024 sc1
    ds_read_b64_tr_b16 v[80:81], v13 offset:18432
    ds_read_b64_tr_b16 v[82:83], v13 offset:18688
    v_mad_i32_i24 v12, v15, -4, v12
    v_mfma_f32_32x32x16_bf16 v[32:47], v[188:191], v[92:95], v[32:47]
    ds_read_b64_tr_b16 v[84:85], v13 offset:51200
    ds_read_b64_tr_b16 v[86:87], v13 offset:51456
    v_mul_u32_u24 v12, 3584, v12
    v_lshl_add_u32 v115, v10, 4, v12
    s_waitcnt vmcnt(9) lgkmcnt(8)
    v_mfma_f32_32x32x16_bf16 v[16:31], v[64:67], v[192:195], v[16:31]
    buffer_load_dwordx4 v[232:235], v2, s[52:55], s31 offen offset:2048 sc1
    ds_read_b64_tr_b16 v[88:89], v13 offset:19456
    ds_read_b64_tr_b16 v[90:91], v13 offset:19712
    v_add_u32 v10, 256, v1
    v_mfma_f32_32x32x16_bf16 v[32:47], v[192:195], v[68:71], v[32:47]
    ds_read_b64_tr_b16 v[92:93], v13 offset:52224
    ds_read_b64_tr_b16 v[94:95], v13 offset:52480
    v_mul_u32_u24 v11, 4682, v10
    v_lshrrev_b32 v11, 16, v11
    s_waitcnt vmcnt(9) lgkmcnt(8)
    v_mfma_f32_32x32x16_bf16 v[16:31], v[72:75], v[196:199], v[16:31]
    buffer_load_dwordx4 v[236:239], v2, s[52:55], s31 offen offset:3072 sc1
    ds_read_b64_tr_b16 v[64:65], v13 offset:20480
    ds_read_b64_tr_b16 v[66:67], v13 offset:20736
    v_mad_i32_i24 v10, v11, -14, v10
    v_mfma_f32_32x32x16_bf16 v[32:47], v[196:199], v[76:79], v[32:47]
    ds_read_b64_tr_b16 v[68:69], v13 offset:53248
    ds_read_b64_tr_b16 v[70:71], v13 offset:53504
    v_add_u32 v10, s80, v10
    v_subrev_u32 v12, 14, v10
    s_waitcnt vmcnt(9) lgkmcnt(8)
    v_mfma_f32_32x32x16_bf16 v[16:31], v[80:83], v[200:203], v[16:31]
    s_add_u32 s31, s31, 4096
    buffer_load_dwordx4 v[240:243], v2, s[52:55], s31 offen offset:0 sc1
    ds_read_b64_tr_b16 v[72:73], v13 offset:21504
    ds_read_b64_tr_b16 v[74:75], v13 offset:21760
    v_min_u32 v10, v10, v12
    v_mfma_f32_32x32x16_bf16 v[32:47], v[200:203], v[84:87], v[32:47]
    ds_read_b64_tr_b16 v[76:77], v13 offset:54272
    ds_read_b64_tr_b16 v[78:79], v13 offset:54528
    v_and_b32 v12, 4, v11
    v_mad_u32_u24 v12, v12, 3, v11
    s_waitcnt vmcnt(9) lgkmcnt(8)
    v_mfma_f32_32x32x16_bf16 v[16:31], v[88:91], v[204:207], v[16:31]
    buffer_load_dwordx4 v[244:247], v2, s[52:55], s31 offen offset:1024 sc1
    ds_read_b64_tr_b16 v[80:81], v13 offset:22528
    ds_read_b64_tr_b16 v[82:83], v13 offset:22784
    v_and_b32 v15, 16, v11
    v_mfma_f32_32x32x16_bf16 v[32:47], v[204:207], v[92:95], v[32:47]
    ds_read_b64_tr_b16 v[84:85], v13 offset:55296
    ds_read_b64_tr_b16 v[86:87], v13 offset:55552
    v_add_u32 v12, v12, v15
    v_bfe_u32 v15, v11, 3, 1
    s_waitcnt vmcnt(9) lgkmcnt(8)
    v_mfma_f32_32x32x16_bf16 v[16:31], v[64:67], v[208:211], v[16:31]
    buffer_load_dwordx4 v[248:251], v2, s[52:55], s31 offen offset:2048 sc1
    ds_read_b64_tr_b16 v[88:89], v13 offset:23552
    ds_read_b64_tr_b16 v[90:91], v13 offset:23808
    v_mad_i32_i24 v12, v15, -4, v12
    v_mfma_f32_32x32x16_bf16 v[32:47], v[208:211], v[68:71], v[32:47]
    ds_read_b64_tr_b16 v[92:93], v13 offset:56320
    ds_read_b64_tr_b16 v[94:95], v13 offset:56576
    v_mul_u32_u24 v12, 3584, v12
    v_lshl_add_u32 v116, v10, 4, v12
    s_waitcnt vmcnt(9) lgkmcnt(8)
    v_mfma_f32_32x32x16_bf16 v[16:31], v[72:75], v[212:215], v[16:31]
    buffer_load_dwordx4 v[252:255], v2, s[52:55], s31 offen offset:3072 sc1
    ds_read_b64_tr_b16 v[64:65], v13 offset:24576
    ds_read_b64_tr_b16 v[66:67], v13 offset:24832
    v_add_u32 v10, 320, v1
    v_mfma_f32_32x32x16_bf16 v[32:47], v[212:215], v[76:79], v[32:47]
    ds_read_b64_tr_b16 v[68:69], v13 offset:57344
    ds_read_b64_tr_b16 v[70:71], v13 offset:57600
    v_mul_u32_u24 v11, 4682, v10
    v_lshrrev_b32 v11, 16, v11
    s_waitcnt vmcnt(9) lgkmcnt(8)
    v_mfma_f32_32x32x16_bf16 v[16:31], v[80:83], v[216:219], v[16:31]
    s_add_u32 m0, s1, 2048
    s_add_u32 s0, s0, 49152
    buffer_load_dwordx4 v96, s[36:39], s0 offen lds
    ds_read_b64_tr_b16 v[72:73], v13 offset:25600
    ds_read_b64_tr_b16 v[74:75], v13 offset:25856
    v_mad_i32_i24 v10, v11, -14, v10
    v_mfma_f32_32x32x16_bf16 v[32:47], v[216:219], v[84:87], v[32:47]
    ds_read_b64_tr_b16 v[76:77], v13 offset:58368
    ds_read_b64_tr_b16 v[78:79], v13 offset:58624
    v_add_u32 v10, s80, v10
    v_subrev_u32 v12, 14, v10
    s_waitcnt vmcnt(9) lgkmcnt(8)
    v_mfma_f32_32x32x16_bf16 v[16:31], v[88:91], v[220:223], v[16:31]
    s_add_u32 m0, s1, 3072
    s_add_u32 s0, s0, 49152
    buffer_load_dwordx4 v96, s[36:39], s0 offen lds
    ds_read_b64_tr_b16 v[80:81], v13 offset:26624
    ds_read_b64_tr_b16 v[82:83], v13 offset:26880
    v_min_u32 v10, v10, v12
    v_mfma_f32_32x32x16_bf16 v[32:47], v[220:223], v[92:95], v[32:47]
    ds_read_b64_tr_b16 v[84:85], v13 offset:59392
    ds_read_b64_tr_b16 v[86:87], v13 offset:59648
    v_and_b32 v12, 4, v11
    v_mad_u32_u24 v12, v12, 3, v11
    s_waitcnt vmcnt(9) lgkmcnt(8)
    v_mfma_f32_32x32x16_bf16 v[16:31], v[64:67], v[224:227], v[16:31]
    s_xor_b32 s69, s69, 4
    s_lshl3_add_u32 s65, s5, s69
    s_mul_i32 s0, s65, 49152
    s_lshl_b32 s1, s65, 10
    s_add_u32 s1, s1, 65536
    s_add_u32 m0, s1, 0
    s_nop 0
    buffer_load_dwordx4 v96, s[36:39], s0 offen lds
    ds_read_b64_tr_b16 v[88:89], v13 offset:27648
    ds_read_b64_tr_b16 v[90:91], v13 offset:27904
    v_and_b32 v15, 16, v11
    v_mfma_f32_32x32x16_bf16 v[32:47], v[224:227], v[68:71], v[32:47]
    ds_read_b64_tr_b16 v[92:93], v13 offset:60416
    ds_read_b64_tr_b16 v[94:95], v13 offset:60672
    v_add_u32 v12, v12, v15
    v_bfe_u32 v15, v11, 3, 1
    s_waitcnt vmcnt(9) lgkmcnt(8)
    v_mfma_f32_32x32x16_bf16 v[16:31], v[72:75], v[228:231], v[16:31]
    s_add_u32 m0, s1, 1024
    s_add_u32 s0, s0, 49152
    buffer_load_dwordx4 v96, s[36:39], s0 offen lds
    ds_read_b64_tr_b16 v[64:65], v13 offset:28672
    ds_read_b64_tr_b16 v[66:67], v13 offset:28928
    v_mad_i32_i24 v12, v15, -4, v12
    v_mfma_f32_32x32x16_bf16 v[32:47], v[228:231], v[76:79], v[32:47]
    ds_read_b64_tr_b16 v[68:69], v13 offset:61440
    ds_read_b64_tr_b16 v[70:71], v13 offset:61696
    v_mul_u32_u24 v12, 3584, v12
    v_lshl_add_u32 v117, v10, 4, v12
    s_waitcnt vmcnt(9) lgkmcnt(8)
    v_mfma_f32_32x32x16_bf16 v[16:31], v[80:83], v[232:235], v[16:31]
    ds_read_b64_tr_b16 v[72:73], v13 offset:29696
    ds_read_b64_tr_b16 v[74:75], v13 offset:29952
    v_add_u32 v10, 384, v1
    v_mfma_f32_32x32x16_bf16 v[32:47], v[232:235], v[84:87], v[32:47]
    ds_read_b64_tr_b16 v[76:77], v13 offset:62464
    ds_read_b64_tr_b16 v[78:79], v13 offset:62720
    v_mul_u32_u24 v11, 4682, v10
    v_lshrrev_b32 v11, 16, v11
    s_waitcnt vmcnt(8) lgkmcnt(8)
    v_mfma_f32_32x32x16_bf16 v[16:31], v[88:91], v[236:239], v[16:31]
    ds_read_b64_tr_b16 v[80:81], v13 offset:30720
    ds_read_b64_tr_b16 v[82:83], v13 offset:30976
    v_mad_i32_i24 v10, v11, -14, v10
    v_mfma_f32_32x32x16_bf16 v[32:47], v[236:239], v[92:95], v[32:47]
    ds_read_b64_tr_b16 v[84:85], v13 offset:63488
    ds_read_b64_tr_b16 v[86:87], v13 offset:63744
    v_add_u32 v10, s80, v10
    v_subrev_u32 v12, 14, v10
    s_waitcnt vmcnt(7) lgkmcnt(8)
    v_mfma_f32_32x32x16_bf16 v[16:31], v[64:67], v[240:243], v[16:31]
    ds_read_b64_tr_b16 v[88:89], v13 offset:31744
    ds_read_b64_tr_b16 v[90:91], v13 offset:32000
    v_min_u32 v10, v10, v12
    v_mfma_f32_32x32x16_bf16 v[32:47], v[240:243], v[68:71], v[32:47]
    ds_read_b64_tr_b16 v[92:93], v13 offset:64512
    ds_read_b64_tr_b16 v[94:95], v13 offset:64768
    v_and_b32 v12, 4, v11
    v_mad_u32_u24 v12, v12, 3, v11
    s_waitcnt vmcnt(6) lgkmcnt(8)
    v_mfma_f32_32x32x16_bf16 v[16:31], v[72:75], v[244:247], v[16:31]
    v_and_b32 v15, 16, v11
    v_mfma_f32_32x32x16_bf16 v[32:47], v[244:247], v[76:79], v[32:47]
    v_add_u32 v12, v12, v15
    v_bfe_u32 v15, v11, 3, 1
    s_waitcnt vmcnt(5) lgkmcnt(4)
    v_mfma_f32_32x32x16_bf16 v[16:31], v[80:83], v[248:251], v[16:31]
    v_mad_i32_i24 v12, v15, -4, v12
    v_mfma_f32_32x32x16_bf16 v[32:47], v[248:251], v[84:87], v[32:47]
    v_mul_u32_u24 v12, 3584, v12
    v_lshl_add_u32 v118, v10, 4, v12
    s_waitcnt vmcnt(4) lgkmcnt(0)
    v_mfma_f32_32x32x16_bf16 v[16:31], v[88:91], v[252:255], v[16:31]
    v_mfma_f32_32x32x16_bf16 v[32:47], v[252:255], v[92:95], v[32:47]
    s_nop 10
    v_cvt_pk_bf16_f32 v48, v16, v17
    v_cvt_pk_bf16_f32 v49, v18, v19
    v_cvt_pk_bf16_f32 v50, v20, v21
    v_cvt_pk_bf16_f32 v51, v22, v23
    buffer_store_dwordx4 v[48:51], v2, s[52:55], s20 offen offset:0 sc1
    v_cvt_pk_bf16_f32 v52, v24, v25
    v_cvt_pk_bf16_f32 v53, v26, v27
    v_cvt_pk_bf16_f32 v54, v28, v29
    v_cvt_pk_bf16_f32 v55, v30, v31
    buffer_store_dwordx4 v[52:55], v2, s[52:55], s20 offen offset:1024 sc1
    v_cvt_pk_bf16_f32 v56, v32, v33
    v_cvt_pk_bf16_f32 v57, v34, v35
    v_cvt_pk_bf16_f32 v58, v36, v37
    v_cvt_pk_bf16_f32 v59, v38, v39
    buffer_store_dwordx4 v[56:59], v2, s[52:55], s20 offen offset:2048 sc1
    v_cvt_pk_bf16_f32 v60, v40, v41
    v_cvt_pk_bf16_f32 v61, v42, v43
    v_cvt_pk_bf16_f32 v62, v44, v45
    v_cvt_pk_bf16_f32 v63, v46, v47
    buffer_store_dwordx4 v[60:63], v2, s[52:55], s20 offen offset:3072 sc1
    s_add_u32 m0, s1, 2048
    s_add_u32 s0, s0, 49152
    buffer_load_dwordx4 v96, s[36:39], s0 offen lds
    s_add_u32 m0, s1, 3072
    s_add_u32 s0, s0, 49152
    buffer_load_dwordx4 v96, s[36:39], s0 offen lds
    ds_write_b128 v119, v[48:51] offset:32768
    ds_write_b128 v119, v[52:55] offset:33792
    ds_write_b128 v119, v[56:59] offset:34816
    ds_write_b128 v119, v[60:63] offset:35840
    ds_read_b64_tr_b16 a[0:1], v98 offset:0
    ds_read_b64_tr_b16 a[2:3], v99 offset:0
    ds_read_b64_tr_b16 a[4:5], v98 offset:8
    ds_read_b64_tr_b16 a[6:7], v99 offset:8
    ds_read_b64_tr_b16 a[8:9], v98 offset:16
    ds_read_b64_tr_b16 a[10:11], v99 offset:16
    ds_read_b64_tr_b16 a[12:13], v98 offset:24
    ds_read_b64_tr_b16 a[14:15], v99 offset:24
    v_and_b32 v11, 31, v1
    v_lshrrev_b32 v12, 5, v1
    v_lshlrev_b32 v12, 2, v12
    v_sub_u32 v11, v11, v12
    v_mov_b32 v12, 0xff800000
    v_cmp_le_i32 s[90:91], 0, v11
    v_cmp_le_i32 s[92:93], 1, v11
    v_cmp_le_i32 s[94:95], 2, v11
    v_cndmask_b32 v16, v12, 0, s[90:91]
    v_cndmask_b32 v32, 0, v12, s[90:91]
    v_cmp_le_i32 s[90:91], 3, v11
    v_cndmask_b32 v17, v12, 0, s[92:93]
    v_cndmask_b32 v33, 0, v12, s[92:93]
    v_cmp_le_i32 s[92:93], 8, v11
    v_cndmask_b32 v18, v12, 0, s[94:95]
    v_cndmask_b32 v34, 0, v12, s[94:95]
    v_cmp_le_i32 s[94:95], 9, v11
    v_cndmask_b32 v19, v12, 0, s[90:91]
    v_cndmask_b32 v35, 0, v12, s[90:91]
    v_cmp_le_i32 s[90:91], 10, v11
    v_cndmask_b32 v20, v12, 0, s[92:93]
    v_cndmask_b32 v36, 0, v12, s[92:93]
    v_cmp_le_i32 s[92:93], 11, v11
    v_cndmask_b32 v21, v12, 0, s[94:95]
    v_cndmask_b32 v37, 0, v12, s[94:95]
    v_cmp_le_i32 s[94:95], 16, v11
    v_cndmask_b32 v22, v12, 0, s[90:91]
    v_cndmask_b32 v38, 0, v12, s[90:91]
    v_cmp_le_i32 s[90:91], 17, v11
    v_cndmask_b32 v23, v12, 0, s[92:93]
    v_cndmask_b32 v39, 0, v12, s[92:93]
    v_cmp_le_i32 s[92:93], 18, v11
    v_cndmask_b32 v24, v12, 0, s[94:95]
    v_cndmask_b32 v40, 0, v12, s[94:95]
    v_cmp_le_i32 s[94:95], 19, v11
    v_cndmask_b32 v25, v12, 0, s[90:91]
    v_cndmask_b32 v41, 0, v12, s[90:91]
    v_cmp_le_i32 s[90:91], 24, v11
    v_cndmask_b32 v26, v12, 0, s[92:93]
    v_cndmask_b32 v42, 0, v12, s[92:93]
    v_cmp_le_i32 s[92:93], 25, v11
    v_cndmask_b32 v27, v12, 0, s[94:95]
    v_cndmask_b32 v43, 0, v12, s[94:95]
    v_cmp_le_i32 s[94:95], 26, v11
    v_cndmask_b32 v28, v12, 0, s[90:91]
    v_cndmask_b32 v44, 0, v12, s[90:91]
    v_cmp_le_i32 s[90:91], 27, v11
    v_cndmask_b32 v29, v12, 0, s[92:93]
    v_cndmask_b32 v45, 0, v12, s[92:93]
    v_cndmask_b32 v30, v12, 0, s[94:95]
    v_cndmask_b32 v46, 0, v12, s[94:95]
    v_cndmask_b32 v31, v12, 0, s[90:91]
    v_cndmask_b32 v47, 0, v12, s[90:91]
    s_waitcnt vmcnt(2)
    s_mov_b64 exec, 1
    buffer_store_dword v3, off, s[52:55], s8 sc1
    s_mov_b64 exec, -1
    s_lshl_b32 s79, s5, 5
    s_add_u32 s80, s79, 128
    s_min_u32 s80, s80, 192
    v_add_u32 v88, s79, v100
    v_add_u32 v89, s79, v101
    v_add_u32 v90, s80, v100
    v_add_u32 v91, s80, v101
    v_and_b32 v10, 1, v1
    v_lshlrev_b32 v11, 10, v10
    v_sub_u32 v11, 115712, v11
    v_lshrrev_b32 v12, 4, v1
    v_lshl_add_u32 v92, v12, 5, v11
    v_lshl_add_u32 v12, v10, 9, v102
    v_lshl_add_u32 v93, s79, 1, v12
    v_lshl_add_u32 v94, s80, 1, v12
    v_and_b32 v103, 0xffffff7f, v103
    s_lshl_b32 s78, s5, 12
    s_mov_b32 s76, 0x3eb8aa3b
    s_mov_b32 s77, 0x3eb8aa3b
    s_waitcnt lgkmcnt(0)
    s_bitcmp1_b32 s64, 31
    s_cbranch_scc1 L_norole_57
    buffer_store_dwordx4 a[0:3], v2, s[52:55], s64 offen offset:0 sc1
    buffer_store_dwordx4 a[4:7], v2, s[52:55], s64 offen offset:1024 sc1
    buffer_store_dwordx4 a[8:11], v2, s[52:55], s64 offen offset:2048 sc1
    buffer_store_dwordx4 a[12:15], v2, s[52:55], s64 offen offset:3072 sc1
    s_waitcnt vmcnt(5)
    s_branch L_role_58
L_norole_57:
    s_waitcnt vmcnt(1)
L_role_58:
    s_barrier
    ds_read_b64_tr_b16 v[64:65], v14 offset:0
    ds_read_b64_tr_b16 v[66:67], v14 offset:256
    ds_read_b64_tr_b16 v[68:69], v14 offset:1024
    ds_read_b64_tr_b16 v[70:71], v14 offset:1280
    ds_read_b64_tr_b16 v[72:73], v14 offset:2048
    ds_read_b64_tr_b16 v[74:75], v14 offset:2304
    ds_read_b64_tr_b16 v[76:77], v14 offset:3072
    ds_read_b64_tr_b16 v[78:79], v14 offset:3328
    ds_read_b64_tr_b16 v[80:81], v14 offset:4096
    ds_read_b64_tr_b16 v[82:83], v14 offset:4352
    s_waitcnt lgkmcnt(8)
    v_mfma_f32_32x32x16_bf16 v[48:63], v[64:67], v[128:131], 0
    ds_read_b64_tr_b16 v[84:85], v14 offset:5120
    ds_read_b64_tr_b16 v[86:87], v14 offset:5376
    s_waitcnt lgkmcnt(8)
    v_mfma_f32_32x32x16_bf16 v[48:63], v[68:71], v[132:135], v[48:63]
    ds_read_b64_tr_b16 v[64:65], v14 offset:6144
    ds_read_b64_tr_b16 v[66:67], v14 offset:6400
    s_waitcnt lgkmcnt(8)
    v_mfma_f32_32x32x16_bf16 v[48:63], v[72:75], v[136:139], v[48:63]
    buffer_load_dword v15, v120, s[52:55], 0 offen offset:0 sc1
    ds_read_b64_tr_b16 v[68:69], v14 offset:7168
    ds_read_b64_tr_b16 v[70:71], v14 offset:7424
    s_waitcnt lgkmcnt(8)
    v_mfma_f32_32x32x16_bf16 v[48:63], v[76:79], v[140:143], v[48:63]
    ds_read_b64_tr_b16 v[72:73], v14 offset:8192
    ds_read_b64_tr_b16 v[74:75], v14 offset:8448
    s_waitcnt lgkmcnt(8)
    v_mfma_f32_32x32x16_bf16 v[48:63], v[80:83], v[144:147], v[48:63]
    ds_read_b64_tr_b16 v[76:77], v14 offset:9216
    ds_read_b64_tr_b16 v[78:79], v14 offset:9472
    s_waitcnt lgkmcnt(8)
    v_mfma_f32_32x32x16_bf16 v[48:63], v[84:87], v[148:151], v[48:63]
    ds_read_b64_tr_b16 v[80:81], v14 offset:10240
    ds_read_b64_tr_b16 v[82:83], v14 offset:10496
    s_waitcnt lgkmcnt(8)
    v_mfma_f32_32x32x16_bf16 v[48:63], v[64:67], v[152:155], v[48:63]
    ds_read_b64_tr_b16 v[84:85], v14 offset:11264
    ds_read_b64_tr_b16 v[86:87], v14 offset:11520
    s_mov_b32 s92, 0x00110011
    s_mov_b32 s93, 0x00110011
    s_waitcnt lgkmcnt(8)
    v_mfma_f32_32x32x16_bf16 v[48:63], v[68:71], v[156:159], v[48:63]
    ds_read_b64_tr_b16 v[64:65], v14 offset:12288
    ds_read_b64_tr_b16 v[66:67], v14 offset:12544
    v_mov_b32 v10, 0x3f803f80
    v_cndmask_b32 v136, 0, v10, s[92:93]
    s_waitcnt lgkmcnt(8)
    v_mfma_f32_32x32x16_bf16 v[48:63], v[72:75], v[160:163], v[48:63]
    ds_read_b64_tr_b16 v[68:69], v14 offset:13312
    ds_read_b64_tr_b16 v[70:71], v14 offset:13568
    v_mov_b32 v137, v136
    v_mov_b32 v138, v136
    s_waitcnt lgkmcnt(8)
    v_mfma_f32_32x32x16_bf16 v[48:63], v[76:79], v[164:167], v[48:63]
    ds_read_b64_tr_b16 v[72:73], v14 offset:14336
    ds_read_b64_tr_b16 v[74:75], v14 offset:14592
    v_mov_b32 v139, v136
    v_mov_b32 v140, v136
    s_waitcnt lgkmcnt(8)
    v_mfma_f32_32x32x16_bf16 v[48:63], v[80:83], v[168:171], v[48:63]
    ds_read_b64_tr_b16 v[76:77], v14 offset:15360
    ds_read_b64_tr_b16 v[78:79], v14 offset:15616
    v_mov_b32 v141, v136
    v_mov_b32 v142, v136
    s_waitcnt lgkmcnt(8)
    v_mfma_f32_32x32x16_bf16 v[48:63], v[84:87], v[172:175], v[48:63]
    ds_read_b64_tr_b16 v[80:81], v14 offset:16384
    ds_read_b64_tr_b16 v[82:83], v14 offset:16640
    v_mov_b32 v143, v136
    v_mov_b32 v144, v136
    s_waitcnt lgkmcnt(8)
    v_mfma_f32_32x32x16_bf16 v[48:63], v[64:67], v[176:179], v[48:63]
    ds_read_b64_tr_b16 v[84:85], v14 offset:17408
    ds_read_b64_tr_b16 v[86:87], v14 offset:17664
    v_mov_b32 v145, v136
    v_mov_b32 v146, v136
    s_waitcnt lgkmcnt(8)
    v_mfma_f32_32x32x16_bf16 v[48:63], v[68:71], v[180:183], v[48:63]
    ds_read_b64_tr_b16 v[64:65], v14 offset:18432
    ds_read_b64_tr_b16 v[66:67], v14 offset:18688
    v_mov_b32 v147, v136
    v_mov_b32 v148, v136
    s_waitcnt lgkmcnt(8)
    v_mfma_f32_32x32x16_bf16 v[48:63], v[72:75], v[184:187], v[48:63]
    ds_read_b64_tr_b16 v[68:69], v14 offset:19456
    ds_read_b64_tr_b16 v[70:71], v14 offset:19712
    v_mov_b32 v149, v136
    v_mov_b32 v150, v136
    s_waitcnt lgkmcnt(8)
    v_mfma_f32_32x32x16_bf16 v[48:63], v[76:79], v[188:191], v[48:63]
    ds_read_b64_tr_b16 v[72:73], v14 offset:20480
    ds_read_b64_tr_b16 v[74:75], v14 offset:20736
    v_mov_b32 v151, v136
    s_waitcnt lgkmcnt(8)
    v_mfma_f32_32x32x16_bf16 v[48:63], v[80:83], v[192:195], v[48:63]
    ds_read_b64_tr_b16 v[76:77], v14 offset:21504
    ds_read_b64_tr_b16 v[78:79], v14 offset:21760
    s_waitcnt vmcnt(0)
    v_cmp_ne_u32 vcc, s68, v15
    s_nop 0
    s_and_b64 vcc, vcc, s[98:99]
    s_cbranch_scc0 L_kvseen_59
    s_mov_b32 s82, 0
L_pkv_60:
    buffer_load_dword v15, v120, s[52:55], 0 offen offset:0 sc1
    s_add_u32 s82, s82, 1
    s_waitcnt vmcnt(0)
    v_cmp_ne_u32 vcc, s68, v15
    s_nop 0
    s_and_b64 vcc, vcc, s[98:99]
    s_cbranch_scc0 L_dkv_61
    s_cmp_lt_u32 s82, 131072
    s_cbranch_scc1 L_pkv_60
L_dkv_61:
L_kvseen_59:
    s_add_u32 m0, s78, 131072
    s_nop 0
    buffer_load_dwordx4 v121, s[52:55], s24 offen offset:0 sc1 lds
    buffer_load_dwordx4 v121, s[52:55], s24 offen offset:1024 sc1 lds
    buffer_load_dwordx4 v121, s[52:55], s24 offen offset:2048 sc1 lds
    buffer_load_dwordx4 v121, s[52:55], s24 offen offset:3072 sc1 lds
    s_waitcnt lgkmcnt(8)
    v_mfma_f32_32x32x16_bf16 v[48:63], v[84:87], v[196:199], v[48:63]
    s_add_u32 m0, s78, 114688
    ds_read_b64_tr_b16 v[80:81], v14 offset:22528
    ds_read_b64_tr_b16 v[82:83], v14 offset:22784
    buffer_load_dwordx4 v122, s[52:55], s25 offen offset:0 sc1 lds
    buffer_load_dwordx4 v122, s[52:55], s25 offen offset:1024 sc1 lds
    s_waitcnt lgkmcnt(8)
    v_mfma_f32_32x32x16_bf16 v[48:63], v[64:67], v[200:203], v[48:63]
    ds_read_b64_tr_b16 v[84:85], v14 offset:23552
    ds_read_b64_tr_b16 v[86:87], v14 offset:23808
    buffer_load_dwordx4 v122, s[52:55], s25 offen offset:2048 sc1 lds
    buffer_load_dwordx4 v122, s[52:55], s25 offen offset:3072 sc1 lds
    s_waitcnt lgkmcnt(8)
    v_mfma_f32_32x32x16_bf16 v[48:63], v[68:71], v[204:207], v[48:63]
    ds_read_b64_tr_b16 v[64:65], v14 offset:24576
    ds_read_b64_tr_b16 v[66:67], v14 offset:24832
    s_waitcnt lgkmcnt(8)
    v_mfma_f32_32x32x16_bf16 v[48:63], v[72:75], v[208:211], v[48:63]
    ds_read_b64_tr_b16 v[68:69], v14 offset:25600
    ds_read_b64_tr_b16 v[70:71], v14 offset:25856
    s_waitcnt lgkmcnt(8)
    v_mfma_f32_32x32x16_bf16 v[48:63], v[76:79], v[212:215], v[48:63]
    ds_read_b64_tr_b16 v[72:73], v14 offset:26624
    ds_read_b64_tr_b16 v[74:75], v14 offset:26880
    s_waitcnt lgkmcnt(8)
    v_mfma_f32_32x32x16_bf16 v[48:63], v[80:83], v[216:219], v[48:63]
    ds_read_b64_tr_b16 v[76:77], v14 offset:27648
    ds_read_b64_tr_b16 v[78:79], v14 offset:27904
    s_waitcnt lgkmcnt(8)
    v_mfma_f32_32x32x16_bf16 v[48:63], v[84:87], v[220:223], v[48:63]
    ds_read_b64_tr_b16 v[80:81], v14 offset:28672
    ds_read_b64_tr_b16 v[82:83], v14 offset:28928
    s_waitcnt lgkmcnt(8)
    v_mfma_f32_32x32x16_bf16 v[48:63], v[64:67], v[224:227], v[48:63]
    ds_read_b64_tr_b16 v[84:85], v14 offset:29696
    ds_read_b64_tr_b16 v[86:87], v14 offset:29952
    s_waitcnt lgkmcnt(8)
    v_mfma_f32_32x32x16_bf16 v[48:63], v[68:71], v[228:231], v[48:63]
    ds_read_b64_tr_b16 v[64:65], v14 offset:30720
    ds_read_b64_tr_b16 v[66:67], v14 offset:30976
    s_waitcnt lgkmcnt(8)
    v_mfma_f32_32x32x16_bf16 v[48:63], v[72:75], v[232:235], v[48:63]
    ds_read_b64_tr_b16 v[68:69], v14 offset:31744
    ds_read_b64_tr_b16 v[70:71], v14 offset:32000
    s_waitcnt lgkmcnt(8)
    v_mfma_f32_32x32x16_bf16 v[48:63], v[76:79], v[236:239], v[48:63]
    s_waitcnt lgkmcnt(6)
    v_mfma_f32_32x32x16_bf16 v[48:63], v[80:83], v[240:243], v[48:63]
    ds_read_b128 v[128:131], v119 offset:32768
    ds_read_b128 v[132:135], v119 offset:33792
    s_waitcnt lgkmcnt(6)
    v_mfma_f32_32x32x16_bf16 v[48:63], v[84:87], v[244:247], v[48:63]
    s_mov_b64 exec, s[86:87]
    ds_read_b128 v[136:139], v119 offset:34816
    ds_read_b128 v[140:143], v119 offset:35840
    s_mov_b64 exec, -1
    s_waitcnt lgkmcnt(6)
    v_mfma_f32_32x32x16_bf16 v[48:63], v[64:67], v[248:251], v[48:63]
    s_waitcnt lgkmcnt(4)
    v_mfma_f32_32x32x16_bf16 v[48:63], v[68:71], v[252:255], v[48:63]
    s_nop 11
    v_pk_mul_f32 v[48:49], v[48:49], s[76:77]
    v_pk_mul_f32 v[50:51], v[50:51], s[76:77]
    v_pk_mul_f32 v[52:53], v[52:53], s[76:77]
    v_pk_mul_f32 v[54:55], v[54:55], s[76:77]
    v_pk_mul_f32 v[56:57], v[56:57], s[76:77]
    v_pk_mul_f32 v[58:59], v[58:59], s[76:77]
    v_pk_mul_f32 v[60:61], v[60:61], s[76:77]
    v_pk_mul_f32 v[62:63], v[62:63], s[76:77]
    v_cvt_pk_bf16_f32 v48, v48, v49
    v_cvt_pk_bf16_f32 v49, v50, v51
    v_cvt_pk_bf16_f32 v50, v52, v53
    v_cvt_pk_bf16_f32 v51, v54, v55
    v_cvt_pk_bf16_f32 v52, v56, v57
    v_cvt_pk_bf16_f32 v53, v58, v59
    v_cvt_pk_bf16_f32 v54, v60, v61
    v_cvt_pk_bf16_f32 v55, v62, v63
    s_waitcnt lgkmcnt(0)
    v_mfma_f32_32x32x16_bf16 v[160:175], v[128:131], v[48:51], v[16:31]
    v_mfma_f32_32x32x16_bf16 v[176:191], v[132:135], v[52:55], v[16:31]
    s_mov_b64 exec, s[88:89]
    ds_read_b128 v[144:147], v119 offset:34816
    ds_read_b128 v[148:151], v119 offset:35840
    s_mov_b64 exec, -1
    s_nop 6
    v_exp_f32 v160, v160
    v_exp_f32 v161, v161
    v_exp_f32 v162, v162
    v_exp_f32 v163, v163
    v_exp_f32 v164, v164
    v_exp_f32 v165, v165
    v_exp_f32 v166, v166
    v_exp_f32 v167, v167
    v_cvt_pk_bf16_f32 v192, v160, v161
    v_cvt_pk_bf16_f32 v193, v162, v163
    v_cvt_pk_bf16_f32 v194, v164, v165
    v_cvt_pk_bf16_f32 v195, v166, v167
    v_exp_f32 v168, v168
    v_exp_f32 v169, v169
    v_exp_f32 v170, v170
    v_exp_f32 v171, v171
    v_mfma_f32_32x32x16_bf16 v[208:223], v[136:139], v[192:195], 0
    s_waitcnt vmcnt(4)
    s_barrier
    ds_read_b128 v[128:131], v119 offset:28672
    s_add_u32 s65, s3, 0
    s_and_b32 s65, s65, 3
    s_mul_i32 s65, s65, 28672
    s_add_u32 s1, s63, s65
    s_lshl4_add_u32 s0, s65, s62
    s_add_u32 m0, s1, 0
    s_nop 0
    buffer_load_dwordx4 v112, s[44:47], s0 offen lds
    s_add_u32 m0, s1, 1024
    s_nop 0
    buffer_load_dwordx4 v113, s[44:47], s0 offen lds
    s_add_u32 m0, s1, 2048
    s_nop 0
    buffer_load_dwordx4 v114, s[44:47], s0 offen lds
    s_add_u32 m0, s1, 3072
    v_exp_f32 v172, v172
    v_exp_f32 v173, v173
    v_exp_f32 v174, v174
    v_exp_f32 v175, v175
    v_cvt_pk_bf16_f32 v196, v168, v169
    v_cvt_pk_bf16_f32 v197, v170, v171
    v_cvt_pk_bf16_f32 v198, v172, v173
    v_cvt_pk_bf16_f32 v199, v174, v175
    s_waitcnt lgkmcnt(0)
    v_mfma_f32_32x32x16_bf16 v[160:175], v[128:131], v[48:51], 0
    s_cmp_lt_u32 s6, 1
    ds_read_b128 v[132:135], v119 offset:29696
    buffer_load_dwordx4 v115, s[44:47], s0 offen lds
    v_exp_f32 v176, v176
    v_exp_f32 v177, v177
    v_exp_f32 v178, v178
    v_exp_f32 v179, v179
    v_mfma_f32_32x32x16_bf16 v[208:223], v[140:143], v[196:199], v[208:223]
    s_cselect_b64 exec, -1, s[86:87]
    ds_read_b128 v[136:139], v119 offset:30720
    ds_read_b128 v[140:143], v119 offset:31744
    s_mov_b64 exec, -1
    s_add_u32 m0, s1, 4096
    v_exp_f32 v180, v180
    v_exp_f32 v181, v181
    v_exp_f32 v182, v182
    v_exp_f32 v183, v183
    v_cvt_pk_bf16_f32 v200, v176, v177
    v_cvt_pk_bf16_f32 v201, v178, v179
    v_cvt_pk_bf16_f32 v202, v180, v181
    v_cvt_pk_bf16_f32 v203, v182, v183
    v_exp_f32 v184, v184
    v_exp_f32 v185, v185
    v_exp_f32 v186, v186
    v_exp_f32 v187, v187
    v_mfma_f32_32x32x16_bf16 v[224:239], v[144:147], v[200:203], 0
    s_waitcnt lgkmcnt(0)
    buffer_load_dwordx4 v116, s[44:47], s0 offen lds
    s_bitcmp1_b32 s64, 31
    s_cbranch_scc1 L_norole_64
    s_mov_b64 exec, 1
    buffer_store_dword v3, off, s[52:55], s67 sc1
    s_mov_b64 exec, -1
L_norole_64:
    v_exp_f32 v188, v188
    v_exp_f32 v189, v189
    v_exp_f32 v190, v190
    v_exp_f32 v191, v191
    v_cvt_pk_bf16_f32 v204, v184, v185
    v_cvt_pk_bf16_f32 v205, v186, v187
    v_cvt_pk_bf16_f32 v206, v188, v189
    v_cvt_pk_bf16_f32 v207, v190, v191
    v_mfma_f32_32x32x16_bf16 v[176:191], v[132:135], v[52:55], 0
    s_cmp_lt_u32 s6, 1
    ds_read_b128 v[128:131], v119 offset:24576
    v_exp_f32 v160, v160
    v_exp_f32 v161, v161
    v_exp_f32 v162, v162
    v_exp_f32 v163, v163
    v_mfma_f32_32x32x16_bf16 v[224:239], v[148:151], v[204:207], v[224:239]
    s_cselect_b64 exec, -1, s[88:89]
    ds_read_b128 v[144:147], v119 offset:30720
    ds_read_b128 v[148:151], v119 offset:31744
    s_mov_b64 exec, -1
    s_add_u32 m0, s1, 5120
    v_exp_f32 v164, v164
    v_exp_f32 v165, v165
    v_exp_f32 v166, v166
    v_exp_f32 v167, v167
    v_cvt_pk_bf16_f32 v192, v160, v161
    v_cvt_pk_bf16_f32 v193, v162, v163
    v_cvt_pk_bf16_f32 v194, v164, v165
    v_cvt_pk_bf16_f32 v195, v166, v167
    v_exp_f32 v168, v168
    v_exp_f32 v169, v169
    v_exp_f32 v170, v170
    v_exp_f32 v171, v171
    v_mfma_f32_32x32x16_bf16 v[208:223], v[136:139], v[192:195], v[208:223]
    s_waitcnt lgkmcnt(0)
    buffer_load_dwordx4 v117, s[44:47], s0 offen lds
    s_add_u32 m0, s1, 6144
    v_exp_f32 v172, v172
    v_exp_f32 v173, v173
    v_exp_f32 v174, v174
    v_exp_f32 v175, v175
    v_cvt_pk_bf16_f32 v196, v168, v169
    v_cvt_pk_bf16_f32 v197, v170, v171
    v_cvt_pk_bf16_f32 v198, v172, v173
    v_cvt_pk_bf16_f32 v199, v174, v175
    v_mfma_f32_32x32x16_bf16 v[160:175], v[128:131], v[48:51], 0
    s_cmp_lt_u32 s6, 2
    ds_read_b128 v[132:135], v119 offset:25600
    buffer_load_dwordx4 v118, s[44:47], s0 offen lds
    v_exp_f32 v176, v176
    v_exp_f32 v177, v177
    v_exp_f32 v178, v178
    v_exp_f32 v179, v179
    v_mfma_f32_32x32x16_bf16 v[208:223], v[140:143], v[196:199], v[208:223]
    s_cselect_b64 exec, -1, s[86:87]
    ds_read_b128 v[136:139], v119 offset:26624
    ds_read_b128 v[140:143], v119 offset:27648
    s_mov_b64 exec, -1
    s_add_u32 s65, s3, 1
    s_and_b32 s65, s65, 3
    s_mul_i32 s65, s65, 28672
    s_add_u32 s1, s63, s65
    s_lshl4_add_u32 s0, s65, s62
    s_add_u32 m0, s1, 0
    v_exp_f32 v180, v180
    v_exp_f32 v181, v181
    v_exp_f32 v182, v182
    v_exp_f32 v183, v183
    v_cvt_pk_bf16_f32 v200, v176, v177
    v_cvt_pk_bf16_f32 v201, v178, v179
    v_cvt_pk_bf16_f32 v202, v180, v181
    v_cvt_pk_bf16_f32 v203, v182, v183
    v_exp_f32 v184, v184
    v_exp_f32 v185, v185
    v_exp_f32 v186, v186
    v_exp_f32 v187, v187
    v_mfma_f32_32x32x16_bf16 v[224:239], v[144:147], v[200:203], v[224:239]
    s_waitcnt lgkmcnt(0)
    buffer_load_dwordx4 v112, s[44:47], s0 offen lds
    s_add_u32 m0, s1, 1024
    v_exp_f32 v188, v188
    v_exp_f32 v189, v189
    v_exp_f32 v190, v190
    v_exp_f32 v191, v191
    v_cvt_pk_bf16_f32 v204, v184, v185
    v_cvt_pk_bf16_f32 v205, v186, v187
    v_cvt_pk_bf16_f32 v206, v188, v189
    v_cvt_pk_bf16_f32 v207, v190, v191
    v_mfma_f32_32x32x16_bf16 v[176:191], v[132:135], v[52:55], 0
    s_cmp_lt_u32 s6, 2
    ds_read_b128 v[128:131], v119 offset:20480
    buffer_load_dwordx4 v113, s[44:47], s0 offen lds
    v_exp_f32 v160, v160
    v_exp_f32 v161, v161
    v_exp_f32 v162, v162
    v_exp_f32 v163, v163
    v_mfma_f32_32x32x16_bf16 v[224:239], v[148:151], v[204:207], v[224:239]
    s_cselect_b64 exec, -1, s[88:89]
    ds_read_b128 v[144:147], v119 offset:26624
    ds_read_b128 v[148:151], v119 offset:27648
    s_mov_b64 exec, -1
    s_add_u32 m0, s1, 2048
    v_exp_f32 v164, v164
    v_exp_f32 v165, v165
    v_exp_f32 v166, v166
    v_exp_f32 v167, v167
    v_cvt_pk_bf16_f32 v192, v160, v161
    v_cvt_pk_bf16_f32 v193, v162, v163
    v_cvt_pk_bf16_f32 v194, v164, v165
    v_cvt_pk_bf16_f32 v195, v166, v167
    v_exp_f32 v168, v168
    v_exp_f32 v169, v169
    v_exp_f32 v170, v170
    v_exp_f32 v171, v171
    v_mfma_f32_32x32x16_bf16 v[208:223], v[136:139], v[192:195], v[208:223]
    s_waitcnt lgkmcnt(0)
    buffer_load_dwordx4 v114, s[44:47], s0 offen lds
    s_add_u32 m0, s1, 3072
    v_exp_f32 v172, v172
    v_exp_f32 v173, v173
    v_exp_f32 v174, v174
    v_exp_f32 v175, v175
    v_cvt_pk_bf16_f32 v196, v168, v169
    v_cvt_pk_bf16_f32 v197, v170, v171
    v_cvt_pk_bf16_f32 v198, v172, v173
    v_cvt_pk_bf16_f32 v199, v174, v175
    v_mfma_f32_32x32x16_bf16 v[160:175], v[128:131], v[48:51], 0
    s_cmp_lt_u32 s6, 3
    ds_read_b128 v[132:135], v119 offset:21504
    buffer_load_dwordx4 v115, s[44:47], s0 offen lds
    v_exp_f32 v176, v176
    v_exp_f32 v177, v177
    v_exp_f32 v178, v178
    v_exp_f32 v179, v179
    v_mfma_f32_32x32x16_bf16 v[208:223], v[140:143], v[196:199], v[208:223]
    s_cselect_b64 exec, -1, s[86:87]
    ds_read_b128 v[136:139], v119 offset:22528
    ds_read_b128 v[140:143], v119 offset:23552
    s_mov_b64 exec, -1
    s_add_u32 m0, s1, 4096
    v_exp_f32 v180, v180
    v_exp_f32 v181, v181
    v_exp_f32 v182, v182
    v_exp_f32 v183, v183
    v_cvt_pk_bf16_f32 v200, v176, v177
    v_cvt_pk_bf16_f32 v201, v178, v179
    v_cvt_pk_bf16_f32 v202, v180, v181
    v_cvt_pk_bf16_f32 v203, v182, v183
    v_exp_f32 v184, v184
    v_exp_f32 v185, v185
    v_exp_f32 v186, v186
    v_exp_f32 v187, v187
    v_mfma_f32_32x32x16_bf16 v[224:239], v[144:147], v[200:203], v[224:239]
    s_waitcnt lgkmcnt(0)
    buffer_load_dwordx4 v116, s[44:47], s0 offen lds
    s_add_u32 m0, s1, 5120
    v_exp_f32 v188, v188
    v_exp_f32 v189, v189
    v_exp_f32 v190, v190
    v_exp_f32 v191, v191
    v_cvt_pk_bf16_f32 v204, v184, v185
    v_cvt_pk_bf16_f32 v205, v186, v187
    v_cvt_pk_bf16_f32 v206, v188, v189
    v_cvt_pk_bf16_f32 v207, v190, v191
    v_mfma_f32_32x32x16_bf16 v[176:191], v[132:135], v[52:55], 0
    s_cmp_lt_u32 s6, 3
    ds_read_b128 v[128:131], v119 offset:16384
    buffer_load_dwordx4 v117, s[44:47], s0 offen lds
    v_exp_f32 v160, v160
    v_exp_f32 v161, v161
    v_exp_f32 v162, v162
    v_exp_f32 v163, v163
    v_mfma_f32_32x32x16_bf16 v[224:239], v[148:151], v[204:207], v[224:239]
    s_cselect_b64 exec, -1, s[88:89]
    ds_read_b128 v[144:147], v119 offset:22528
    ds_read_b128 v[148:151], v119 offset:23552
    s_mov_b64 exec, -1
    s_add_u32 m0, s1, 6144
    v_exp_f32 v164, v164
    v_exp_f32 v165, v165
    v_exp_f32 v166, v166
    v_exp_f32 v167, v167
    v_cvt_pk_bf16_f32 v192, v160, v161
    v_cvt_pk_bf16_f32 v193, v162, v163
    v_cvt_pk_bf16_f32 v194, v164, v165
    v_cvt_pk_bf16_f32 v195, v166, v167
    v_exp_f32 v168, v168
    v_exp_f32 v169, v169
    v_exp_f32 v170, v170
    v_exp_f32 v171, v171
    v_mfma_f32_32x32x16_bf16 v[208:223], v[136:139], v[192:195], v[208:223]
    s_waitcnt lgkmcnt(0)
    buffer_load_dwordx4 v118, s[44:47], s0 offen lds
    s_add_u32 s65, s3, 2
    s_and_b32 s65, s65, 3
    s_mul_i32 s65, s65, 28672
    s_add_u32 s1, s63, s65
    s_lshl4_add_u32 s0, s65, s62
    s_add_u32 m0, s1, 0
    v_exp_f32 v172, v172
    v_exp_f32 v173, v173
    v_exp_f32 v174, v174
    v_exp_f32 v175, v175
    v_cvt_pk_bf16_f32 v196, v168, v169
    v_cvt_pk_bf16_f32 v197, v170, v171
    v_cvt_pk_bf16_f32 v198, v172, v173
    v_cvt_pk_bf16_f32 v199, v174, v175
    v_mfma_f32_32x32x16_bf16 v[160:175], v[128:131], v[48:51], 0
    s_cmp_lt_u32 s6, 4
    ds_read_b128 v[132:135], v119 offset:17408
    buffer_load_dwordx4 v112, s[44:47], s0 offen lds
    v_exp_f32 v176, v176
    v_exp_f32 v177, v177
    v_exp_f32 v178, v178
    v_exp_f32 v179, v179
    v_mfma_f32_32x32x16_bf16 v[208:223], v[140:143], v[196:199], v[208:223]
    s_cselect_b64 exec, -1, s[86:87]
    ds_read_b128 v[136:139], v119 offset:18432
    ds_read_b128 v[140:143], v119 offset:19456
    s_mov_b64 exec, -1
    s_add_u32 m0, s1, 1024
    v_exp_f32 v180, v180
    v_exp_f32 v181, v181
    v_exp_f32 v182, v182
    v_exp_f32 v183, v183
    v_cvt_pk_bf16_f32 v200, v176, v177
    v_cvt_pk_bf16_f32 v201, v178, v179
    v_cvt_pk_bf16_f32 v202, v180, v181
    v_cvt_pk_bf16_f32 v203, v182, v183
    v_exp_f32 v184, v184
    v_exp_f32 v185, v185
    v_exp_f32 v186, v186
    v_exp_f32 v187, v187
    v_mfma_f32_32x32x16_bf16 v[224:239], v[144:147], v[200:203], v[224:239]
    s_waitcnt vmcnt(15) lgkmcnt(0)
    s_barrier
    buffer_load_dwordx4 v113, s[44:47], s0 offen lds
    s_add_u32 m0, s1, 2048
    v_exp_f32 v188, v188
    v_exp_f32 v189, v189
    v_exp_f32 v190, v190
    v_exp_f32 v191, v191
    v_cvt_pk_bf16_f32 v204, v184, v185
    v_cvt_pk_bf16_f32 v205, v186, v187
    v_cvt_pk_bf16_f32 v206, v188, v189
    v_cvt_pk_bf16_f32 v207, v190, v191
    v_mfma_f32_32x32x16_bf16 v[176:191], v[132:135], v[52:55], 0
    s_cmp_lt_u32 s6, 4
    ds_read_b128 v[128:131], v119 offset:12288
    buffer_load_dwordx4 v114, s[44:47], s0 offen lds
    v_exp_f32 v160, v160
    v_exp_f32 v161, v161
    v_exp_f32 v162, v162
    v_exp_f32 v163, v163
    v_mfma_f32_32x32x16_bf16 v[224:239], v[148:151], v[204:207], v[224:239]
    s_cselect_b64 exec, -1, s[88:89]
    ds_read_b128 v[144:147], v119 offset:18432
    ds_read_b128 v[148:151], v119 offset:19456
    s_mov_b64 exec, -1
    s_add_u32 m0, s1, 3072
    v_exp_f32 v164, v164
    v_exp_f32 v165, v165
    v_exp_f32 v166, v166
    v_exp_f32 v167, v167
    v_cvt_pk_bf16_f32 v192, v160, v161
    v_cvt_pk_bf16_f32 v193, v162, v163
    v_cvt_pk_bf16_f32 v194, v164, v165
    v_cvt_pk_bf16_f32 v195, v166, v167
    v_exp_f32 v168, v168
    v_exp_f32 v169, v169
    v_exp_f32 v170, v170
    v_exp_f32 v171, v171
    v_mfma_f32_32x32x16_bf16 v[208:223], v[136:139], v[192:195], v[208:223]
    s_waitcnt lgkmcnt(0)
    buffer_load_dwordx4 v115, s[44:47], s0 offen lds
    s_add_u32 m0, s1, 4096
    v_exp_f32 v172, v172
    v_exp_f32 v173, v173
    v_exp_f32 v174, v174
    v_exp_f32 v175, v175
    v_cvt_pk_bf16_f32 v196, v168, v169
    v_cvt_pk_bf16_f32 v197, v170, v171
    v_cvt_pk_bf16_f32 v198, v172, v173
    v_cvt_pk_bf16_f32 v199, v174, v175
    v_mfma_f32_32x32x16_bf16 v[160:175], v[128:131], v[48:51], 0
    s_cmp_lt_u32 s6, 5
    ds_read_b128 v[132:135], v119 offset:13312
    buffer_load_dwordx4 v116, s[44:47], s0 offen lds
    v_exp_f32 v176, v176
    v_exp_f32 v177, v177
    v_exp_f32 v178, v178
    v_exp_f32 v179, v179
    v_mfma_f32_32x32x16_bf16 v[208:223], v[140:143], v[196:199], v[208:223]
    s_cselect_b64 exec, -1, s[86:87]
    ds_read_b128 v[136:139], v119 offset:14336
    ds_read_b128 v[140:143], v119 offset:15360
    s_mov_b64 exec, -1
    s_add_u32 m0, s1, 5120
    v_exp_f32 v180, v180
    v_exp_f32 v181, v181
    v_exp_f32 v182, v182
    v_exp_f32 v183, v183
    v_cvt_pk_bf16_f32 v200, v176, v177
    v_cvt_pk_bf16_f32 v201, v178, v179
    v_cvt_pk_bf16_f32 v202, v180, v181
    v_cvt_pk_bf16_f32 v203, v182, v183
    v_exp_f32 v184, v184
    v_exp_f32 v185, v185
    v_exp_f32 v186, v186
    v_exp_f32 v187, v187
    v_mfma_f32_32x32x16_bf16 v[224:239], v[144:147], v[200:203], v[224:239]
    s_waitcnt lgkmcnt(0)
    buffer_load_dwordx4 v117, s[44:47], s0 offen lds
    s_add_u32 m0, s1, 6144
    v_exp_f32 v188, v188
    v_exp_f32 v189, v189
    v_exp_f32 v190, v190
    v_exp_f32 v191, v191
    v_cvt_pk_bf16_f32 v204, v184, v185
    v_cvt_pk_bf16_f32 v205, v186, v187
    v_cvt_pk_bf16_f32 v206, v188, v189
    v_cvt_pk_bf16_f32 v207, v190, v191
    v_mfma_f32_32x32x16_bf16 v[176:191], v[132:135], v[52:55], 0
    s_cmp_lt_u32 s6, 5
    ds_read_b128 v[128:131], v119 offset:8192
    buffer_load_dwordx4 v118, s[44:47], s0 offen lds
    v_exp_f32 v160, v160
    v_exp_f32 v161, v161
    v_exp_f32 v162, v162
    v_exp_f32 v163, v163
    v_mfma_f32_32x32x16_bf16 v[224:239], v[148:151], v[204:207], v[224:239]
    s_cselect_b64 exec, -1, s[88:89]
    ds_read_b128 v[144:147], v119 offset:14336
    ds_read_b128 v[148:151], v119 offset:15360
    s_mov_b64 exec, -1
    s_add_u32 s65, s3, 3
    s_and_b32 s65, s65, 3
    s_mul_i32 s65, s65, 28672
    s_add_u32 s1, s63, s65
    s_lshl4_add_u32 s0, s65, s62
    s_add_u32 m0, s1, 0
    v_exp_f32 v164, v164
    v_exp_f32 v165, v165
    v_exp_f32 v166, v166
    v_exp_f32 v167, v167
    v_cvt_pk_bf16_f32 v192, v160, v161
    v_cvt_pk_bf16_f32 v193, v162, v163
    v_cvt_pk_bf16_f32 v194, v164, v165
    v_cvt_pk_bf16_f32 v195, v166, v167
    v_exp_f32 v168, v168
    v_exp_f32 v169, v169
    v_exp_f32 v170, v170
    v_exp_f32 v171, v171
    v_mfma_f32_32x32x16_bf16 v[208:223], v[136:139], v[192:195], v[208:223]
    s_waitcnt lgkmcnt(0)
    buffer_load_dwordx4 v112, s[44:47], s0 offen lds
    s_add_u32 m0, s1, 1024
    v_exp_f32 v172, v172
    v_exp_f32 v173, v173
    v_exp_f32 v174, v174
    v_exp_f32 v175, v175
    v_cvt_pk_bf16_f32 v196, v168, v169
    v_cvt_pk_bf16_f32 v197, v170, v171
    v_cvt_pk_bf16_f32 v198, v172, v173
    v_cvt_pk_bf16_f32 v199, v174, v175
    v_mfma_f32_32x32x16_bf16 v[160:175], v[128:131], v[48:51], 0
    s_cmp_lt_u32 s6, 6
    ds_read_b128 v[132:135], v119 offset:9216
    buffer_load_dwordx4 v113, s[44:47], s0 offen lds
    v_exp_f32 v176, v176
    v_exp_f32 v177, v177
    v_exp_f32 v178, v178
    v_exp_f32 v179, v179
    v_mfma_f32_32x32x16_bf16 v[208:223], v[140:143], v[196:199], v[208:223]
    s_cselect_b64 exec, -1, s[86:87]
    ds_read_b128 v[136:139], v119 offset:10240
    ds_read_b128 v[140:143], v119 offset:11264
    s_mov_b64 exec, -1
    s_add_u32 m0, s1, 2048
    v_exp_f32 v180, v180
    v_exp_f32 v181, v181
    v_exp_f32 v182, v182
    v_exp_f32 v183, v183
    v_cvt_pk_bf16_f32 v200, v176, v177
    v_cvt_pk_bf16_f32 v201, v178, v179
    v_cvt_pk_bf16_f32 v202, v180, v181
    v_cvt_pk_bf16_f32 v203, v182, v183
    v_exp_f32 v184, v184
    v_exp_f32 v185, v185
    v_exp_f32 v186, v186
    v_exp_f32 v187, v187
    v_mfma_f32_32x32x16_bf16 v[224:239], v[144:147], v[200:203], v[224:239]
    s_waitcnt lgkmcnt(0)
    buffer_load_dwordx4 v114, s[44:47], s0 offen lds
    s_add_u32 m0, s1, 3072
    v_exp_f32 v188, v188
    v_exp_f32 v189, v189
    v_exp_f32 v190, v190
    v_exp_f32 v191, v191
    v_cvt_pk_bf16_f32 v204, v184, v185
    v_cvt_pk_bf16_f32 v205, v186, v187
    v_cvt_pk_bf16_f32 v206, v188, v189
    v_cvt_pk_bf16_f32 v207, v190, v191
    v_mfma_f32_32x32x16_bf16 v[176:191], v[132:135], v[52:55], 0
    s_cmp_lt_u32 s6, 6
    ds_read_b128 v[128:131], v119 offset:4096
    buffer_load_dwordx4 v115, s[44:47], s0 offen lds
    v_exp_f32 v160, v160
    v_exp_f32 v161, v161
    v_exp_f32 v162, v162
    v_exp_f32 v163, v163
    v_mfma_f32_32x32x16_bf16 v[224:239], v[148:151], v[204:207], v[224:239]
    s_cselect_b64 exec, -1, s[88:89]
    ds_read_b128 v[144:147], v119 offset:10240
    ds_read_b128 v[148:151], v119 offset:11264
    s_mov_b64 exec, -1
    v_exp_f32 v164, v164
    v_exp_f32 v165, v165
    v_exp_f32 v166, v166
    v_exp_f32 v167, v167
    v_cvt_pk_bf16_f32 v192, v160, v161
    v_cvt_pk_bf16_f32 v193, v162, v163
    v_cvt_pk_bf16_f32 v194, v164, v165
    v_cvt_pk_bf16_f32 v195, v166, v167
    v_exp_f32 v168, v168
    v_exp_f32 v169, v169
    v_exp_f32 v170, v170
    v_exp_f32 v171, v171
    v_mfma_f32_32x32x16_bf16 v[208:223], v[136:139], v[192:195], v[208:223]
    s_waitcnt lgkmcnt(0)
    buffer_load_dword v15, v126, s[52:55], 0 offen offset:0 sc1
    s_add_u32 m0, s1, 4096
    v_exp_f32 v172, v172
    v_exp_f32 v173, v173
    v_exp_f32 v174, v174
    v_exp_f32 v175, v175
    v_cvt_pk_bf16_f32 v196, v168, v169
    v_cvt_pk_bf16_f32 v197, v170, v171
    v_cvt_pk_bf16_f32 v198, v172, v173
    v_cvt_pk_bf16_f32 v199, v174, v175
    v_mfma_f32_32x32x16_bf16 v[160:175], v[128:131], v[48:51], 0
    s_cmp_lt_u32 s6, 7
    ds_read_b128 v[132:135], v119 offset:5120
    buffer_load_dwordx4 v116, s[44:47], s0 offen lds
    v_exp_f32 v176, v176
    v_exp_f32 v177, v177
    v_exp_f32 v178, v178
    v_exp_f32 v179, v179
    v_mfma_f32_32x32x16_bf16 v[208:223], v[140:143], v[196:199], v[208:223]
    s_cselect_b64 exec, -1, s[86:87]
    ds_read_b128 v[136:139], v119 offset:6144
    ds_read_b128 v[140:143], v119 offset:7168
    s_mov_b64 exec, -1
    s_add_u32 m0, s1, 5120
    v_exp_f32 v180, v180
    v_exp_f32 v181, v181
    v_exp_f32 v182, v182
    v_exp_f32 v183, v183
    v_cvt_pk_bf16_f32 v200, v176, v177
    v_cvt_pk_bf16_f32 v201, v178, v179
    v_cvt_pk_bf16_f32 v202, v180, v181
    v_cvt_pk_bf16_f32 v203, v182, v183
    v_exp_f32 v184, v184
    v_exp_f32 v185, v185
    v_exp_f32 v186, v186
    v_exp_f32 v187, v187
    v_mfma_f32_32x32x16_bf16 v[224:239], v[144:147], v[200:203], v[224:239]
    s_waitcnt lgkmcnt(0)
    buffer_load_dwordx4 v117, s[44:47], s0 offen lds
    v_exp_f32 v188, v188
    v_exp_f32 v189, v189
    v_exp_f32 v190, v190
    v_exp_f32 v191, v191
    v_cvt_pk_bf16_f32 v204, v184, v185
    v_cvt_pk_bf16_f32 v205, v186, v187
    v_cvt_pk_bf16_f32 v206, v188, v189
    v_cvt_pk_bf16_f32 v207, v190, v191
    v_mfma_f32_32x32x16_bf16 v[176:191], v[132:135], v[52:55], 0
    s_cmp_lt_u32 s6, 7
    ds_read_b128 v[128:131], v119 offset:0
    s_mov_b32 s65, 0
    buffer_load_dwordx4 v[64:67], v124, s[52:55], s65 offen sc1
    v_exp_f32 v160, v160
    v_exp_f32 v161, v161
    v_exp_f32 v162, v162
    v_exp_f32 v163, v163
    v_mfma_f32_32x32x16_bf16 v[224:239], v[148:151], v[204:207], v[224:239]
    s_cselect_b64 exec, -1, s[88:89]
    ds_read_b128 v[144:147], v119 offset:6144
    ds_read_b128 v[148:151], v119 offset:7168
    s_mov_b64 exec, -1
    v_exp_f32 v164, v164
    v_exp_f32 v165, v165
    v_exp_f32 v166, v166
    v_exp_f32 v167, v167
    v_cvt_pk_bf16_f32 v192, v160, v161
    v_cvt_pk_bf16_f32 v193, v162, v163
    v_cvt_pk_bf16_f32 v194, v164, v165
    v_cvt_pk_bf16_f32 v195, v166, v167
    v_exp_f32 v168, v168
    v_exp_f32 v169, v169
    v_exp_f32 v170, v170
    v_exp_f32 v171, v171
    v_mfma_f32_32x32x16_bf16 v[208:223], v[136:139], v[192:195], v[208:223]
    s_waitcnt lgkmcnt(0)
    s_mov_b32 s65, 12288
    buffer_load_dwordx4 v[68:71], v124, s[52:55], s65 offen sc1
    v_exp_f32 v172, v172
    v_exp_f32 v173, v173
    v_exp_f32 v174, v174
    v_exp_f32 v175, v175
    v_cvt_pk_bf16_f32 v196, v168, v169
    v_cvt_pk_bf16_f32 v197, v170, v171
    v_cvt_pk_bf16_f32 v198, v172, v173
    v_cvt_pk_bf16_f32 v199, v174, v175
    v_mfma_f32_32x32x16_bf16 v[160:175], v[128:131], v[48:51], v[32:47]
    s_cmp_lt_u32 s6, 8
    ds_read_b128 v[132:135], v119 offset:1024
    s_mov_b32 s65, 24576
    buffer_load_dwordx4 v[72:75], v124, s[52:55], s65 offen sc1
    v_exp_f32 v176, v176
    v_exp_f32 v177, v177
    v_exp_f32 v178, v178
    v_exp_f32 v179, v179
    v_mfma_f32_32x32x16_bf16 v[208:223], v[140:143], v[196:199], v[208:223]
    s_cselect_b64 exec, -1, s[86:87]
    ds_read_b128 v[136:139], v119 offset:2048
    ds_read_b128 v[140:143], v119 offset:3072
    s_mov_b64 exec, -1
    v_exp_f32 v180, v180
    v_exp_f32 v181, v181
    v_exp_f32 v182, v182
    v_exp_f32 v183, v183
    v_cvt_pk_bf16_f32 v200, v176, v177
    v_cvt_pk_bf16_f32 v201, v178, v179
    v_cvt_pk_bf16_f32 v202, v180, v181
    v_cvt_pk_bf16_f32 v203, v182, v183
    v_exp_f32 v184, v184
    v_exp_f32 v185, v185
    v_exp_f32 v186, v186
    v_exp_f32 v187, v187
    v_mfma_f32_32x32x16_bf16 v[224:239], v[144:147], v[200:203], v[224:239]
    s_waitcnt lgkmcnt(0)
    s_mov_b32 s65, 36864
    buffer_load_dwordx4 v[76:79], v124, s[52:55], s65 offen sc1
    v_exp_f32 v188, v188
    v_exp_f32 v189, v189
    v_exp_f32 v190, v190
    v_exp_f32 v191, v191
    v_cvt_pk_bf16_f32 v204, v184, v185
    v_cvt_pk_bf16_f32 v205, v186, v187
    v_cvt_pk_bf16_f32 v206, v188, v189
    v_cvt_pk_bf16_f32 v207, v190, v191
    v_mfma_f32_32x32x16_bf16 v[176:191], v[132:135], v[52:55], v[32:47]
    s_cmp_lt_u32 s6, 8
    buffer_load_dwordx4 v[80:83], v125, s[52:55], 0 offen sc1
    v_exp_f32 v160, v160
    v_exp_f32 v161, v161
    v_exp_f32 v162, v162
    v_exp_f32 v163, v163
    v_mfma_f32_32x32x16_bf16 v[224:239], v[148:151], v[204:207], v[224:239]
    s_cselect_b64 exec, -1, s[88:89]
    ds_read_b128 v[144:147], v119 offset:2048
    ds_read_b128 v[148:151], v119 offset:3072
    s_mov_b64 exec, -1
    v_exp_f32 v164, v164
    v_exp_f32 v165, v165
    v_exp_f32 v166, v166
    v_exp_f32 v167, v167
    v_cvt_pk_bf16_f32 v192, v160, v161
    v_cvt_pk_bf16_f32 v193, v162, v163
    v_cvt_pk_bf16_f32 v194, v164, v165
    v_cvt_pk_bf16_f32 v195, v166, v167
    v_exp_f32 v168, v168
    v_exp_f32 v169, v169
    v_exp_f32 v170, v170
    v_exp_f32 v171, v171
    v_mfma_f32_32x32x16_bf16 v[208:223], v[136:139], v[192:195], v[208:223]
    s_waitcnt lgkmcnt(0)
    s_waitcnt vmcnt(7)
    v_cmp_ne_u32 vcc, s68, v15
    s_cbranch_vccnz L_fpretry_62
L_fpback_63:
    v_exp_f32 v172, v172
    v_exp_f32 v173, v173
    v_exp_f32 v174, v174
    v_exp_f32 v175, v175
    v_cvt_pk_bf16_f32 v196, v168, v169
    v_cvt_pk_bf16_f32 v197, v170, v171
    v_cvt_pk_bf16_f32 v198, v172, v173
    v_cvt_pk_bf16_f32 v199, v174, v175
    buffer_load_dwordx4 a[192:195], v2, s[52:55], s96 offen offset:0 sc1
    v_exp_f32 v176, v176
    v_exp_f32 v177, v177
    v_exp_f32 v178, v178
    v_exp_f32 v179, v179
    v_mfma_f32_32x32x16_bf16 v[208:223], v[140:143], v[196:199], v[208:223]
    v_exp_f32 v180, v180
    v_exp_f32 v181, v181
    v_exp_f32 v182, v182
    v_exp_f32 v183, v183
    v_cvt_pk_bf16_f32 v200, v176, v177
    v_cvt_pk_bf16_f32 v201, v178, v179
    v_cvt_pk_bf16_f32 v202, v180, v181
    v_cvt_pk_bf16_f32 v203, v182, v183
    v_exp_f32 v184, v184
    v_exp_f32 v185, v185
    v_exp_f32 v186, v186
    v_exp_f32 v187, v187
    v_mfma_f32_32x32x16_bf16 v[224:239], v[144:147], v[200:203], v[224:239]
    buffer_load_dwordx4 a[196:199], v2, s[52:55], s96 offen offset:1024 sc1
    v_exp_f32 v188, v188
    v_exp_f32 v189, v189
    v_exp_f32 v190, v190
    v_exp_f32 v191, v191
    v_cvt_pk_bf16_f32 v204, v184, v185
    v_cvt_pk_bf16_f32 v205, v186, v187
    v_cvt_pk_bf16_f32 v206, v188, v189
    v_cvt_pk_bf16_f32 v207, v190, v191
    s_nop 1
    v_mfma_f32_32x32x16_bf16 v[224:239], v[148:151], v[204:207], v[224:239]
    s_mov_b32 s76, 0x1f800000
    s_mov_b32 s77, 0x5f800000
    s_mov_b32 s78, 0x7f000000
    v_add_f32 v10, abs(v208), abs(v209)
    v_add_f32 v10, v10, abs(v210)
    v_add_f32 v10, v10, abs(v211)
    v_add_f32 v10, v10, abs(v212)
    v_add_f32 v10, v10, abs(v213)
    v_add_f32 v10, v10, abs(v214)
    v_add_f32 v10, v10, abs(v215)
    v_cmp_nle_f32 vcc, s76, v216
    v_cmp_nge_f32 s[92:93], s77, v216
    v_add_f32 v10, v10, abs(v232)
    v_add_f32 v10, v10, abs(v233)
    v_add_f32 v10, v10, abs(v234)
    v_add_f32 v10, v10, abs(v235)
    v_add_f32 v10, v10, abs(v236)
    v_add_f32 v10, v10, abs(v237)
    v_add_f32 v10, v10, abs(v238)
    v_add_f32 v10, v10, abs(v239)
    s_or_b64 vcc, vcc, s[92:93]
    v_cmp_nle_f32 s[92:93], s76, v224
    v_cmp_nge_f32 s[94:95], s77, v224
    v_cmp_ngt_f32 s[90:91], s78, v10
    v_rcp_f32 v10, v216
    v_rcp_f32 v12, v224
    s_or_b64 vcc, vcc, s[92:93]
    s_or_b64 vcc, vcc, s[94:95]
    s_or_b64 vcc, vcc, s[90:91]
    s_cbranch_scc1 L_fb_66
L_attok_67:
    v_pk_mul_f32 v[208:209], v[208:209], v[10:11] op_sel_hi:[1,0]
    v_pk_mul_f32 v[210:211], v[210:211], v[10:11] op_sel_hi:[1,0]
    v_pk_mul_f32 v[212:213], v[212:213], v[10:11] op_sel_hi:[1,0]
    v_pk_mul_f32 v[214:215], v[214:215], v[10:11] op_sel_hi:[1,0]
    v_cvt_pk_bf16_f32 v192, v208, v209
    v_cvt_pk_bf16_f32 v193, v210, v211
    v_cvt_pk_bf16_f32 v194, v212, v213
    v_cvt_pk_bf16_f32 v195, v214, v215
    buffer_store_dwordx4 v[192:195], v123, s[52:55], s21 offen offset:0 sc1
    v_pk_mul_f32 v[232:233], v[232:233], v[12:13] op_sel_hi:[1,0]
    v_pk_mul_f32 v[234:235], v[234:235], v[12:13] op_sel_hi:[1,0]
    v_pk_mul_f32 v[236:237], v[236:237], v[12:13] op_sel_hi:[1,0]
    v_pk_mul_f32 v[238:239], v[238:239], v[12:13] op_sel_hi:[1,0]
    v_cvt_pk_bf16_f32 v196, v232, v233
    v_cvt_pk_bf16_f32 v197, v234, v235
    v_cvt_pk_bf16_f32 v198, v236, v237
    v_cvt_pk_bf16_f32 v199, v238, v239
    buffer_store_dwordx4 v[196:199], v123, s[52:55], s21 offen offset:512 sc1
    buffer_load_dwordx4 a[200:203], v2, s[52:55], s96 offen offset:2048 sc1
    buffer_load_dwordx4 a[204:207], v2, s[52:55], s96 offen offset:3072 sc1
    s_add_u32 s96, s96, 4096
    buffer_load_dwordx4 a[208:211], v2, s[52:55], s96 offen offset:0 sc1
    buffer_load_dwordx4 a[212:215], v2, s[52:55], s96 offen offset:1024 sc1
    buffer_load_dwordx4 a[216:219], v2, s[52:55], s96 offen offset:2048 sc1
    buffer_load_dwordx4 a[220:223], v2, s[52:55], s96 offen offset:3072 sc1
    s_add_u32 s96, s96, 4096
    buffer_load_dwordx4 a[224:227], v2, s[52:55], s96 offen offset:0 sc1
    buffer_load_dwordx4 a[228:231], v2, s[52:55], s96 offen offset:1024 sc1
    s_waitcnt vmcnt(10)
    s_mov_b32 s82, 0
L_pmr_68:
    v_xor_b32 v64, s40, v64
    v_xor_b32 v65, s41, v65
    v_xor_b32 v66, s42, v66
    v_xor_b32 v67, s43, v67
    v_or3_b32 v84, v64, v65, v66
    v_or_b32 v84, v84, v67
    v_xor_b32 v68, s40, v68
    v_xor_b32 v69, s41, v69
    v_xor_b32 v70, s42, v70
    v_xor_b32 v71, s43, v71
    v_or3_b32 v84, v68, v69, v84
    v_or3_b32 v84, v70, v71, v84
    v_xor_b32 v72, s40, v72
    v_xor_b32 v73, s41, v73
    v_xor_b32 v74, s42, v74
    v_xor_b32 v75, s43, v75
    v_or3_b32 v84, v72, v73, v84
    v_or3_b32 v84, v74, v75, v84
    v_xor_b32 v76, s40, v76
    v_xor_b32 v77, s41, v77
    v_xor_b32 v78, s42, v78
    v_xor_b32 v79, s43, v79
    v_or3_b32 v84, v76, v77, v84
    v_or3_b32 v84, v78, v79, v84
    v_xor_b32 v80, s40, v80
    v_xor_b32 v81, s41, v81
    v_xor_b32 v82, s42, v82
    v_xor_b32 v83, s43, v83
    v_or3_b32 v84, v80, v81, v84
    v_or3_b32 v84, v82, v83, v84
    v_and_b32 v84, 0xff, v84
    v_cmp_ne_u32 vcc, 0, v84
    s_cbranch_vccz L_dmr_69
    s_add_u32 s82, s82, 1
    s_cmp_ge_u32 s82, 131072
    s_cbranch_scc1 L_dmr_69
    s_mov_b32 s65, 0
    buffer_load_dwordx4 v[64:67], v124, s[52:55], s65 offen sc1
    s_mov_b32 s65, 12288
    buffer_load_dwordx4 v[68:71], v124, s[52:55], s65 offen sc1
    s_mov_b32 s65, 24576
    buffer_load_dwordx4 v[72:75], v124, s[52:55], s65 offen sc1
    s_mov_b32 s65, 36864
    buffer_load_dwordx4 v[76:79], v124, s[52:55], s65 offen sc1
    buffer_load_dwordx4 v[80:83], v125, s[52:55], 0 offen sc1
    s_waitcnt vmcnt(0)
    s_branch L_pmr_68
L_dmr_69:
    s_waitcnt vmcnt(8)
    s_mov_b64 exec, 1
    buffer_store_dword v3, off, s[52:55], s9 sc1
    s_mov_b64 exec, -1
    buffer_load_dwordx4 a[232:235], v2, s[52:55], s96 offen offset:2048 sc1
    buffer_load_dwordx4 a[236:239], v2, s[52:55], s96 offen offset:3072 sc1
    s_add_u32 s96, s96, 4096
    buffer_load_dwordx4 a[240:243], v2, s[52:55], s96 offen offset:0 sc1
    s_cmp_ge_u32 s5, 2
    s_cselect_b32 s80, 1.0, 0
    v_permlane32_swap_b32 v80, v81
    v_permlane32_swap_b32 v82, v83
    v_add_f32 v80, v80, v81
    v_add_f32 v82, v82, v83
    v_pk_add_f32 v[64:65], v[64:65], v[68:69]
    v_pk_add_f32 v[72:73], v[72:73], v[76:77]
    v_pk_add_f32 v[66:67], v[66:67], v[70:71]
    v_pk_add_f32 v[74:75], v[74:75], v[78:79]
    v_pk_add_f32 v[64:65], v[64:65], v[72:73]
    v_pk_add_f32 v[66:67], v[66:67], v[74:75]
    v_cvt_pk_bf16_f32 v68, v64, v65
    v_cvt_pk_bf16_f32 v69, v66, v67
    v_lshlrev_b32 v72, 16, v68
    v_and_b32 v73, 0xffff0000, v68
    v_lshlrev_b32 v74, 16, v69
    v_and_b32 v75, 0xffff0000, v69
    v_add_f32 v72, s80, v72
    v_add_f32 v73, s80, v73
    v_add_f32 v74, s80, v74
    v_add_f32 v75, s80, v75
    v_cvt_pk_bf16_f32 v64, v72, v73
    v_cvt_pk_bf16_f32 v65, v74, v75
    v_permlane16_swap_b32 v80, v82
    v_add_f32 v80, v80, v82
    v_cvt_pk_bf16_f32 v80, v80, v80
    v_lshlrev_b32 v12, 16, v80
    s_lshl_b32 s76, s5, 11
    s_add_u32 s76, s76, 155648
    s_mov_b32 s77, 8192
    v_and_b32 v13, 15, v1
    v_lshrrev_b32 v14, 3, v1
    v_and_b32 v14, 6, v14
    v_xor_b32 v14, v14, v13
    v_and_b32 v14, 7, v14
    v_lshl_add_u32 v13, v13, 7, s76
    v_lshl_add_u32 v13, v14, 4, v13
    v_xor_b32 v14, 16, v13
    v_mov_b32 v95, v127
    s_barrier
    s_add_u32 m0, s76, 0
    s_nop 0
    buffer_load_dwordx4 v4, s[32:35], 0 offen lds
    s_add_u32 m0, s76, 1024
    s_nop 0
    buffer_load_dwordx4 v4, s[32:35], s77 offen lds
    ds_write_b64 v110, v[64:65]
    ds_write_b32 v111, v12
    s_waitcnt lgkmcnt(0)
    buffer_load_dword v15, v104, s[52:55], 0 offen offset:64 sc1
    buffer_load_dwordx4 a[244:247], v2, s[52:55], s96 offen offset:1024 sc1
    buffer_load_dwordx4 a[248:251], v2, s[52:55], s96 offen offset:2048 sc1
    buffer_load_dwordx4 a[252:255], v2, s[52:55], s96 offen offset:3072 sc1
    s_add_u32 m0, s1, 6144
    s_nop 0
    buffer_load_dwordx4 v118, s[44:47], s0 offen lds
    s_waitcnt vmcnt(4)
    v_cmp_ne_u32 vcc, s68, v15
    s_nop 0
    s_and_b64 vcc, vcc, s[60:61]
    s_cbranch_scc0 L_qo_70
    s_mov_b32 s82, 0
L_po_71:
    buffer_load_dword v15, v104, s[52:55], 0 offen offset:64 sc1
    s_add_u32 s82, s82, 1
    s_waitcnt vmcnt(0)
    v_cmp_ne_u32 vcc, s68, v15
    s_nop 0
    s_and_b64 vcc, vcc, s[60:61]
    s_cbranch_scc0 L_do_72
    s_cmp_lt_u32 s82, 131072
    s_cbranch_scc1 L_po_71
L_do_72:
L_qo_70:
    buffer_load_dwordx4 v[128:131], v2, s[52:55], s10 offen offset:0 sc1
    buffer_load_dwordx4 v[132:135], v2, s[52:55], s10 offen offset:1024 sc1
    buffer_load_dwordx4 v[136:139], v2, s[52:55], s10 offen offset:2048 sc1
    buffer_load_dwordx4 v[140:143], v2, s[52:55], s10 offen offset:3072 sc1
    buffer_load_dwordx4 v[144:147], v2, s[52:55], s11 offen offset:0 sc1
    buffer_load_dwordx4 v[148:151], v2, s[52:55], s11 offen offset:1024 sc1
    buffer_load_dwordx4 v[152:155], v2, s[52:55], s11 offen offset:2048 sc1
    buffer_load_dwordx4 v[156:159], v2, s[52:55], s11 offen offset:3072 sc1
    buffer_load_dwordx4 v[160:163], v2, s[52:55], s12 offen offset:0 sc1
    buffer_load_dwordx4 v[164:167], v2, s[52:55], s12 offen offset:1024 sc1
    buffer_load_dwordx4 v[168:171], v2, s[52:55], s12 offen offset:2048 sc1
    buffer_load_dwordx4 v[172:175], v2, s[52:55], s12 offen offset:3072 sc1
    ds_read_b128 v[192:195], v13
    ds_read_b128 v[196:199], v14
    s_waitcnt lgkmcnt(0)
    v_lshlrev_b32 v240, 16, v192
    v_and_b32 v241, 0xffff0000, v192
    v_lshlrev_b32 v242, 16, v193
    v_and_b32 v243, 0xffff0000, v193
    v_lshlrev_b32 v244, 16, v194
    v_and_b32 v245, 0xffff0000, v194
    v_lshlrev_b32 v246, 16, v195
    v_and_b32 v247, 0xffff0000, v195
    v_lshlrev_b32 v248, 16, v196
    v_and_b32 v249, 0xffff0000, v196
    v_lshlrev_b32 v250, 16, v197
    v_and_b32 v251, 0xffff0000, v197
    v_lshlrev_b32 v252, 16, v198
    v_and_b32 v253, 0xffff0000, v198
    v_lshlrev_b32 v254, 16, v199
    v_and_b32 v255, 0xffff0000, v199
    s_waitcnt vmcnt(11)
    v_mfma_f32_16x16x32_bf16 v[16:19], a[192:195], v[128:131], 0
    v_mfma_f32_16x16x32_bf16 v[20:23], a[196:199], v[128:131], 0
    buffer_load_dwordx4 v[176:179], v2, s[52:55], s13 offen offset:0 sc1
    v_mfma_f32_16x16x32_bf16 v[24:27], a[200:203], v[128:131], 0
    v_mfma_f32_16x16x32_bf16 v[28:31], a[204:207], v[128:131], 0
    s_waitcnt vmcnt(11)
    v_mfma_f32_16x16x32_bf16 v[16:19], a[208:211], v[132:135], v[16:19]
    v_mfma_f32_16x16x32_bf16 v[20:23], a[212:215], v[132:135], v[20:23]
    buffer_load_dwordx4 v[180:183], v2, s[52:55], s13 offen offset:1024 sc1
    v_mfma_f32_16x16x32_bf16 v[24:27], a[216:219], v[132:135], v[24:27]
    v_mfma_f32_16x16x32_bf16 v[28:31], a[220:223], v[132:135], v[28:31]
    s_waitcnt vmcnt(11)
    v_mfma_f32_16x16x32_bf16 v[16:19], a[224:227], v[136:139], v[16:19]
    v_mfma_f32_16x16x32_bf16 v[20:23], a[228:231], v[136:139], v[20:23]
    buffer_load_dwordx4 v[184:187], v2, s[52:55], s13 offen offset:2048 sc1
    v_mfma_f32_16x16x32_bf16 v[24:27], a[232:235], v[136:139], v[24:27]
    v_mfma_f32_16x16x32_bf16 v[28:31], a[236:239], v[136:139], v[28:31]
    s_waitcnt vmcnt(11)
    v_mfma_f32_16x16x32_bf16 v[16:19], a[240:243], v[140:143], v[16:19]
    v_mfma_f32_16x16x32_bf16 v[20:23], a[244:247], v[140:143], v[20:23]
    buffer_load_dwordx4 v[188:191], v2, s[52:55], s13 offen offset:3072 sc1
    v_mfma_f32_16x16x32_bf16 v[24:27], a[248:251], v[140:143], v[24:27]
    buffer_load_dwordx4 a[0:3], v2, s[52:55], s101 offen offset:0 sc1
    v_mfma_f32_16x16x32_bf16 v[28:31], a[252:255], v[140:143], v[28:31]
    s_waitcnt vmcnt(12)
    v_mfma_f32_16x16x32_bf16 v[32:35], a[192:195], v[144:147], 0
    v_mfma_f32_16x16x32_bf16 v[36:39], a[196:199], v[144:147], 0
    buffer_load_dwordx4 a[4:7], v2, s[52:55], s101 offen offset:1024 sc1
    v_mfma_f32_16x16x32_bf16 v[40:43], a[200:203], v[144:147], 0
    buffer_load_dwordx4 a[8:11], v2, s[52:55], s101 offen offset:2048 sc1
    v_mfma_f32_16x16x32_bf16 v[44:47], a[204:207], v[144:147], 0
    ds_write_b128 v6, v[16:19] offset:0
    s_waitcnt vmcnt(13)
    v_mfma_f32_16x16x32_bf16 v[32:35], a[208:211], v[148:151], v[32:35]
    v_mfma_f32_16x16x32_bf16 v[36:39], a[212:215], v[148:151], v[36:39]
    buffer_load_dwordx4 a[12:15], v2, s[52:55], s101 offen offset:3072 sc1
    v_mfma_f32_16x16x32_bf16 v[40:43], a[216:219], v[148:151], v[40:43]
    s_add_u32 s101, s101, 4096
    buffer_load_dwordx4 a[16:19], v2, s[52:55], s101 offen offset:0 sc1
    ds_write_b128 v6, v[20:23] offset:1024
    v_mfma_f32_16x16x32_bf16 v[44:47], a[220:223], v[148:151], v[44:47]
    s_waitcnt vmcnt(14)
    v_mfma_f32_16x16x32_bf16 v[32:35], a[224:227], v[152:155], v[32:35]
    v_mfma_f32_16x16x32_bf16 v[36:39], a[228:231], v[152:155], v[36:39]
    buffer_load_dwordx4 a[20:23], v2, s[52:55], s101 offen offset:1024 sc1
    ds_write_b128 v6, v[24:27] offset:2048
    v_mfma_f32_16x16x32_bf16 v[40:43], a[232:235], v[152:155], v[40:43]
    buffer_load_dwordx4 a[24:27], v2, s[52:55], s101 offen offset:2048 sc1
    v_mfma_f32_16x16x32_bf16 v[44:47], a[236:239], v[152:155], v[44:47]
    s_waitcnt vmcnt(15)
    v_mfma_f32_16x16x32_bf16 v[32:35], a[240:243], v[156:159], v[32:35]
    ds_write_b128 v6, v[28:31] offset:3072
    v_mfma_f32_16x16x32_bf16 v[36:39], a[244:247], v[156:159], v[36:39]
    buffer_load_dwordx4 a[28:31], v2, s[52:55], s101 offen offset:3072 sc1
    v_mfma_f32_16x16x32_bf16 v[40:43], a[248:251], v[156:159], v[40:43]
    s_add_u32 s101, s101, 4096
    buffer_load_dwordx4 a[32:35], v2, s[52:55], s101 offen offset:0 sc1
    v_mfma_f32_16x16x32_bf16 v[44:47], a[252:255], v[156:159], v[44:47]
    s_waitcnt vmcnt(16)
    v_mfma_f32_16x16x32_bf16 v[112:115], a[192:195], v[160:163], 0
    v_mfma_f32_16x16x32_bf16 v[116:119], a[196:199], v[160:163], 0
    buffer_load_dwordx4 a[36:39], v2, s[52:55], s101 offen offset:1024 sc1
    v_mfma_f32_16x16x32_bf16 v[120:123], a[200:203], v[160:163], 0
    buffer_load_dwordx4 a[40:43], v2, s[52:55], s101 offen offset:2048 sc1
    v_mfma_f32_16x16x32_bf16 v[124:127], a[204:207], v[160:163], 0
    ds_write_b128 v7, v[32:35] offset:0
    s_waitcnt vmcnt(17) lgkmcnt(1)
    s_barrier
    v_mfma_f32_16x16x32_bf16 v[112:115], a[208:211], v[164:167], v[112:115]
    ds_read_b128 v[48:51], v9 offset:0
    v_mfma_f32_16x16x32_bf16 v[116:119], a[212:215], v[164:167], v[116:119]
    buffer_load_dwordx4 a[44:47], v2, s[52:55], s101 offen offset:3072 sc1
    ds_read_b128 v[52:55], v9 offset:1024
    v_mfma_f32_16x16x32_bf16 v[120:123], a[216:219], v[164:167], v[120:123]
    s_add_u32 s101, s101, 4096
    buffer_load_dwordx4 a[48:51], v2, s[52:55], s101 offen offset:0 sc1
    ds_write_b128 v7, v[36:39] offset:1024
    ds_read_b128 v[56:59], v9 offset:2048
    v_mfma_f32_16x16x32_bf16 v[124:127], a[220:223], v[164:167], v[124:127]
    ds_read_b128 v[60:63], v9 offset:3072
    s_waitcnt vmcnt(18)
    v_mfma_f32_16x16x32_bf16 v[112:115], a[224:227], v[168:171], v[112:115]
    v_mfma_f32_16x16x32_bf16 v[116:119], a[228:231], v[168:171], v[116:119]
    buffer_load_dwordx4 a[52:55], v2, s[52:55], s101 offen offset:1024 sc1
    ds_write_b128 v7, v[40:43] offset:2048
    v_mfma_f32_16x16x32_bf16 v[120:123], a[232:235], v[168:171], v[120:123]
    buffer_load_dwordx4 a[56:59], v2, s[52:55], s101 offen offset:2048 sc1
    ds_read_b128 v[80:83], v95 offset:0
    v_mfma_f32_16x16x32_bf16 v[124:127], a[236:239], v[168:171], v[124:127]
    ds_read_b128 v[84:87], v95 offset:16
    s_waitcnt vmcnt(19)
    v_mfma_f32_16x16x32_bf16 v[112:115], a[240:243], v[172:175], v[112:115]
    ds_write_b128 v7, v[44:47] offset:3072
    v_mfma_f32_16x16x32_bf16 v[116:119], a[244:247], v[172:175], v[116:119]
    buffer_load_dwordx4 a[60:63], v2, s[52:55], s101 offen offset:3072 sc1
    ds_read_b128 v[208:211], v5 offset:0
    v_mfma_f32_16x16x32_bf16 v[120:123], a[248:251], v[172:175], v[120:123]
    s_add_u32 s101, s101, 4096
    buffer_load_dwordx4 a[64:67], v2, s[52:55], s101 offen offset:0 sc1
    ds_read_b128 v[212:215], v5 offset:16
    v_mfma_f32_16x16x32_bf16 v[124:127], a[252:255], v[172:175], v[124:127]
    ds_read_b128 v[216:219], v5 offset:32
    s_waitcnt vmcnt(20) lgkmcnt(0)
    s_barrier
    v_mfma_f32_16x16x32_bf16 v[48:51], a[192:195], v[176:179], v[48:51]
    ds_read_b128 v[64:67], v9 offset:4096
    v_mfma_f32_16x16x32_bf16 v[52:55], a[196:199], v[176:179], v[52:55]
    buffer_load_dwordx4 a[68:71], v2, s[52:55], s101 offen offset:1024 sc1
    ds_read_b128 v[68:71], v9 offset:5120
    v_mfma_f32_16x16x32_bf16 v[56:59], a[200:203], v[176:179], v[56:59]
    buffer_load_dwordx4 a[72:75], v2, s[52:55], s101 offen offset:2048 sc1
    ds_read_b128 v[72:75], v9 offset:6144
    v_mfma_f32_16x16x32_bf16 v[60:63], a[204:207], v[176:179], v[60:63]
    ds_write_b128 v8, v[112:115] offset:0
    ds_read_b128 v[76:79], v9 offset:7168
    s_waitcnt vmcnt(21)
    v_mfma_f32_16x16x32_bf16 v[48:51], a[208:211], v[180:183], v[48:51]
    ds_read_b128 v[220:223], v5 offset:48
    v_mfma_f32_16x16x32_bf16 v[52:55], a[212:215], v[180:183], v[52:55]
    buffer_load_dwordx4 a[76:79], v2, s[52:55], s101 offen offset:3072 sc1
    v_lshlrev_b32 v224, 16, v80
    v_and_b32 v225, 0xffff0000, v80
    v_mfma_f32_16x16x32_bf16 v[56:59], a[216:219], v[180:183], v[56:59]
    s_add_u32 s101, s101, 4096
    buffer_load_dwordx4 a[80:83], v2, s[52:55], s101 offen offset:0 sc1
    ds_write_b128 v8, v[116:119] offset:1024
    v_lshlrev_b32 v226, 16, v81
    v_and_b32 v227, 0xffff0000, v81
    v_mfma_f32_16x16x32_bf16 v[60:63], a[220:223], v[180:183], v[60:63]
    v_lshlrev_b32 v228, 16, v82
    v_and_b32 v229, 0xffff0000, v82
    s_waitcnt vmcnt(22)
    v_mfma_f32_16x16x32_bf16 v[48:51], a[224:227], v[184:187], v[48:51]
    v_lshlrev_b32 v230, 16, v83
    v_and_b32 v231, 0xffff0000, v83
    v_mfma_f32_16x16x32_bf16 v[52:55], a[228:231], v[184:187], v[52:55]
    buffer_load_dwordx4 a[84:87], v2, s[52:55], s101 offen offset:1024 sc1
    ds_write_b128 v8, v[120:123] offset:2048
    v_lshlrev_b32 v232, 16, v84
    v_and_b32 v233, 0xffff0000, v84
    v_mfma_f32_16x16x32_bf16 v[56:59], a[232:235], v[184:187], v[56:59]
    buffer_load_dwordx4 a[88:91], v2, s[52:55], s101 offen offset:2048 sc1
    v_lshlrev_b32 v234, 16, v85
    v_and_b32 v235, 0xffff0000, v85
    v_mfma_f32_16x16x32_bf16 v[60:63], a[236:239], v[184:187], v[60:63]
    s_waitcnt vmcnt(23)
    v_mfma_f32_16x16x32_bf16 v[48:51], a[240:243], v[188:191], v[48:51]
    ds_write_b128 v8, v[124:127] offset:3072
    v_lshlrev_b32 v238, 16, v87
    v_and_b32 v239, 0xffff0000, v87
    v_mfma_f32_16x16x32_bf16 v[52:55], a[244:247], v[188:191], v[52:55]
    buffer_load_dwordx4 a[92:95], v2, s[52:55], s101 offen offset:3072 sc1
    v_mfma_f32_16x16x32_bf16 v[56:59], a[248:251], v[188:191], v[56:59]
    v_mfma_f32_16x16x32_bf16 v[60:63], a[252:255], v[188:191], v[60:63]
    v_lshlrev_b32 v236, 16, v86
    v_and_b32 v237, 0xffff0000, v86
    s_waitcnt lgkmcnt(0)
    s_barrier
    ds_read_b128 v[32:35], v9 offset:0
    ds_read_b128 v[36:39], v9 offset:1024
    ds_read_b128 v[40:43], v9 offset:2048
    ds_read_b128 v[44:47], v9 offset:3072
    v_pk_add_f32 v[48:49], v[48:49], v[64:65]
    v_pk_add_f32 v[50:51], v[50:51], v[66:67]
    v_pk_add_f32 v[52:53], v[52:53], v[68:69]
    v_pk_add_f32 v[54:55], v[54:55], v[70:71]
    v_pk_add_f32 v[56:57], v[56:57], v[72:73]
    v_pk_add_f32 v[58:59], v[58:59], v[74:75]
    v_pk_add_f32 v[60:61], v[60:61], v[76:77]
    v_pk_add_f32 v[62:63], v[62:63], v[78:79]
    s_waitcnt lgkmcnt(3)
    v_pk_add_f32 v[48:49], v[48:49], v[32:33]
    v_pk_add_f32 v[50:51], v[50:51], v[34:35]
    s_waitcnt lgkmcnt(2)
    v_pk_add_f32 v[52:53], v[52:53], v[36:37]
    v_pk_add_f32 v[54:55], v[54:55], v[38:39]
    s_waitcnt lgkmcnt(1)
    v_pk_add_f32 v[56:57], v[56:57], v[40:41]
    v_pk_add_f32 v[58:59], v[58:59], v[42:43]
    s_waitcnt lgkmcnt(0)
    v_pk_add_f32 v[60:61], v[60:61], v[44:45]
    v_pk_add_f32 v[62:63], v[62:63], v[46:47]
    v_pk_fma_f32 v[240:241], v[48:49], v[208:209], v[240:241]
    v_pk_fma_f32 v[242:243], v[50:51], v[210:211], v[242:243]
    v_pk_fma_f32 v[244:245], v[52:53], v[212:213], v[244:245]
    v_pk_fma_f32 v[246:247], v[54:55], v[214:215], v[246:247]
    v_pk_mul_f32 v[224:225], v[240:241], v[224:225]
    v_pk_mul_f32 v[226:227], v[242:243], v[226:227]
    v_pk_mul_f32 v[228:229], v[244:245], v[228:229]
    v_pk_mul_f32 v[230:231], v[246:247], v[230:231]
    v_cvt_pk_bf16_f32 v192, v224, v225
    v_cvt_pk_bf16_f32 v193, v226, v227
    v_cvt_pk_bf16_f32 v194, v228, v229
    v_cvt_pk_bf16_f32 v195, v230, v231
    buffer_store_dwordx4 v[192:195], v2, s[52:55], s22 offen offset:0 sc1
    v_pk_fma_f32 v[248:249], v[56:57], v[216:217], v[248:249]
    v_pk_fma_f32 v[250:251], v[58:59], v[218:219], v[250:251]
    v_pk_fma_f32 v[252:253], v[60:61], v[220:221], v[252:253]
    v_pk_fma_f32 v[254:255], v[62:63], v[222:223], v[254:255]
    v_pk_mul_f32 v[232:233], v[248:249], v[232:233]
    v_pk_mul_f32 v[234:235], v[250:251], v[234:235]
    v_pk_mul_f32 v[236:237], v[252:253], v[236:237]
    v_pk_mul_f32 v[238:239], v[254:255], v[238:239]
    v_cvt_pk_bf16_f32 v196, v232, v233
    v_cvt_pk_bf16_f32 v197, v234, v235
    v_cvt_pk_bf16_f32 v198, v236, v237
    v_cvt_pk_bf16_f32 v199, v238, v239
    buffer_store_dwordx4 v[196:199], v2, s[52:55], s22 offen offset:1024 sc1
    v_pk_add_f32 v[200:201], v[240:241], v[242:243]
    v_pk_mul_f32 v[202:203], v[240:241], v[240:241]
    v_pk_fma_f32 v[202:203], v[242:243], v[242:243], v[202:203]
    v_pk_add_f32 v[200:201], v[200:201], v[244:245]
    v_pk_fma_f32 v[202:203], v[244:245], v[244:245], v[202:203]
    v_pk_add_f32 v[200:201], v[200:201], v[246:247]
    v_pk_fma_f32 v[202:203], v[246:247], v[246:247], v[202:203]
    v_pk_add_f32 v[200:201], v[200:201], v[248:249]
    v_pk_fma_f32 v[202:203], v[248:249], v[248:249], v[202:203]
    v_pk_add_f32 v[200:201], v[200:201], v[250:251]
    v_pk_fma_f32 v[202:203], v[250:251], v[250:251], v[202:203]
    v_pk_add_f32 v[200:201], v[200:201], v[252:253]
    v_pk_fma_f32 v[202:203], v[252:253], v[252:253], v[202:203]
    v_pk_add_f32 v[200:201], v[200:201], v[254:255]
    v_pk_fma_f32 v[202:203], v[254:255], v[254:255], v[202:203]
    v_add_f32 v200, v200, v201
    v_add_f32 v202, v202, v203
    s_nop 1
    v_permlane32_swap_b32 v200, v202
    v_add_f32 v200, v200, v202
    v_mov_b32 v201, v200
    s_nop 1
    v_permlane16_swap_b32 v200, v201
    v_add_f32 v200, v200, v201
    buffer_store_dword v200, v105, s[52:55], s23 offen sc1
    s_lshl_b64 s[60:61], s[60:61], 16
    ds_read_b128 v[16:19], v92 offset:0
    ds_read_b64_tr_b16 v[20:21], v88 offset:0
    ds_read_b64_tr_b16 v[22:23], v88 offset:1792
    ds_read_b64_tr_b16 v[24:25], v90 offset:0
    ds_read_b64_tr_b16 v[26:27], v90 offset:1792
    ds_read_b128 v[28:31], v92 offset:16
    ds_read_b64_tr_b16 v[32:33], v88 offset:7168
    ds_read_b64_tr_b16 v[34:35], v88 offset:8960
    ds_read_b64_tr_b16 v[36:37], v90 offset:7168
    ds_read_b64_tr_b16 v[38:39], v90 offset:8960
    ds_read_b128 v[40:43], v92 offset:128
    ds_read_b64_tr_b16 v[44:45], v88 offset:14336
    ds_read_b64_tr_b16 v[46:47], v88 offset:16128
    ds_read_b64_tr_b16 v[48:49], v90 offset:14336
    ds_read_b64_tr_b16 v[50:51], v90 offset:16128
    s_add_u32 s101, s101, 4096
    buffer_load_dwordx4 a[96:99], v2, s[52:55], s101 offen offset:0 sc1
    buffer_load_dwordx4 a[100:103], v2, s[52:55], s101 offen offset:1024 sc1
    buffer_load_dwordx4 a[104:107], v2, s[52:55], s101 offen offset:2048 sc1
    buffer_load_dwordx4 a[108:111], v2, s[52:55], s101 offen offset:3072 sc1
    s_mov_b32 s81, 1
    s_waitcnt lgkmcnt(10)
    v_mfma_f32_16x16x32_bf16 v[96:99], v[20:23], v[16:19], 0
    ds_read_b128 v[52:55], v92 offset:144
    ds_read_b64_tr_b16 v[56:57], v88 offset:21504
    ds_read_b64_tr_b16 v[58:59], v88 offset:23296
    v_mfma_f32_16x16x32_bf16 v[204:207], v[24:27], v[16:19], 0
    ds_read_b64_tr_b16 v[60:61], v90 offset:21504
    ds_read_b64_tr_b16 v[62:63], v90 offset:23296
    s_waitcnt lgkmcnt(10)
    v_mfma_f32_16x16x32_bf16 v[96:99], v[32:35], v[28:31], v[96:99]
    ds_read_b128 v[16:19], v92 offset:256
    ds_read_b64_tr_b16 v[20:21], v88 offset:28672
    ds_read_b64_tr_b16 v[22:23], v88 offset:30464
    v_mfma_f32_16x16x32_bf16 v[204:207], v[36:39], v[28:31], v[204:207]
    ds_read_b64_tr_b16 v[24:25], v90 offset:28672
    ds_read_b64_tr_b16 v[26:27], v90 offset:30464
    s_waitcnt lgkmcnt(10)
    v_mfma_f32_16x16x32_bf16 v[96:99], v[44:47], v[40:43], v[96:99]
    ds_read_b128 v[28:31], v92 offset:272
    ds_read_b64_tr_b16 v[32:33], v88 offset:35840
    ds_read_b64_tr_b16 v[34:35], v88 offset:37632
    v_mfma_f32_16x16x32_bf16 v[204:207], v[48:51], v[40:43], v[204:207]
    ds_read_b64_tr_b16 v[36:37], v90 offset:35840
    ds_read_b64_tr_b16 v[38:39], v90 offset:37632
    s_waitcnt lgkmcnt(10)
    v_mfma_f32_16x16x32_bf16 v[96:99], v[56:59], v[52:55], v[96:99]
    ds_read_b128 v[40:43], v92 offset:384
    ds_read_b64_tr_b16 v[44:45], v88 offset:43008
    ds_read_b64_tr_b16 v[46:47], v88 offset:44800
    v_mfma_f32_16x16x32_bf16 v[204:207], v[60:63], v[52:55], v[204:207]
    ds_read_b64_tr_b16 v[48:49], v90 offset:43008
    ds_read_b64_tr_b16 v[50:51], v90 offset:44800
    s_waitcnt lgkmcnt(10)
    v_mfma_f32_16x16x32_bf16 v[96:99], v[20:23], v[16:19], v[96:99]
    ds_read_b128 v[52:55], v92 offset:400
    ds_read_b64_tr_b16 v[56:57], v88 offset:50176
    ds_read_b64_tr_b16 v[58:59], v88 offset:51968
    v_mfma_f32_16x16x32_bf16 v[204:207], v[24:27], v[16:19], v[204:207]
    ds_read_b64_tr_b16 v[60:61], v90 offset:50176
    ds_read_b64_tr_b16 v[62:63], v90 offset:51968
    s_waitcnt lgkmcnt(10)
    v_mfma_f32_16x16x32_bf16 v[96:99], v[32:35], v[28:31], v[96:99]
    ds_read_b128 v[16:19], v92 offset:512
    ds_read_b64_tr_b16 v[20:21], v89 offset:0
    ds_read_b64_tr_b16 v[22:23], v89 offset:1792
    v_mfma_f32_16x16x32_bf16 v[204:207], v[36:39], v[28:31], v[204:207]
    ds_read_b64_tr_b16 v[24:25], v91 offset:0
    ds_read_b64_tr_b16 v[26:27], v91 offset:1792
    s_waitcnt lgkmcnt(10)
    v_mfma_f32_16x16x32_bf16 v[96:99], v[44:47], v[40:43], v[96:99]
    ds_read_b128 v[28:31], v92 offset:528
    ds_read_b64_tr_b16 v[32:33], v89 offset:7168
    ds_read_b64_tr_b16 v[34:35], v89 offset:8960
    v_mfma_f32_16x16x32_bf16 v[204:207], v[48:51], v[40:43], v[204:207]
    ds_read_b64_tr_b16 v[36:37], v91 offset:7168
    ds_read_b64_tr_b16 v[38:39], v91 offset:8960
    s_waitcnt lgkmcnt(10)
    v_mfma_f32_16x16x32_bf16 v[96:99], v[56:59], v[52:55], v[96:99]
    ds_read_b128 v[40:43], v92 offset:640
    ds_read_b64_tr_b16 v[44:45], v89 offset:14336
    ds_read_b64_tr_b16 v[46:47], v89 offset:16128
    v_mfma_f32_16x16x32_bf16 v[204:207], v[60:63], v[52:55], v[204:207]
    ds_read_b64_tr_b16 v[48:49], v91 offset:14336
    ds_read_b64_tr_b16 v[50:51], v91 offset:16128
    s_waitcnt vmcnt(4)
    s_mov_b64 exec, 1
    buffer_store_dword v3, off, s[52:55], s14 sc1
    s_mov_b64 exec, -1
    s_add_u32 s101, s101, 4096
    buffer_load_dwordx4 a[112:115], v2, s[52:55], s101 offen offset:0 sc1
    buffer_load_dwordx4 a[116:119], v2, s[52:55], s101 offen offset:1024 sc1
    s_waitcnt lgkmcnt(10)
    v_mfma_f32_16x16x32_bf16 v[96:99], v[20:23], v[16:19], v[96:99]
    ds_read_b128 v[52:55], v92 offset:656
    ds_read_b64_tr_b16 v[56:57], v89 offset:21504
    ds_read_b64_tr_b16 v[58:59], v89 offset:23296
    v_mfma_f32_16x16x32_bf16 v[204:207], v[24:27], v[16:19], v[204:207]
    ds_read_b64_tr_b16 v[60:61], v91 offset:21504
    ds_read_b64_tr_b16 v[62:63], v91 offset:23296
    s_waitcnt lgkmcnt(10)
    v_mfma_f32_16x16x32_bf16 v[96:99], v[32:35], v[28:31], v[96:99]
    ds_read_b128 v[16:19], v92 offset:768
    ds_read_b64_tr_b16 v[20:21], v89 offset:28672
    ds_read_b64_tr_b16 v[22:23], v89 offset:30464
    v_mfma_f32_16x16x32_bf16 v[204:207], v[36:39], v[28:31], v[204:207]
    ds_read_b64_tr_b16 v[24:25], v91 offset:28672
    ds_read_b64_tr_b16 v[26:27], v91 offset:30464
    s_waitcnt lgkmcnt(10)
    v_mfma_f32_16x16x32_bf16 v[96:99], v[44:47], v[40:43], v[96:99]
    ds_read_b128 v[28:31], v92 offset:784
    ds_read_b64_tr_b16 v[32:33], v89 offset:35840
    ds_read_b64_tr_b16 v[34:35], v89 offset:37632
    v_mfma_f32_16x16x32_bf16 v[204:207], v[48:51], v[40:43], v[204:207]
    ds_read_b64_tr_b16 v[36:37], v91 offset:35840
    ds_read_b64_tr_b16 v[38:39], v91 offset:37632
    buffer_load_dword v15, v103, s[52:55], 0 offen offset:128 sc1
    buffer_load_dwordx4 a[120:123], v2, s[52:55], s101 offen offset:2048 sc1
    buffer_load_dwordx4 a[124:127], v2, s[52:55], s101 offen offset:3072 sc1
    s_add_u32 s101, s101, 4096
    buffer_load_dwordx4 a[128:131], v2, s[52:55], s101 offen offset:0 sc1
    buffer_load_dwordx4 a[132:135], v2, s[52:55], s101 offen offset:1024 sc1
    buffer_load_dwordx4 a[136:139], v2, s[52:55], s101 offen offset:2048 sc1
    buffer_load_dwordx4 a[140:143], v2, s[52:55], s101 offen offset:3072 sc1
    s_waitcnt lgkmcnt(10)
    v_mfma_f32_16x16x32_bf16 v[96:99], v[56:59], v[52:55], v[96:99]
    ds_read_b128 v[40:43], v92 offset:896
    ds_read_b64_tr_b16 v[44:45], v89 offset:43008
    ds_read_b64_tr_b16 v[46:47], v89 offset:44800
    v_mfma_f32_16x16x32_bf16 v[204:207], v[60:63], v[52:55], v[204:207]
    ds_read_b64_tr_b16 v[48:49], v91 offset:43008
    ds_read_b64_tr_b16 v[50:51], v91 offset:44800
    s_waitcnt lgkmcnt(10)
    v_mfma_f32_16x16x32_bf16 v[96:99], v[20:23], v[16:19], v[96:99]
    ds_read_b128 v[52:55], v92 offset:912
    ds_read_b64_tr_b16 v[56:57], v89 offset:50176
    ds_read_b64_tr_b16 v[58:59], v89 offset:51968
    v_mfma_f32_16x16x32_bf16 v[204:207], v[24:27], v[16:19], v[204:207]
    ds_read_b64_tr_b16 v[60:61], v91 offset:50176
    ds_read_b64_tr_b16 v[62:63], v91 offset:51968
    s_waitcnt lgkmcnt(10)
    v_mfma_f32_16x16x32_bf16 v[96:99], v[32:35], v[28:31], v[96:99]
    v_mfma_f32_16x16x32_bf16 v[204:207], v[36:39], v[28:31], v[204:207]
    s_waitcnt lgkmcnt(5)
    v_mfma_f32_16x16x32_bf16 v[96:99], v[44:47], v[40:43], v[96:99]
    ds_read_b64_tr_b16 v[72:73], v100 offset:0
    ds_read_b64_tr_b16 v[74:75], v100 offset:1792
    v_mfma_f32_16x16x32_bf16 v[204:207], v[48:51], v[40:43], v[204:207]
    ds_read_b64_tr_b16 v[76:77], v100 offset:32
    ds_read_b64_tr_b16 v[78:79], v100 offset:1824
    s_waitcnt lgkmcnt(4)
    v_mfma_f32_16x16x32_bf16 v[96:99], v[56:59], v[52:55], v[96:99]
    ds_read_b64_tr_b16 v[80:81], v100 offset:64
    ds_read_b64_tr_b16 v[82:83], v100 offset:1856
    v_mfma_f32_16x16x32_bf16 v[204:207], v[60:63], v[52:55], v[204:207]
    ds_read_b64_tr_b16 v[84:85], v100 offset:96
    ds_read_b64_tr_b16 v[86:87], v100 offset:1888
    s_waitcnt vmcnt(6)
    v_cmp_ne_u32 vcc, s68, v15
    s_nop 0
    s_and_b64 vcc, vcc, s[84:85]
    s_cbranch_scc1 L_ylate_73
    buffer_load_dwordx4 v[112:115], v2, s[52:55], s28 offen offset:0 sc1
    buffer_load_dwordx4 v[116:119], v2, s[52:55], s29 offen offset:0 sc1
    buffer_load_dwordx4 v[120:123], v2, s[52:55], s28 offen offset:1024 sc1
    buffer_load_dwordx4 v[124:127], v2, s[52:55], s29 offen offset:1024 sc1
    buffer_load_dwordx4 v[128:131], v2, s[52:55], s28 offen offset:2048 sc1
    buffer_load_dwordx4 v[132:135], v2, s[52:55], s29 offen offset:2048 sc1
    buffer_load_dwordx4 v[136:139], v2, s[52:55], s28 offen offset:3072 sc1
    buffer_load_dwordx4 v[140:143], v2, s[52:55], s29 offen offset:3072 sc1
    s_mov_b32 s81, 0
L_ylate_73:
    ds_write_b128 v93, v[96:99]
    ds_write_b128 v94, v[204:207]
    ds_read_b64_tr_b16 v[88:89], v100 offset:192
    ds_read_b64_tr_b16 v[90:91], v100 offset:1984
    s_cmp_eq_u32 s81, 0
    s_waitcnt lgkmcnt(2)
    s_barrier
    s_cbranch_scc1 L_yok_74
    s_mov_b32 s82, 0
L_py_75:
    buffer_load_dword v15, v103, s[52:55], 0 offen offset:128 sc1
    s_add_u32 s82, s82, 1
    s_waitcnt vmcnt(0)
    v_cmp_ne_u32 vcc, s68, v15
    s_nop 0
    s_and_b64 vcc, vcc, s[84:85]
    s_cbranch_scc0 L_dy_76
    s_cmp_lt_u32 s82, 131072
    s_cbranch_scc1 L_py_75
L_dy_76:
    buffer_load_dwordx4 v[112:115], v2, s[52:55], s28 offen offset:0 sc1
    buffer_load_dwordx4 v[116:119], v2, s[52:55], s29 offen offset:0 sc1
    buffer_load_dwordx4 v[120:123], v2, s[52:55], s28 offen offset:1024 sc1
    buffer_load_dwordx4 v[124:127], v2, s[52:55], s29 offen offset:1024 sc1
    buffer_load_dwordx4 v[128:131], v2, s[52:55], s28 offen offset:2048 sc1
    buffer_load_dwordx4 v[132:135], v2, s[52:55], s29 offen offset:2048 sc1
    buffer_load_dwordx4 v[136:139], v2, s[52:55], s28 offen offset:3072 sc1
    buffer_load_dwordx4 v[140:143], v2, s[52:55], s29 offen offset:3072 sc1
L_yok_74:
    s_add_u32 s28, s28, 4096
    buffer_load_dwordx4 v[144:147], v2, s[52:55], s28 offen offset:0 sc1
    s_add_u32 s29, s29, 4096
    buffer_load_dwordx4 v[148:151], v2, s[52:55], s29 offen offset:0 sc1
    s_waitcnt vmcnt(8)
    v_mfma_f32_16x16x32_bf16 v[16:19], v[72:75], v[112:115], 0
    ds_read_b64_tr_b16 v[92:93], v100 offset:7168
    v_mfma_f32_16x16x32_bf16 v[20:23], v[72:75], v[116:119], 0
    ds_read_b64_tr_b16 v[94:95], v100 offset:8960
    v_mfma_f32_16x16x32_bf16 v[28:31], v[76:79], v[116:119], 0
    ds_read_b64_tr_b16 v[72:73], v100 offset:7200
    buffer_load_dwordx4 v[152:155], v2, s[52:55], s28 offen offset:1024 sc1
    v_mfma_f32_16x16x32_bf16 v[24:27], v[76:79], v[112:115], 0
    ds_read_b64_tr_b16 v[74:75], v100 offset:8992
    v_mfma_f32_16x16x32_bf16 v[32:35], v[80:83], v[112:115], 0
    ds_read_b64_tr_b16 v[76:77], v100 offset:7232
    v_mfma_f32_16x16x32_bf16 v[36:39], v[80:83], v[116:119], 0
    ds_read_b64_tr_b16 v[78:79], v100 offset:9024
    v_mfma_f32_16x16x32_bf16 v[44:47], v[84:87], v[116:119], 0
    ds_read_b64_tr_b16 v[80:81], v100 offset:7264
    buffer_load_dwordx4 v[156:159], v2, s[52:55], s29 offen offset:1024 sc1
    v_mfma_f32_16x16x32_bf16 v[40:43], v[84:87], v[112:115], 0
    ds_read_b64_tr_b16 v[82:83], v100 offset:9056
    s_waitcnt lgkmcnt(8)
    v_mfma_f32_16x16x32_bf16 v[64:67], v[88:91], v[112:115], 0
    ds_read_b64_tr_b16 v[84:85], v100 offset:7360
    buffer_load_dwordx4 v[160:163], v2, s[52:55], s28 offen offset:2048 sc1
    v_mfma_f32_16x16x32_bf16 v[68:71], v[88:91], v[116:119], 0
    ds_read_b64_tr_b16 v[86:87], v100 offset:9152
    s_waitcnt vmcnt(9) lgkmcnt(6)
    v_mfma_f32_16x16x32_bf16 v[16:19], v[92:95], v[120:123], v[16:19]
    ds_read_b64_tr_b16 v[88:89], v100 offset:14336
    v_mfma_f32_16x16x32_bf16 v[20:23], v[92:95], v[124:127], v[20:23]
    ds_read_b64_tr_b16 v[90:91], v100 offset:16128
    v_mfma_f32_16x16x32_bf16 v[28:31], v[72:75], v[124:127], v[28:31]
    ds_read_b64_tr_b16 v[92:93], v100 offset:14368
    buffer_load_dwordx4 v[164:167], v2, s[52:55], s29 offen offset:2048 sc1
    v_mfma_f32_16x16x32_bf16 v[24:27], v[72:75], v[120:123], v[24:27]
    ds_read_b64_tr_b16 v[94:95], v100 offset:16160
    s_waitcnt lgkmcnt(6)
    v_mfma_f32_16x16x32_bf16 v[32:35], v[76:79], v[120:123], v[32:35]
    ds_read_b64_tr_b16 v[72:73], v100 offset:14400
    v_mfma_f32_16x16x32_bf16 v[36:39], v[76:79], v[124:127], v[36:39]
    ds_read_b64_tr_b16 v[74:75], v100 offset:16192
    v_mfma_f32_16x16x32_bf16 v[44:47], v[80:83], v[124:127], v[44:47]
    ds_read_b64_tr_b16 v[76:77], v100 offset:14432
    buffer_load_dwordx4 v[168:171], v2, s[52:55], s28 offen offset:3072 sc1
    v_mfma_f32_16x16x32_bf16 v[40:43], v[80:83], v[120:123], v[40:43]
    ds_read_b64_tr_b16 v[78:79], v100 offset:16224
    s_waitcnt lgkmcnt(8)
    v_mfma_f32_16x16x32_bf16 v[64:67], v[84:87], v[120:123], v[64:67]
    ds_read_b64_tr_b16 v[80:81], v100 offset:14528
    buffer_load_dwordx4 v[172:175], v2, s[52:55], s29 offen offset:3072 sc1
    v_mfma_f32_16x16x32_bf16 v[68:71], v[84:87], v[124:127], v[68:71]
    ds_read_b64_tr_b16 v[82:83], v100 offset:16320
    s_waitcnt vmcnt(10) lgkmcnt(6)
    v_mfma_f32_16x16x32_bf16 v[16:19], v[88:91], v[128:131], v[16:19]
    ds_read_b64_tr_b16 v[84:85], v100 offset:21504
    v_mfma_f32_16x16x32_bf16 v[20:23], v[88:91], v[132:135], v[20:23]
    ds_read_b64_tr_b16 v[86:87], v100 offset:23296
    v_mfma_f32_16x16x32_bf16 v[28:31], v[92:95], v[132:135], v[28:31]
    s_add_u32 s28, s28, 4096
    ds_read_b64_tr_b16 v[88:89], v100 offset:21536
    buffer_load_dwordx4 v[176:179], v2, s[52:55], s28 offen offset:0 sc1
    v_mfma_f32_16x16x32_bf16 v[24:27], v[92:95], v[128:131], v[24:27]
    ds_read_b64_tr_b16 v[90:91], v100 offset:23328
    s_waitcnt lgkmcnt(6)
    v_mfma_f32_16x16x32_bf16 v[32:35], v[72:75], v[128:131], v[32:35]
    ds_read_b64_tr_b16 v[92:93], v100 offset:21568
    v_mfma_f32_16x16x32_bf16 v[36:39], v[72:75], v[132:135], v[36:39]
    ds_read_b64_tr_b16 v[94:95], v100 offset:23360
    v_mfma_f32_16x16x32_bf16 v[44:47], v[76:79], v[132:135], v[44:47]
    s_add_u32 s29, s29, 4096
    ds_read_b64_tr_b16 v[72:73], v100 offset:21600
    buffer_load_dwordx4 v[180:183], v2, s[52:55], s29 offen offset:0 sc1
    v_mfma_f32_16x16x32_bf16 v[40:43], v[76:79], v[128:131], v[40:43]
    ds_read_b64_tr_b16 v[74:75], v100 offset:23392
    s_waitcnt lgkmcnt(8)
    v_mfma_f32_16x16x32_bf16 v[64:67], v[80:83], v[128:131], v[64:67]
    ds_read_b64_tr_b16 v[76:77], v100 offset:21696
    buffer_load_dword v48, v106, s[52:55], s30 offen offset:0 sc1
    v_mfma_f32_16x16x32_bf16 v[68:71], v[80:83], v[132:135], v[68:71]
    ds_read_b64_tr_b16 v[78:79], v100 offset:23488
    s_waitcnt vmcnt(11) lgkmcnt(6)
    v_mfma_f32_16x16x32_bf16 v[16:19], v[84:87], v[136:139], v[16:19]
    ds_read_b64_tr_b16 v[80:81], v100 offset:28672
    v_mfma_f32_16x16x32_bf16 v[20:23], v[84:87], v[140:143], v[20:23]
    ds_read_b64_tr_b16 v[82:83], v100 offset:30464
    v_mfma_f32_16x16x32_bf16 v[28:31], v[88:91], v[140:143], v[28:31]
    ds_read_b64_tr_b16 v[84:85], v100 offset:28704
    buffer_load_dword v49, v106, s[52:55], s30 offen offset:128 sc1
    v_mfma_f32_16x16x32_bf16 v[24:27], v[88:91], v[136:139], v[24:27]
    ds_read_b64_tr_b16 v[86:87], v100 offset:30496
    s_waitcnt lgkmcnt(6)
    v_mfma_f32_16x16x32_bf16 v[32:35], v[92:95], v[136:139], v[32:35]
    ds_read_b64_tr_b16 v[88:89], v100 offset:28736
    buffer_load_dword v50, v106, s[52:55], s30 offen offset:256 sc1
    v_mfma_f32_16x16x32_bf16 v[36:39], v[92:95], v[140:143], v[36:39]
    ds_read_b64_tr_b16 v[90:91], v100 offset:30528
    v_mfma_f32_16x16x32_bf16 v[44:47], v[72:75], v[140:143], v[44:47]
    ds_read_b64_tr_b16 v[92:93], v100 offset:28768
    buffer_load_dword v51, v106, s[52:55], s30 offen offset:384 sc1
    v_mfma_f32_16x16x32_bf16 v[40:43], v[72:75], v[136:139], v[40:43]
    ds_read_b64_tr_b16 v[94:95], v100 offset:30560
    s_waitcnt lgkmcnt(8)
    v_mfma_f32_16x16x32_bf16 v[64:67], v[76:79], v[136:139], v[64:67]
    ds_read_b64_tr_b16 v[72:73], v100 offset:28864
    buffer_load_dword v52, v106, s[52:55], s30 offen offset:512 sc1
    v_mfma_f32_16x16x32_bf16 v[68:71], v[76:79], v[140:143], v[68:71]
    ds_read_b64_tr_b16 v[74:75], v100 offset:30656
    s_waitcnt vmcnt(13) lgkmcnt(6)
    v_mfma_f32_16x16x32_bf16 v[16:19], v[80:83], v[144:147], v[16:19]
    ds_read_b64_tr_b16 v[76:77], v100 offset:35840
    v_mfma_f32_16x16x32_bf16 v[20:23], v[80:83], v[148:151], v[20:23]
    ds_read_b64_tr_b16 v[78:79], v100 offset:37632
    v_mfma_f32_16x16x32_bf16 v[28:31], v[84:87], v[148:151], v[28:31]
    ds_read_b64_tr_b16 v[80:81], v100 offset:35872
    buffer_load_dword v53, v106, s[52:55], s30 offen offset:640 sc1
    v_mfma_f32_16x16x32_bf16 v[24:27], v[84:87], v[144:147], v[24:27]
    ds_read_b64_tr_b16 v[82:83], v100 offset:37664
    s_waitcnt lgkmcnt(6)
    v_mfma_f32_16x16x32_bf16 v[32:35], v[88:91], v[144:147], v[32:35]
    ds_read_b64_tr_b16 v[84:85], v100 offset:35904
    buffer_load_dword v54, v106, s[52:55], s30 offen offset:768 sc1
    v_mfma_f32_16x16x32_bf16 v[36:39], v[88:91], v[148:151], v[36:39]
    ds_read_b64_tr_b16 v[86:87], v100 offset:37696
    v_mfma_f32_16x16x32_bf16 v[44:47], v[92:95], v[148:151], v[44:47]
    ds_read_b64_tr_b16 v[88:89], v100 offset:35936
    buffer_load_dword v55, v106, s[52:55], s30 offen offset:896 sc1
    v_mfma_f32_16x16x32_bf16 v[40:43], v[92:95], v[144:147], v[40:43]
    ds_read_b64_tr_b16 v[90:91], v100 offset:37728
    s_waitcnt lgkmcnt(8)
    v_mfma_f32_16x16x32_bf16 v[64:67], v[72:75], v[144:147], v[64:67]
    ds_read_b64_tr_b16 v[92:93], v100 offset:36032
    buffer_load_dwordx4 v[184:187], v2, s[52:55], s28 offen offset:1024 sc1
    v_mfma_f32_16x16x32_bf16 v[68:71], v[72:75], v[148:151], v[68:71]
    ds_read_b64_tr_b16 v[94:95], v100 offset:37824
    s_waitcnt vmcnt(15) lgkmcnt(6)
    v_mfma_f32_16x16x32_bf16 v[16:19], v[76:79], v[152:155], v[16:19]
    ds_read_b64_tr_b16 v[72:73], v100 offset:43008
    v_mfma_f32_16x16x32_bf16 v[20:23], v[76:79], v[156:159], v[20:23]
    ds_read_b64_tr_b16 v[74:75], v100 offset:44800
    v_mfma_f32_16x16x32_bf16 v[28:31], v[80:83], v[156:159], v[28:31]
    ds_read_b64_tr_b16 v[76:77], v100 offset:43040
    buffer_load_dwordx4 v[188:191], v2, s[52:55], s29 offen offset:1024 sc1
    v_mfma_f32_16x16x32_bf16 v[24:27], v[80:83], v[152:155], v[24:27]
    ds_read_b64_tr_b16 v[78:79], v100 offset:44832
    s_waitcnt lgkmcnt(6)
    v_mfma_f32_16x16x32_bf16 v[32:35], v[84:87], v[152:155], v[32:35]
    ds_read_b64_tr_b16 v[80:81], v100 offset:43072
    buffer_load_dwordx4 v[192:195], v2, s[52:55], s28 offen offset:2048 sc1
    v_mfma_f32_16x16x32_bf16 v[36:39], v[84:87], v[156:159], v[36:39]
    ds_read_b64_tr_b16 v[82:83], v100 offset:44864
    v_mfma_f32_16x16x32_bf16 v[44:47], v[88:91], v[156:159], v[44:47]
    ds_read_b64_tr_b16 v[84:85], v100 offset:43104
    buffer_load_dwordx4 v[196:199], v2, s[52:55], s29 offen offset:2048 sc1
    v_mfma_f32_16x16x32_bf16 v[40:43], v[88:91], v[152:155], v[40:43]
    ds_read_b64_tr_b16 v[86:87], v100 offset:44896
    s_waitcnt lgkmcnt(8)
    v_mfma_f32_16x16x32_bf16 v[64:67], v[92:95], v[152:155], v[64:67]
    ds_read_b64_tr_b16 v[88:89], v100 offset:43200
    buffer_load_dwordx4 v[200:203], v2, s[52:55], s28 offen offset:3072 sc1
    v_mfma_f32_16x16x32_bf16 v[68:71], v[92:95], v[156:159], v[68:71]
    ds_read_b64_tr_b16 v[90:91], v100 offset:44992
    s_waitcnt vmcnt(17) lgkmcnt(6)
    v_mfma_f32_16x16x32_bf16 v[16:19], v[72:75], v[160:163], v[16:19]
    ds_read_b64_tr_b16 v[92:93], v100 offset:50176
    v_mfma_f32_16x16x32_bf16 v[20:23], v[72:75], v[164:167], v[20:23]
    ds_read_b64_tr_b16 v[94:95], v100 offset:51968
    v_mfma_f32_16x16x32_bf16 v[28:31], v[76:79], v[164:167], v[28:31]
    ds_read_b64_tr_b16 v[72:73], v100 offset:50208
    buffer_load_dwordx4 v[204:207], v2, s[52:55], s29 offen offset:3072 sc1
    v_mfma_f32_16x16x32_bf16 v[24:27], v[76:79], v[160:163], v[24:27]
    ds_read_b64_tr_b16 v[74:75], v100 offset:52000
    s_waitcnt lgkmcnt(6)
    v_mfma_f32_16x16x32_bf16 v[32:35], v[80:83], v[160:163], v[32:35]
    ds_read_b64_tr_b16 v[76:77], v100 offset:50240
    v_mfma_f32_16x16x32_bf16 v[36:39], v[80:83], v[164:167], v[36:39]
    ds_read_b64_tr_b16 v[78:79], v100 offset:52032
    v_mfma_f32_16x16x32_bf16 v[44:47], v[84:87], v[164:167], v[44:47]
    s_add_u32 s28, s28, 4096
    ds_read_b64_tr_b16 v[80:81], v100 offset:50272
    buffer_load_dwordx4 v[208:211], v2, s[52:55], s28 offen offset:0 sc1
    v_mfma_f32_16x16x32_bf16 v[40:43], v[84:87], v[160:163], v[40:43]
    ds_read_b64_tr_b16 v[82:83], v100 offset:52064
    s_waitcnt lgkmcnt(8)
    v_mfma_f32_16x16x32_bf16 v[64:67], v[88:91], v[160:163], v[64:67]
    s_add_u32 s29, s29, 4096
    ds_read_b64_tr_b16 v[84:85], v100 offset:50368
    buffer_load_dwordx4 v[212:215], v2, s[52:55], s29 offen offset:0 sc1
    v_mfma_f32_16x16x32_bf16 v[68:71], v[88:91], v[164:167], v[68:71]
    ds_read_b64_tr_b16 v[86:87], v100 offset:52160
    s_waitcnt vmcnt(18) lgkmcnt(6)
    v_mfma_f32_16x16x32_bf16 v[16:19], v[92:95], v[168:171], v[16:19]
    ds_read_b64_tr_b16 v[88:89], v101 offset:0
    v_mfma_f32_16x16x32_bf16 v[20:23], v[92:95], v[172:175], v[20:23]
    ds_read_b64_tr_b16 v[90:91], v101 offset:1792
    v_mfma_f32_16x16x32_bf16 v[28:31], v[72:75], v[172:175], v[28:31]
    ds_read_b64_tr_b16 v[92:93], v101 offset:32
    buffer_load_dwordx4 v[216:219], v2, s[52:55], s28 offen offset:1024 sc1
    v_mfma_f32_16x16x32_bf16 v[24:27], v[72:75], v[168:171], v[24:27]
    ds_read_b64_tr_b16 v[94:95], v101 offset:1824
    s_waitcnt lgkmcnt(6)
    v_mfma_f32_16x16x32_bf16 v[32:35], v[76:79], v[168:171], v[32:35]
    ds_read_b64_tr_b16 v[72:73], v101 offset:64
    v_mfma_f32_16x16x32_bf16 v[36:39], v[76:79], v[172:175], v[36:39]
    ds_read_b64_tr_b16 v[74:75], v101 offset:1856
    v_mfma_f32_16x16x32_bf16 v[44:47], v[80:83], v[172:175], v[44:47]
    ds_read_b64_tr_b16 v[76:77], v101 offset:96
    buffer_load_dwordx4 v[220:223], v2, s[52:55], s29 offen offset:1024 sc1
    v_mfma_f32_16x16x32_bf16 v[40:43], v[80:83], v[168:171], v[40:43]
    ds_read_b64_tr_b16 v[78:79], v101 offset:1888
    s_waitcnt lgkmcnt(8)
    v_mfma_f32_16x16x32_bf16 v[64:67], v[84:87], v[168:171], v[64:67]
    ds_read_b64_tr_b16 v[80:81], v101 offset:192
    buffer_load_dwordx4 v[224:227], v2, s[52:55], s28 offen offset:2048 sc1
    v_mfma_f32_16x16x32_bf16 v[68:71], v[84:87], v[172:175], v[68:71]
    ds_read_b64_tr_b16 v[82:83], v101 offset:1984
    s_waitcnt vmcnt(19) lgkmcnt(6)
    v_mfma_f32_16x16x32_bf16 v[16:19], v[88:91], v[176:179], v[16:19]
    ds_read_b64_tr_b16 v[84:85], v101 offset:7168
    v_mfma_f32_16x16x32_bf16 v[20:23], v[88:91], v[180:183], v[20:23]
    ds_read_b64_tr_b16 v[86:87], v101 offset:8960
    v_mfma_f32_16x16x32_bf16 v[28:31], v[92:95], v[180:183], v[28:31]
    ds_read_b64_tr_b16 v[88:89], v101 offset:7200
    buffer_load_dwordx4 v[228:231], v2, s[52:55], s29 offen offset:2048 sc1
    v_mfma_f32_16x16x32_bf16 v[24:27], v[92:95], v[176:179], v[24:27]
    ds_read_b64_tr_b16 v[90:91], v101 offset:8992
    s_waitcnt lgkmcnt(6)
    v_mfma_f32_16x16x32_bf16 v[32:35], v[72:75], v[176:179], v[32:35]
    ds_read_b64_tr_b16 v[92:93], v101 offset:7232
    v_mfma_f32_16x16x32_bf16 v[36:39], v[72:75], v[180:183], v[36:39]
    ds_read_b64_tr_b16 v[94:95], v101 offset:9024
    v_mfma_f32_16x16x32_bf16 v[44:47], v[76:79], v[180:183], v[44:47]
    ds_read_b64_tr_b16 v[72:73], v101 offset:7264
    buffer_load_dwordx4 v[232:235], v2, s[52:55], s28 offen offset:3072 sc1
    v_mfma_f32_16x16x32_bf16 v[40:43], v[76:79], v[176:179], v[40:43]
    ds_read_b64_tr_b16 v[74:75], v101 offset:9056
    s_waitcnt lgkmcnt(8)
    v_mfma_f32_16x16x32_bf16 v[64:67], v[80:83], v[176:179], v[64:67]
    ds_read_b64_tr_b16 v[76:77], v101 offset:7360
    buffer_load_dwordx4 v[236:239], v2, s[52:55], s29 offen offset:3072 sc1
    v_mfma_f32_16x16x32_bf16 v[68:71], v[80:83], v[180:183], v[68:71]
    ds_read_b64_tr_b16 v[78:79], v101 offset:9152
    s_waitcnt vmcnt(12) lgkmcnt(6)
    v_mfma_f32_16x16x32_bf16 v[16:19], v[84:87], v[184:187], v[16:19]
    ds_read_b64_tr_b16 v[80:81], v101 offset:14336
    v_mfma_f32_16x16x32_bf16 v[20:23], v[84:87], v[188:191], v[20:23]
    ds_read_b64_tr_b16 v[82:83], v101 offset:16128
    v_mfma_f32_16x16x32_bf16 v[28:31], v[88:91], v[188:191], v[28:31]
    s_add_u32 s101, s101, 4096
    ds_read_b64_tr_b16 v[84:85], v101 offset:14368
    buffer_load_dwordx4 a[144:147], v2, s[52:55], s101 offen offset:0 sc1
    v_mfma_f32_16x16x32_bf16 v[24:27], v[88:91], v[184:187], v[24:27]
    ds_read_b64_tr_b16 v[86:87], v101 offset:16160
    s_waitcnt lgkmcnt(6)
    v_mfma_f32_16x16x32_bf16 v[32:35], v[92:95], v[184:187], v[32:35]
    ds_read_b64_tr_b16 v[88:89], v101 offset:14400
    v_mfma_f32_16x16x32_bf16 v[36:39], v[92:95], v[188:191], v[36:39]
    ds_read_b64_tr_b16 v[90:91], v101 offset:16192
    v_mfma_f32_16x16x32_bf16 v[44:47], v[72:75], v[188:191], v[44:47]
    ds_read_b64_tr_b16 v[92:93], v101 offset:14432
    buffer_load_dwordx4 a[148:151], v2, s[52:55], s101 offen offset:1024 sc1
    v_mfma_f32_16x16x32_bf16 v[40:43], v[72:75], v[184:187], v[40:43]
    ds_read_b64_tr_b16 v[94:95], v101 offset:16224
    s_waitcnt lgkmcnt(8)
    v_mfma_f32_16x16x32_bf16 v[64:67], v[76:79], v[184:187], v[64:67]
    ds_read_b64_tr_b16 v[72:73], v101 offset:14528
    buffer_load_dwordx4 a[152:155], v2, s[52:55], s101 offen offset:2048 sc1
    v_mfma_f32_16x16x32_bf16 v[68:71], v[76:79], v[188:191], v[68:71]
    ds_read_b64_tr_b16 v[74:75], v101 offset:16320
    s_waitcnt vmcnt(13) lgkmcnt(6)
    v_mfma_f32_16x16x32_bf16 v[16:19], v[80:83], v[192:195], v[16:19]
    ds_read_b64_tr_b16 v[76:77], v101 offset:21504
    v_mfma_f32_16x16x32_bf16 v[20:23], v[80:83], v[196:199], v[20:23]
    ds_read_b64_tr_b16 v[78:79], v101 offset:23296
    v_mfma_f32_16x16x32_bf16 v[28:31], v[84:87], v[196:199], v[28:31]
    ds_read_b64_tr_b16 v[80:81], v101 offset:21536
    buffer_load_dwordx4 a[156:159], v2, s[52:55], s101 offen offset:3072 sc1
    v_mfma_f32_16x16x32_bf16 v[24:27], v[84:87], v[192:195], v[24:27]
    ds_read_b64_tr_b16 v[82:83], v101 offset:23328
    s_waitcnt lgkmcnt(6)
    v_mfma_f32_16x16x32_bf16 v[32:35], v[88:91], v[192:195], v[32:35]
    ds_read_b64_tr_b16 v[84:85], v101 offset:21568
    v_mfma_f32_16x16x32_bf16 v[36:39], v[88:91], v[196:199], v[36:39]
    ds_read_b64_tr_b16 v[86:87], v101 offset:23360
    v_mfma_f32_16x16x32_bf16 v[44:47], v[92:95], v[196:199], v[44:47]
    s_add_u32 s101, s101, 4096
    ds_read_b64_tr_b16 v[88:89], v101 offset:21600
    buffer_load_dwordx4 a[160:163], v2, s[52:55], s101 offen offset:0 sc1
    v_mfma_f32_16x16x32_bf16 v[40:43], v[92:95], v[192:195], v[40:43]
    ds_read_b64_tr_b16 v[90:91], v101 offset:23392
    s_waitcnt lgkmcnt(8)
    v_mfma_f32_16x16x32_bf16 v[64:67], v[72:75], v[192:195], v[64:67]
    ds_read_b64_tr_b16 v[92:93], v101 offset:21696
    buffer_load_dwordx4 a[164:167], v2, s[52:55], s101 offen offset:1024 sc1
    v_mfma_f32_16x16x32_bf16 v[68:71], v[72:75], v[196:199], v[68:71]
    ds_read_b64_tr_b16 v[94:95], v101 offset:23488
    s_waitcnt vmcnt(14) lgkmcnt(6)
    v_mfma_f32_16x16x32_bf16 v[16:19], v[76:79], v[200:203], v[16:19]
    ds_read_b64_tr_b16 v[72:73], v101 offset:28672
    v_add_f32 v48, v48, v52
    v_mfma_f32_16x16x32_bf16 v[20:23], v[76:79], v[204:207], v[20:23]
    ds_read_b64_tr_b16 v[74:75], v101 offset:30464
    v_add_f32 v49, v49, v53
    v_mfma_f32_16x16x32_bf16 v[28:31], v[80:83], v[204:207], v[28:31]
    ds_read_b64_tr_b16 v[76:77], v101 offset:28704
    v_add_f32 v50, v50, v54
    v_mfma_f32_16x16x32_bf16 v[24:27], v[80:83], v[200:203], v[24:27]
    ds_read_b64_tr_b16 v[78:79], v101 offset:30496
    s_waitcnt lgkmcnt(6)
    v_mfma_f32_16x16x32_bf16 v[32:35], v[84:87], v[200:203], v[32:35]
    ds_read_b64_tr_b16 v[80:81], v101 offset:28736
    buffer_load_dwordx4 a[168:171], v2, s[52:55], s101 offen offset:2048 sc1
    v_mfma_f32_16x16x32_bf16 v[36:39], v[84:87], v[204:207], v[36:39]
    ds_read_b64_tr_b16 v[82:83], v101 offset:30528
    v_add_f32 v51, v51, v55
    v_mfma_f32_16x16x32_bf16 v[44:47], v[88:91], v[204:207], v[44:47]
    ds_read_b64_tr_b16 v[84:85], v101 offset:28768
    v_add_f32 v48, v48, v50
    v_mfma_f32_16x16x32_bf16 v[40:43], v[88:91], v[200:203], v[40:43]
    ds_read_b64_tr_b16 v[86:87], v101 offset:30560
    s_waitcnt lgkmcnt(8)
    v_mfma_f32_16x16x32_bf16 v[64:67], v[92:95], v[200:203], v[64:67]
    ds_read_b64_tr_b16 v[88:89], v101 offset:28864
    buffer_load_dwordx4 a[172:175], v2, s[52:55], s101 offen offset:3072 sc1
    v_mfma_f32_16x16x32_bf16 v[68:71], v[92:95], v[204:207], v[68:71]
    ds_read_b64_tr_b16 v[90:91], v101 offset:30656
    s_waitcnt vmcnt(14) lgkmcnt(6)
    v_mfma_f32_16x16x32_bf16 v[16:19], v[72:75], v[208:211], v[16:19]
    ds_read_b64_tr_b16 v[92:93], v101 offset:35840
    v_add_f32 v49, v49, v51
    v_mfma_f32_16x16x32_bf16 v[20:23], v[72:75], v[212:215], v[20:23]
    ds_read_b64_tr_b16 v[94:95], v101 offset:37632
    v_add_f32 v48, v48, v49
    v_mfma_f32_16x16x32_bf16 v[28:31], v[76:79], v[212:215], v[28:31]
    ds_read_b64_tr_b16 v[72:73], v101 offset:35872
    v_mul_f32 v48, 0x3b000000, v48
    v_mfma_f32_16x16x32_bf16 v[24:27], v[76:79], v[208:211], v[24:27]
    ds_read_b64_tr_b16 v[74:75], v101 offset:37664
    s_waitcnt lgkmcnt(6)
    v_mfma_f32_16x16x32_bf16 v[32:35], v[80:83], v[208:211], v[32:35]
    s_add_u32 s101, s101, 4096
    ds_read_b64_tr_b16 v[76:77], v101 offset:35904
    buffer_load_dwordx4 a[176:179], v2, s[52:55], s101 offen offset:0 sc1
    v_mfma_f32_16x16x32_bf16 v[36:39], v[80:83], v[212:215], v[36:39]
    ds_read_b64_tr_b16 v[78:79], v101 offset:37696
    v_mov_b32 v49, v48
    v_mfma_f32_16x16x32_bf16 v[44:47], v[84:87], v[212:215], v[44:47]
    ds_read_b64_tr_b16 v[80:81], v101 offset:35936
    v_permlane32_swap_b32 v48, v49
    v_mfma_f32_16x16x32_bf16 v[40:43], v[84:87], v[208:211], v[40:43]
    ds_read_b64_tr_b16 v[82:83], v101 offset:37728
    s_waitcnt lgkmcnt(8)
    v_mfma_f32_16x16x32_bf16 v[64:67], v[88:91], v[208:211], v[64:67]
    ds_read_b64_tr_b16 v[84:85], v101 offset:36032
    buffer_load_dwordx4 a[180:183], v2, s[52:55], s101 offen offset:1024 sc1
    v_mfma_f32_16x16x32_bf16 v[68:71], v[88:91], v[212:215], v[68:71]
    ds_read_b64_tr_b16 v[86:87], v101 offset:37824
    s_waitcnt vmcnt(14) lgkmcnt(6)
    v_mfma_f32_16x16x32_bf16 v[16:19], v[92:95], v[216:219], v[16:19]
    ds_read_b64_tr_b16 v[88:89], v101 offset:43008
    v_fma_f32 v49, -v48, v48, v49
    v_mfma_f32_16x16x32_bf16 v[20:23], v[92:95], v[220:223], v[20:23]
    ds_read_b64_tr_b16 v[90:91], v101 offset:44800
    v_max_f32 v49, 0, v49
    v_mfma_f32_16x16x32_bf16 v[28:31], v[72:75], v[220:223], v[28:31]
    ds_read_b64_tr_b16 v[92:93], v101 offset:43040
    v_add_f32 v49, 0x3727c5ac, v49
    v_mfma_f32_16x16x32_bf16 v[24:27], v[72:75], v[216:219], v[24:27]
    ds_read_b64_tr_b16 v[94:95], v101 offset:44832
    s_waitcnt lgkmcnt(6)
    v_mfma_f32_16x16x32_bf16 v[32:35], v[76:79], v[216:219], v[32:35]
    ds_read_b64_tr_b16 v[72:73], v101 offset:43072
    buffer_load_dwordx4 a[184:187], v2, s[52:55], s101 offen offset:2048 sc1
    v_mfma_f32_16x16x32_bf16 v[36:39], v[76:79], v[220:223], v[36:39]
    ds_read_b64_tr_b16 v[74:75], v101 offset:44864
    v_rsq_f32 v10, v49
    v_mfma_f32_16x16x32_bf16 v[44:47], v[80:83], v[220:223], v[44:47]
    ds_read_b64_tr_b16 v[76:77], v101 offset:43104
    v_mul_f32 v11, -v48, v10
    v_mfma_f32_16x16x32_bf16 v[40:43], v[80:83], v[216:219], v[40:43]
    ds_read_b64_tr_b16 v[78:79], v101 offset:44896
    s_waitcnt lgkmcnt(8)
    v_mfma_f32_16x16x32_bf16 v[64:67], v[84:87], v[216:219], v[64:67]
    ds_read_b64_tr_b16 v[80:81], v101 offset:43200
    buffer_load_dwordx4 a[188:191], v2, s[52:55], s101 offen offset:3072 sc1
    v_mfma_f32_16x16x32_bf16 v[68:71], v[84:87], v[220:223], v[68:71]
    ds_read_b64_tr_b16 v[82:83], v101 offset:44992
    s_waitcnt vmcnt(14) lgkmcnt(6)
    v_mfma_f32_16x16x32_bf16 v[16:19], v[88:91], v[224:227], v[16:19]
    ds_read_b64_tr_b16 v[84:85], v101 offset:50176
    v_mov_b32 v12, v10
    v_mfma_f32_16x16x32_bf16 v[20:23], v[88:91], v[228:231], v[20:23]
    ds_read_b64_tr_b16 v[86:87], v101 offset:51968
    v_mov_b32 v13, v11
    v_mfma_f32_16x16x32_bf16 v[28:31], v[92:95], v[228:231], v[28:31]
    ds_read_b64_tr_b16 v[88:89], v101 offset:50208
    v_permlane16_swap_b32 v10, v12
    v_mfma_f32_16x16x32_bf16 v[24:27], v[92:95], v[224:227], v[24:27]
    ds_read_b64_tr_b16 v[90:91], v101 offset:52000
    s_waitcnt lgkmcnt(6)
    v_mfma_f32_16x16x32_bf16 v[32:35], v[72:75], v[224:227], v[32:35]
    s_add_u32 s101, s101, 4096
    ds_read_b64_tr_b16 v[92:93], v101 offset:50240
    buffer_load_dwordx4 a[192:195], v2, s[52:55], s101 offen offset:0 sc1
    v_mfma_f32_16x16x32_bf16 v[36:39], v[72:75], v[228:231], v[36:39]
    ds_read_b64_tr_b16 v[94:95], v101 offset:52032
    v_permlane16_swap_b32 v11, v13
    v_mfma_f32_16x16x32_bf16 v[44:47], v[76:79], v[228:231], v[44:47]
    ds_read_b64_tr_b16 v[72:73], v101 offset:50272
    v_mfma_f32_16x16x32_bf16 v[40:43], v[76:79], v[224:227], v[40:43]
    ds_read_b64_tr_b16 v[74:75], v101 offset:52064
    s_waitcnt lgkmcnt(8)
    v_mfma_f32_16x16x32_bf16 v[64:67], v[80:83], v[224:227], v[64:67]
    ds_read_b64_tr_b16 v[76:77], v101 offset:50368
    buffer_load_dwordx4 a[196:199], v2, s[52:55], s101 offen offset:1024 sc1
    v_mfma_f32_16x16x32_bf16 v[68:71], v[80:83], v[228:231], v[68:71]
    ds_read_b64_tr_b16 v[78:79], v101 offset:52160
    s_waitcnt vmcnt(14) lgkmcnt(6)
    v_mfma_f32_16x16x32_bf16 v[16:19], v[84:87], v[232:235], v[16:19]
    ds_read_b64_tr_b16 v[80:81], v100 offset:128
    v_mfma_f32_16x16x32_bf16 v[20:23], v[84:87], v[236:239], v[20:23]
    ds_read_b64_tr_b16 v[82:83], v100 offset:1920
    v_mfma_f32_16x16x32_bf16 v[28:31], v[88:91], v[236:239], v[28:31]
    ds_read_b64_tr_b16 v[84:85], v100 offset:160
    v_mfma_f32_16x16x32_bf16 v[24:27], v[88:91], v[232:235], v[24:27]
    ds_read_b64_tr_b16 v[86:87], v100 offset:1952
    s_waitcnt lgkmcnt(6)
    v_mfma_f32_16x16x32_bf16 v[32:35], v[92:95], v[232:235], v[32:35]
    ds_read_b64_tr_b16 v[88:89], v100 offset:7296
    buffer_load_dwordx4 a[200:203], v2, s[52:55], s101 offen offset:2048 sc1
    v_mfma_f32_16x16x32_bf16 v[36:39], v[92:95], v[236:239], v[36:39]
    ds_read_b64_tr_b16 v[90:91], v100 offset:9088
    v_mfma_f32_16x16x32_bf16 v[44:47], v[72:75], v[236:239], v[44:47]
    ds_read_b64_tr_b16 v[92:93], v100 offset:7328
    v_mfma_f32_16x16x32_bf16 v[40:43], v[72:75], v[232:235], v[40:43]
    ds_read_b64_tr_b16 v[94:95], v100 offset:9120
    s_waitcnt lgkmcnt(8)
    v_mfma_f32_16x16x32_bf16 v[64:67], v[76:79], v[232:235], v[64:67]
    ds_read_b64_tr_b16 v[72:73], v100 offset:14464
    buffer_load_dwordx4 a[204:207], v2, s[52:55], s101 offen offset:3072 sc1
    v_mfma_f32_16x16x32_bf16 v[68:71], v[76:79], v[236:239], v[68:71]
    ds_read_b64_tr_b16 v[74:75], v100 offset:16256
    ds_read_b128 v[48:51], v102 offset:0
    ds_read_b128 v[52:55], v102 offset:512
    ds_read_b128 v[56:59], v102 offset:64
    ds_read_b128 v[60:63], v102 offset:576
    s_waitcnt lgkmcnt(2)
    v_pk_fma_f32 v[96:97], v[48:49], v[10:11], v[52:53] op_sel:[0,1,0] op_sel_hi:[1,1,1]
    v_pk_fma_f32 v[98:99], v[50:51], v[10:11], v[54:55] op_sel:[0,1,0] op_sel_hi:[1,1,1]
    v_pk_fma_f32 v[96:97], v[16:17], v[10:11], v[96:97] op_sel:[0,0,0] op_sel_hi:[1,0,1]
    v_pk_fma_f32 v[98:99], v[18:19], v[10:11], v[98:99] op_sel:[0,0,0] op_sel_hi:[1,0,1]
    v_cvt_pk_bf16_f32 v16, v96, v97
    v_cvt_pk_bf16_f32 v17, v98, v99
    v_pk_max_i16 v16, v16, 0
    v_pk_max_i16 v17, v17, 0
    v_pk_fma_f32 v[96:97], v[48:49], v[12:13], v[52:53] op_sel:[0,1,0] op_sel_hi:[1,1,1]
    v_pk_fma_f32 v[98:99], v[50:51], v[12:13], v[54:55] op_sel:[0,1,0] op_sel_hi:[1,1,1]
    v_pk_fma_f32 v[96:97], v[20:21], v[12:13], v[96:97] op_sel:[0,0,0] op_sel_hi:[1,0,1]
    v_pk_fma_f32 v[98:99], v[22:23], v[12:13], v[98:99] op_sel:[0,0,0] op_sel_hi:[1,0,1]
    ds_read_b128 v[48:51], v102 offset:128
    ds_read_b128 v[52:55], v102 offset:640
    v_cvt_pk_bf16_f32 v20, v96, v97
    v_cvt_pk_bf16_f32 v21, v98, v99
    v_pk_max_i16 v20, v20, 0
    v_pk_max_i16 v21, v21, 0
    s_waitcnt lgkmcnt(2)
    v_pk_fma_f32 v[96:97], v[56:57], v[10:11], v[60:61] op_sel:[0,1,0] op_sel_hi:[1,1,1]
    v_pk_fma_f32 v[98:99], v[58:59], v[10:11], v[62:63] op_sel:[0,1,0] op_sel_hi:[1,1,1]
    v_pk_fma_f32 v[96:97], v[24:25], v[10:11], v[96:97] op_sel:[0,0,0] op_sel_hi:[1,0,1]
    v_pk_fma_f32 v[98:99], v[26:27], v[10:11], v[98:99] op_sel:[0,0,0] op_sel_hi:[1,0,1]
    v_cvt_pk_bf16_f32 v18, v96, v97
    v_cvt_pk_bf16_f32 v19, v98, v99
    v_pk_max_i16 v18, v18, 0
    v_pk_max_i16 v19, v19, 0
    buffer_store_dwordx4 v[16:19], v107, s[52:55], s26 offen offset:0 sc1
    v_pk_fma_f32 v[96:97], v[56:57], v[12:13], v[60:61] op_sel:[0,1,0] op_sel_hi:[1,1,1]
    v_pk_fma_f32 v[98:99], v[58:59], v[12:13], v[62:63] op_sel:[0,1,0] op_sel_hi:[1,1,1]
    v_pk_fma_f32 v[96:97], v[28:29], v[12:13], v[96:97] op_sel:[0,0,0] op_sel_hi:[1,0,1]
    v_pk_fma_f32 v[98:99], v[30:31], v[12:13], v[98:99] op_sel:[0,0,0] op_sel_hi:[1,0,1]
    ds_read_b128 v[56:59], v102 offset:192
    ds_read_b128 v[60:63], v102 offset:704
    v_cvt_pk_bf16_f32 v22, v96, v97
    v_cvt_pk_bf16_f32 v23, v98, v99
    v_pk_max_i16 v22, v22, 0
    v_pk_max_i16 v23, v23, 0
    buffer_store_dwordx4 v[20:23], v107, s[52:55], s27 offen offset:0 sc1
    s_waitcnt lgkmcnt(2)
    v_pk_fma_f32 v[96:97], v[48:49], v[10:11], v[52:53] op_sel:[0,1,0] op_sel_hi:[1,1,1]
    v_pk_fma_f32 v[98:99], v[50:51], v[10:11], v[54:55] op_sel:[0,1,0] op_sel_hi:[1,1,1]
    v_pk_fma_f32 v[96:97], v[32:33], v[10:11], v[96:97] op_sel:[0,0,0] op_sel_hi:[1,0,1]
    v_pk_fma_f32 v[98:99], v[34:35], v[10:11], v[98:99] op_sel:[0,0,0] op_sel_hi:[1,0,1]
    v_cvt_pk_bf16_f32 v32, v96, v97
    v_cvt_pk_bf16_f32 v33, v98, v99
    v_pk_max_i16 v32, v32, 0
    v_pk_max_i16 v33, v33, 0
    v_pk_fma_f32 v[96:97], v[48:49], v[12:13], v[52:53] op_sel:[0,1,0] op_sel_hi:[1,1,1]
    v_pk_fma_f32 v[98:99], v[50:51], v[12:13], v[54:55] op_sel:[0,1,0] op_sel_hi:[1,1,1]
    v_pk_fma_f32 v[96:97], v[36:37], v[12:13], v[96:97] op_sel:[0,0,0] op_sel_hi:[1,0,1]
    v_pk_fma_f32 v[98:99], v[38:39], v[12:13], v[98:99] op_sel:[0,0,0] op_sel_hi:[1,0,1]
    ds_read_b128 v[48:51], v102 offset:384
    ds_read_b128 v[52:55], v102 offset:896
    v_cvt_pk_bf16_f32 v36, v96, v97
    v_cvt_pk_bf16_f32 v37, v98, v99
    v_pk_max_i16 v36, v36, 0
    v_pk_max_i16 v37, v37, 0
    s_waitcnt lgkmcnt(2)
    v_pk_fma_f32 v[96:97], v[56:57], v[10:11], v[60:61] op_sel:[0,1,0] op_sel_hi:[1,1,1]
    v_pk_fma_f32 v[98:99], v[58:59], v[10:11], v[62:63] op_sel:[0,1,0] op_sel_hi:[1,1,1]
    v_pk_fma_f32 v[96:97], v[40:41], v[10:11], v[96:97] op_sel:[0,0,0] op_sel_hi:[1,0,1]
    v_pk_fma_f32 v[98:99], v[42:43], v[10:11], v[98:99] op_sel:[0,0,0] op_sel_hi:[1,0,1]
    v_cvt_pk_bf16_f32 v34, v96, v97
    v_cvt_pk_bf16_f32 v35, v98, v99
    v_pk_max_i16 v34, v34, 0
    v_pk_max_i16 v35, v35, 0
    buffer_store_dwordx4 v[32:35], v107, s[52:55], s26 offen offset:1024 sc1
    v_pk_fma_f32 v[96:97], v[56:57], v[12:13], v[60:61] op_sel:[0,1,0] op_sel_hi:[1,1,1]
    v_pk_fma_f32 v[98:99], v[58:59], v[12:13], v[62:63] op_sel:[0,1,0] op_sel_hi:[1,1,1]
    v_pk_fma_f32 v[96:97], v[44:45], v[12:13], v[96:97] op_sel:[0,0,0] op_sel_hi:[1,0,1]
    v_pk_fma_f32 v[98:99], v[46:47], v[12:13], v[98:99] op_sel:[0,0,0] op_sel_hi:[1,0,1]
    v_cvt_pk_bf16_f32 v38, v96, v97
    v_cvt_pk_bf16_f32 v39, v98, v99
    v_pk_max_i16 v38, v38, 0
    v_pk_max_i16 v39, v39, 0
    buffer_store_dwordx4 v[36:39], v107, s[52:55], s27 offen offset:1024 sc1
    s_waitcnt lgkmcnt(0)
    v_pk_fma_f32 v[96:97], v[48:49], v[10:11], v[52:53] op_sel:[0,1,0] op_sel_hi:[1,1,1]
    v_pk_fma_f32 v[98:99], v[50:51], v[10:11], v[54:55] op_sel:[0,1,0] op_sel_hi:[1,1,1]
    v_pk_fma_f32 v[96:97], v[64:65], v[10:11], v[96:97] op_sel:[0,0,0] op_sel_hi:[1,0,1]
    v_pk_fma_f32 v[98:99], v[66:67], v[10:11], v[98:99] op_sel:[0,0,0] op_sel_hi:[1,0,1]
    v_cvt_pk_bf16_f32 v64, v96, v97
    v_cvt_pk_bf16_f32 v65, v98, v99
    v_pk_max_i16 v64, v64, 0
    v_pk_max_i16 v65, v65, 0
    buffer_store_dword v64, v108, s[52:55], s26 offen offset:3072 sc1
    buffer_store_dword v65, v108, s[52:55], s26 offen offset:3328 sc1
    v_pk_fma_f32 v[96:97], v[48:49], v[12:13], v[52:53] op_sel:[0,1,0] op_sel_hi:[1,1,1]
    v_pk_fma_f32 v[98:99], v[50:51], v[12:13], v[54:55] op_sel:[0,1,0] op_sel_hi:[1,1,1]
    v_pk_fma_f32 v[96:97], v[68:69], v[12:13], v[96:97] op_sel:[0,0,0] op_sel_hi:[1,0,1]
    v_pk_fma_f32 v[98:99], v[70:71], v[12:13], v[98:99] op_sel:[0,0,0] op_sel_hi:[1,0,1]
    v_cvt_pk_bf16_f32 v68, v96, v97
    v_cvt_pk_bf16_f32 v69, v98, v99
    v_pk_max_i16 v68, v68, 0
    v_pk_max_i16 v69, v69, 0
    buffer_store_dword v68, v108, s[52:55], s27 offen offset:3072 sc1
    buffer_store_dword v69, v108, s[52:55], s27 offen offset:3328 sc1
    v_mfma_f32_16x16x32_bf16 v[48:51], v[80:83], v[112:115], 0
    ds_read_b64_tr_b16 v[76:77], v100 offset:14496
    v_mfma_f32_16x16x32_bf16 v[52:55], v[80:83], v[116:119], 0
    ds_read_b64_tr_b16 v[78:79], v100 offset:16288
    v_mfma_f32_16x16x32_bf16 v[60:63], v[84:87], v[116:119], 0
    s_add_u32 s101, s101, 4096
    ds_read_b64_tr_b16 v[80:81], v100 offset:21632
    buffer_load_dwordx4 a[208:211], v2, s[52:55], s101 offen offset:0 sc1
    v_mfma_f32_16x16x32_bf16 v[56:59], v[84:87], v[112:115], 0
    ds_read_b64_tr_b16 v[82:83], v100 offset:23424
    v_mfma_f32_16x16x32_bf16 v[48:51], v[88:91], v[120:123], v[48:51]
    ds_read_b64_tr_b16 v[84:85], v100 offset:21664
    v_mfma_f32_16x16x32_bf16 v[52:55], v[88:91], v[124:127], v[52:55]
    ds_read_b64_tr_b16 v[86:87], v100 offset:23456
    v_mfma_f32_16x16x32_bf16 v[60:63], v[92:95], v[124:127], v[60:63]
    ds_read_b64_tr_b16 v[88:89], v100 offset:28800
    buffer_load_dwordx4 a[212:215], v2, s[52:55], s101 offen offset:1024 sc1
    v_mfma_f32_16x16x32_bf16 v[56:59], v[92:95], v[120:123], v[56:59]
    ds_read_b64_tr_b16 v[90:91], v100 offset:30592
    s_waitcnt lgkmcnt(6)
    v_mfma_f32_16x16x32_bf16 v[48:51], v[72:75], v[128:131], v[48:51]
    ds_read_b64_tr_b16 v[92:93], v100 offset:28832
    v_mfma_f32_16x16x32_bf16 v[52:55], v[72:75], v[132:135], v[52:55]
    ds_read_b64_tr_b16 v[94:95], v100 offset:30624
    v_mfma_f32_16x16x32_bf16 v[60:63], v[76:79], v[132:135], v[60:63]
    ds_read_b64_tr_b16 v[72:73], v100 offset:35968
    v_mfma_f32_16x16x32_bf16 v[56:59], v[76:79], v[128:131], v[56:59]
    ds_read_b64_tr_b16 v[74:75], v100 offset:37760
    s_waitcnt lgkmcnt(6)
    v_mfma_f32_16x16x32_bf16 v[48:51], v[80:83], v[136:139], v[48:51]
    ds_read_b64_tr_b16 v[76:77], v100 offset:36000
    v_mfma_f32_16x16x32_bf16 v[52:55], v[80:83], v[140:143], v[52:55]
    ds_read_b64_tr_b16 v[78:79], v100 offset:37792
    v_mfma_f32_16x16x32_bf16 v[60:63], v[84:87], v[140:143], v[60:63]
    ds_read_b64_tr_b16 v[80:81], v100 offset:43136
    v_mfma_f32_16x16x32_bf16 v[56:59], v[84:87], v[136:139], v[56:59]
    ds_read_b64_tr_b16 v[82:83], v100 offset:44928
    s_waitcnt lgkmcnt(6)
    v_mfma_f32_16x16x32_bf16 v[48:51], v[88:91], v[144:147], v[48:51]
    ds_read_b64_tr_b16 v[84:85], v100 offset:43168
    v_mfma_f32_16x16x32_bf16 v[52:55], v[88:91], v[148:151], v[52:55]
    ds_read_b64_tr_b16 v[86:87], v100 offset:44960
    v_mfma_f32_16x16x32_bf16 v[60:63], v[92:95], v[148:151], v[60:63]
    ds_read_b64_tr_b16 v[88:89], v100 offset:50304
    v_mfma_f32_16x16x32_bf16 v[56:59], v[92:95], v[144:147], v[56:59]
    ds_read_b64_tr_b16 v[90:91], v100 offset:52096
    s_waitcnt lgkmcnt(6)
    v_mfma_f32_16x16x32_bf16 v[48:51], v[72:75], v[152:155], v[48:51]
    ds_read_b64_tr_b16 v[92:93], v100 offset:50336
    v_mfma_f32_16x16x32_bf16 v[52:55], v[72:75], v[156:159], v[52:55]
    ds_read_b64_tr_b16 v[94:95], v100 offset:52128
    v_mfma_f32_16x16x32_bf16 v[60:63], v[76:79], v[156:159], v[60:63]
    ds_read_b64_tr_b16 v[72:73], v101 offset:128
    v_mfma_f32_16x16x32_bf16 v[56:59], v[76:79], v[152:155], v[56:59]
    ds_read_b64_tr_b16 v[74:75], v101 offset:1920
    s_waitcnt lgkmcnt(6)
    v_mfma_f32_16x16x32_bf16 v[48:51], v[80:83], v[160:163], v[48:51]
    ds_read_b64_tr_b16 v[76:77], v101 offset:160
    v_mfma_f32_16x16x32_bf16 v[52:55], v[80:83], v[164:167], v[52:55]
    ds_read_b64_tr_b16 v[78:79], v101 offset:1952
    v_mfma_f32_16x16x32_bf16 v[60:63], v[84:87], v[164:167], v[60:63]
    ds_read_b64_tr_b16 v[80:81], v101 offset:7296
    v_mfma_f32_16x16x32_bf16 v[56:59], v[84:87], v[160:163], v[56:59]
    ds_read_b64_tr_b16 v[82:83], v101 offset:9088
    s_waitcnt lgkmcnt(6)
    v_mfma_f32_16x16x32_bf16 v[48:51], v[88:91], v[168:171], v[48:51]
    ds_read_b64_tr_b16 v[84:85], v101 offset:7328
    v_mfma_f32_16x16x32_bf16 v[52:55], v[88:91], v[172:175], v[52:55]
    ds_read_b64_tr_b16 v[86:87], v101 offset:9120
    v_mfma_f32_16x16x32_bf16 v[60:63], v[92:95], v[172:175], v[60:63]
    ds_read_b64_tr_b16 v[88:89], v101 offset:14464
    v_mfma_f32_16x16x32_bf16 v[56:59], v[92:95], v[168:171], v[56:59]
    ds_read_b64_tr_b16 v[90:91], v101 offset:16256
    s_waitcnt lgkmcnt(6)
    v_mfma_f32_16x16x32_bf16 v[48:51], v[72:75], v[176:179], v[48:51]
    ds_read_b64_tr_b16 v[92:93], v101 offset:14496
    v_mfma_f32_16x16x32_bf16 v[52:55], v[72:75], v[180:183], v[52:55]
    ds_read_b64_tr_b16 v[94:95], v101 offset:16288
    v_mfma_f32_16x16x32_bf16 v[60:63], v[76:79], v[180:183], v[60:63]
    ds_read_b64_tr_b16 v[72:73], v101 offset:21632
    v_mfma_f32_16x16x32_bf16 v[56:59], v[76:79], v[176:179], v[56:59]
    ds_read_b64_tr_b16 v[74:75], v101 offset:23424
    s_waitcnt lgkmcnt(6)
    v_mfma_f32_16x16x32_bf16 v[48:51], v[80:83], v[184:187], v[48:51]
    ds_read_b64_tr_b16 v[76:77], v101 offset:21664
    v_mfma_f32_16x16x32_bf16 v[52:55], v[80:83], v[188:191], v[52:55]
    ds_read_b64_tr_b16 v[78:79], v101 offset:23456
    v_mfma_f32_16x16x32_bf16 v[60:63], v[84:87], v[188:191], v[60:63]
    ds_read_b64_tr_b16 v[80:81], v101 offset:28800
    v_mfma_f32_16x16x32_bf16 v[56:59], v[84:87], v[184:187], v[56:59]
    ds_read_b64_tr_b16 v[82:83], v101 offset:30592
    s_waitcnt lgkmcnt(6)
    v_mfma_f32_16x16x32_bf16 v[48:51], v[88:91], v[192:195], v[48:51]
    ds_read_b64_tr_b16 v[84:85], v101 offset:28832
    v_mfma_f32_16x16x32_bf16 v[52:55], v[88:91], v[196:199], v[52:55]
    ds_read_b64_tr_b16 v[86:87], v101 offset:30624
    v_mfma_f32_16x16x32_bf16 v[60:63], v[92:95], v[196:199], v[60:63]
    ds_read_b64_tr_b16 v[88:89], v101 offset:35968
    v_mfma_f32_16x16x32_bf16 v[56:59], v[92:95], v[192:195], v[56:59]
    ds_read_b64_tr_b16 v[90:91], v101 offset:37760
    s_waitcnt lgkmcnt(6)
    v_mfma_f32_16x16x32_bf16 v[48:51], v[72:75], v[200:203], v[48:51]
    ds_read_b64_tr_b16 v[92:93], v101 offset:36000
    v_mfma_f32_16x16x32_bf16 v[52:55], v[72:75], v[204:207], v[52:55]
    ds_read_b64_tr_b16 v[94:95], v101 offset:37792
    v_mfma_f32_16x16x32_bf16 v[60:63], v[76:79], v[204:207], v[60:63]
    ds_read_b64_tr_b16 v[72:73], v101 offset:43136
    v_mfma_f32_16x16x32_bf16 v[56:59], v[76:79], v[200:203], v[56:59]
    ds_read_b64_tr_b16 v[74:75], v101 offset:44928
    s_waitcnt lgkmcnt(6)
    v_mfma_f32_16x16x32_bf16 v[48:51], v[80:83], v[208:211], v[48:51]
    ds_read_b64_tr_b16 v[76:77], v101 offset:43168
    v_mfma_f32_16x16x32_bf16 v[52:55], v[80:83], v[212:215], v[52:55]
    ds_read_b64_tr_b16 v[78:79], v101 offset:44960
    v_mfma_f32_16x16x32_bf16 v[60:63], v[84:87], v[212:215], v[60:63]
    ds_read_b64_tr_b16 v[80:81], v101 offset:50304
    v_mfma_f32_16x16x32_bf16 v[56:59], v[84:87], v[208:211], v[56:59]
    ds_read_b64_tr_b16 v[82:83], v101 offset:52096
    s_waitcnt lgkmcnt(6)
    v_mfma_f32_16x16x32_bf16 v[48:51], v[88:91], v[216:219], v[48:51]
    ds_read_b64_tr_b16 v[84:85], v101 offset:50336
    v_mfma_f32_16x16x32_bf16 v[52:55], v[88:91], v[220:223], v[52:55]
    ds_read_b64_tr_b16 v[86:87], v101 offset:52128
    v_mfma_f32_16x16x32_bf16 v[60:63], v[92:95], v[220:223], v[60:63]
    v_mfma_f32_16x16x32_bf16 v[56:59], v[92:95], v[216:219], v[56:59]
    s_waitcnt lgkmcnt(4)
    v_mfma_f32_16x16x32_bf16 v[48:51], v[72:75], v[224:227], v[48:51]
    v_mfma_f32_16x16x32_bf16 v[52:55], v[72:75], v[228:231], v[52:55]
    v_mfma_f32_16x16x32_bf16 v[60:63], v[76:79], v[228:231], v[60:63]
    v_mfma_f32_16x16x32_bf16 v[56:59], v[76:79], v[224:227], v[56:59]
    s_waitcnt vmcnt(2)
    s_mov_b64 exec, 1
    buffer_store_dword v3, off, s[52:55], s15 sc1
    s_mov_b64 exec, -1
    s_waitcnt lgkmcnt(0)
    v_mfma_f32_16x16x32_bf16 v[48:51], v[80:83], v[232:235], v[48:51]
    ds_read_b128 v[176:179], v102 offset:256
    v_mfma_f32_16x16x32_bf16 v[52:55], v[80:83], v[236:239], v[52:55]
    ds_read_b128 v[180:183], v102 offset:768
    v_mfma_f32_16x16x32_bf16 v[60:63], v[84:87], v[236:239], v[60:63]
    ds_read_b128 v[184:187], v102 offset:320
    v_mfma_f32_16x16x32_bf16 v[56:59], v[84:87], v[232:235], v[56:59]
    ds_read_b128 v[188:191], v102 offset:832
    buffer_load_dword v15, v104, s[52:55], 0 offen offset:128 sc1
    buffer_load_dwordx4 a[216:219], v2, s[52:55], s101 offen offset:2048 sc1
    buffer_load_dwordx4 a[220:223], v2, s[52:55], s101 offen offset:3072 sc1
    s_waitcnt lgkmcnt(2)
    v_pk_fma_f32 v[96:97], v[176:177], v[10:11], v[180:181] op_sel:[0,1,0] op_sel_hi:[1,1,1]
    v_pk_fma_f32 v[98:99], v[178:179], v[10:11], v[182:183] op_sel:[0,1,0] op_sel_hi:[1,1,1]
    v_pk_fma_f32 v[96:97], v[48:49], v[10:11], v[96:97] op_sel:[0,0,0] op_sel_hi:[1,0,1]
    v_pk_fma_f32 v[98:99], v[50:51], v[10:11], v[98:99] op_sel:[0,0,0] op_sel_hi:[1,0,1]
    v_cvt_pk_bf16_f32 v48, v96, v97
    v_cvt_pk_bf16_f32 v49, v98, v99
    v_pk_max_i16 v48, v48, 0
    v_pk_max_i16 v49, v49, 0
    v_pk_fma_f32 v[96:97], v[176:177], v[12:13], v[180:181] op_sel:[0,1,0] op_sel_hi:[1,1,1]
    v_pk_fma_f32 v[98:99], v[178:179], v[12:13], v[182:183] op_sel:[0,1,0] op_sel_hi:[1,1,1]
    v_pk_fma_f32 v[96:97], v[52:53], v[12:13], v[96:97] op_sel:[0,0,0] op_sel_hi:[1,0,1]
    v_pk_fma_f32 v[98:99], v[54:55], v[12:13], v[98:99] op_sel:[0,0,0] op_sel_hi:[1,0,1]
    v_cvt_pk_bf16_f32 v52, v96, v97
    v_cvt_pk_bf16_f32 v53, v98, v99
    v_pk_max_i16 v52, v52, 0
    v_pk_max_i16 v53, v53, 0
    s_waitcnt lgkmcnt(0)
    v_pk_fma_f32 v[96:97], v[184:185], v[10:11], v[188:189] op_sel:[0,1,0] op_sel_hi:[1,1,1]
    v_pk_fma_f32 v[98:99], v[186:187], v[10:11], v[190:191] op_sel:[0,1,0] op_sel_hi:[1,1,1]
    v_pk_fma_f32 v[96:97], v[56:57], v[10:11], v[96:97] op_sel:[0,0,0] op_sel_hi:[1,0,1]
    v_pk_fma_f32 v[98:99], v[58:59], v[10:11], v[98:99] op_sel:[0,0,0] op_sel_hi:[1,0,1]
    v_cvt_pk_bf16_f32 v50, v96, v97
    v_cvt_pk_bf16_f32 v51, v98, v99
    v_pk_max_i16 v50, v50, 0
    v_pk_max_i16 v51, v51, 0
    v_pk_fma_f32 v[96:97], v[184:185], v[12:13], v[188:189] op_sel:[0,1,0] op_sel_hi:[1,1,1]
    v_pk_fma_f32 v[98:99], v[186:187], v[12:13], v[190:191] op_sel:[0,1,0] op_sel_hi:[1,1,1]
    v_pk_fma_f32 v[96:97], v[60:61], v[12:13], v[96:97] op_sel:[0,0,0] op_sel_hi:[1,0,1]
    v_pk_fma_f32 v[98:99], v[62:63], v[12:13], v[98:99] op_sel:[0,0,0] op_sel_hi:[1,0,1]
    v_cvt_pk_bf16_f32 v54, v96, v97
    v_cvt_pk_bf16_f32 v55, v98, v99
    v_pk_max_i16 v54, v54, 0
    v_pk_max_i16 v55, v55, 0
    ds_read_b128 v[80:83], v5 offset:256
    ds_read_b128 v[84:87], v5 offset:272
    ds_read_b128 v[88:91], v5 offset:288
    ds_read_b128 v[92:95], v5 offset:304
    v_add_u32 v12, 1, v3
    s_waitcnt vmcnt(2)
    v_subrev_u32 v15, s68, v15
    v_cmp_lt_u32 vcc, 1, v15
    s_nop 0
    s_and_b64 vcc, vcc, s[60:61]
    s_cbranch_scc0 L_hida_77
    s_mov_b32 s82, 0
L_phid_78:
    buffer_load_dword v15, v104, s[52:55], 0 offen offset:128 sc1
    s_add_u32 s82, s82, 1
    s_waitcnt vmcnt(0)
    v_subrev_u32 v15, s68, v15
    v_cmp_lt_u32 vcc, 1, v15
    s_nop 0
    s_and_b64 vcc, vcc, s[60:61]
    s_cbranch_scc0 L_dhid_79
    s_cmp_lt_u32 s82, 131072
    s_cbranch_scc1 L_phid_78
L_dhid_79:
L_hida_77:
    buffer_load_dwordx4 v[112:115], v2, s[52:55], s16 offen offset:0 sc1
    buffer_load_dwordx4 v[116:119], v2, s[52:55], s16 offen offset:1024 sc1
    buffer_load_dword v120, v109, s[52:55], s16 offen offset:3072 sc1
    buffer_load_dword v121, v109, s[52:55], s16 offen offset:3328 sc1
    buffer_load_dword v122, v109, s[52:55], s16 offen offset:3584 sc1
    buffer_load_dword v123, v109, s[52:55], s16 offen offset:3840 sc1
    s_add_u32 s78, s16, 4096
    buffer_load_dwordx4 v[124:127], v2, s[52:55], s78 offen offset:0 sc1
    buffer_load_dwordx4 v[128:131], v2, s[52:55], s78 offen offset:1024 sc1
    buffer_load_dwordx4 v[132:135], v2, s[52:55], s78 offen offset:3072 sc1
    s_add_u32 s78, s16, 8192
    buffer_load_dwordx4 v[136:139], v2, s[52:55], s78 offen offset:0 sc1
    buffer_load_dword v140, v109, s[52:55], s78 offen offset:2048 sc1
    buffer_load_dword v141, v109, s[52:55], s78 offen offset:2304 sc1
    buffer_load_dword v142, v109, s[52:55], s78 offen offset:2560 sc1
    buffer_load_dword v143, v109, s[52:55], s78 offen offset:2816 sc1
    buffer_store_dwordx4 v[48:51], v107, s[52:55], s26 offen offset:2048 sc1
    buffer_store_dwordx4 v[52:55], v107, s[52:55], s27 offen offset:2048 sc1
    s_lshl_b32 s76, s5, 13
    s_add_u32 s76, s76, 126976
    s_mov_b32 s77, 8192
    v_and_b32 v13, 15, v1
    v_lshrrev_b32 v14, 3, v1
    v_and_b32 v14, 6, v14
    v_xor_b32 v14, v14, v13
    v_and_b32 v14, 7, v14
    v_lshl_add_u32 v13, v13, 7, s76
    v_lshl_add_u32 v13, v14, 4, v13
    v_xor_b32 v14, 16, v13
    v_subrev_u32 v8, 40960, v8
    v_subrev_u32 v11, 40960, v9
    s_waitcnt vmcnt(15)
    v_mfma_f32_16x16x32_bf16 v[16:19], a[0:3], v[112:115], 0
    v_mfma_f32_16x16x32_bf16 v[20:23], a[4:7], v[112:115], 0
    buffer_load_dwordx4 v[144:147], v2, s[52:55], s78 offen offset:3072 sc1
    v_mfma_f32_16x16x32_bf16 v[24:27], a[8:11], v[112:115], 0
    v_mfma_f32_16x16x32_bf16 v[28:31], a[12:15], v[112:115], 0
    s_waitcnt vmcnt(15)
    v_mfma_f32_16x16x32_bf16 v[16:19], a[16:19], v[116:119], v[16:19]
    s_add_u32 s78, s16, 12288
    v_mfma_f32_16x16x32_bf16 v[20:23], a[20:23], v[116:119], v[20:23]
    buffer_load_dwordx4 v[148:151], v2, s[52:55], s78 offen offset:0 sc1
    v_mfma_f32_16x16x32_bf16 v[24:27], a[24:27], v[116:119], v[24:27]
    v_mfma_f32_16x16x32_bf16 v[28:31], a[28:31], v[116:119], v[28:31]
    s_waitcnt vmcnt(12)
    v_mfma_f32_16x16x32_bf16 v[16:19], a[48:51], v[120:123], v[16:19]
    v_mfma_f32_16x16x32_bf16 v[20:23], a[52:55], v[120:123], v[20:23]
    buffer_load_dwordx4 v[152:155], v2, s[52:55], s17 offen offset:0 sc1
    v_mfma_f32_16x16x32_bf16 v[24:27], a[56:59], v[120:123], v[24:27]
    v_mfma_f32_16x16x32_bf16 v[28:31], a[60:63], v[120:123], v[28:31]
    s_waitcnt vmcnt(12)
    v_mfma_f32_16x16x32_bf16 v[16:19], a[64:67], v[124:127], v[16:19]
    v_mfma_f32_16x16x32_bf16 v[20:23], a[68:71], v[124:127], v[20:23]
    buffer_load_dwordx4 v[156:159], v2, s[52:55], s17 offen offset:1024 sc1
    v_mfma_f32_16x16x32_bf16 v[24:27], a[72:75], v[124:127], v[24:27]
    v_mfma_f32_16x16x32_bf16 v[28:31], a[76:79], v[124:127], v[28:31]
    s_waitcnt vmcnt(12)
    v_mfma_f32_16x16x32_bf16 v[16:19], a[80:83], v[128:131], v[16:19]
    v_mfma_f32_16x16x32_bf16 v[20:23], a[84:87], v[128:131], v[20:23]
    buffer_load_dword v160, v109, s[52:55], s17 offen offset:3072 sc1
    buffer_load_dword v161, v109, s[52:55], s17 offen offset:3328 sc1
    buffer_load_dword v162, v109, s[52:55], s17 offen offset:3584 sc1
    buffer_load_dword v163, v109, s[52:55], s17 offen offset:3840 sc1
    v_mfma_f32_16x16x32_bf16 v[24:27], a[88:91], v[128:131], v[24:27]
    v_mfma_f32_16x16x32_bf16 v[28:31], a[92:95], v[128:131], v[28:31]
    s_waitcnt vmcnt(15)
    v_mfma_f32_16x16x32_bf16 v[16:19], a[112:115], v[132:135], v[16:19]
    s_add_u32 s78, s17, 4096
    v_mfma_f32_16x16x32_bf16 v[20:23], a[116:119], v[132:135], v[20:23]
    buffer_load_dwordx4 v[164:167], v2, s[52:55], s78 offen offset:0 sc1
    v_mfma_f32_16x16x32_bf16 v[24:27], a[120:123], v[132:135], v[24:27]
    v_mfma_f32_16x16x32_bf16 v[28:31], a[124:127], v[132:135], v[28:31]
    s_waitcnt vmcnt(15)
    v_mfma_f32_16x16x32_bf16 v[16:19], a[128:131], v[136:139], v[16:19]
    v_mfma_f32_16x16x32_bf16 v[20:23], a[132:135], v[136:139], v[20:23]
    buffer_load_dwordx4 v[168:171], v2, s[52:55], s78 offen offset:1024 sc1
    v_mfma_f32_16x16x32_bf16 v[24:27], a[136:139], v[136:139], v[24:27]
    v_mfma_f32_16x16x32_bf16 v[28:31], a[140:143], v[136:139], v[28:31]
    s_waitcnt vmcnt(12)
    v_mfma_f32_16x16x32_bf16 v[16:19], a[160:163], v[140:143], v[16:19]
    v_mfma_f32_16x16x32_bf16 v[20:23], a[164:167], v[140:143], v[20:23]
    buffer_load_dwordx4 v[172:175], v2, s[52:55], s78 offen offset:3072 sc1
    v_mfma_f32_16x16x32_bf16 v[24:27], a[168:171], v[140:143], v[24:27]
    v_mfma_f32_16x16x32_bf16 v[28:31], a[172:175], v[140:143], v[28:31]
    s_waitcnt vmcnt(10)
    s_mov_b64 exec, 1
    buffer_store_dword v12, off, s[52:55], s15 sc1
    s_mov_b64 exec, -1
    v_mfma_f32_16x16x32_bf16 v[16:19], a[176:179], v[144:147], v[16:19]
    s_add_u32 s78, s17, 8192
    v_mfma_f32_16x16x32_bf16 v[20:23], a[180:183], v[144:147], v[20:23]
    buffer_load_dwordx4 v[112:115], v2, s[52:55], s78 offen offset:0 sc1
    v_mfma_f32_16x16x32_bf16 v[24:27], a[184:187], v[144:147], v[24:27]
    v_mfma_f32_16x16x32_bf16 v[28:31], a[188:191], v[144:147], v[28:31]
    s_waitcnt vmcnt(11)
    v_mfma_f32_16x16x32_bf16 v[16:19], a[192:195], v[148:151], v[16:19]
    v_mfma_f32_16x16x32_bf16 v[20:23], a[196:199], v[148:151], v[20:23]
    buffer_load_dword v116, v109, s[52:55], s78 offen offset:2048 sc1
    buffer_load_dword v117, v109, s[52:55], s78 offen offset:2304 sc1
    buffer_load_dword v118, v109, s[52:55], s78 offen offset:2560 sc1
    buffer_load_dword v119, v109, s[52:55], s78 offen offset:2816 sc1
    v_mfma_f32_16x16x32_bf16 v[24:27], a[200:203], v[148:151], v[24:27]
    v_mfma_f32_16x16x32_bf16 v[28:31], a[204:207], v[148:151], v[28:31]
    s_waitcnt vmcnt(14)
    v_mfma_f32_16x16x32_bf16 v[32:35], a[0:3], v[152:155], 0
    v_mfma_f32_16x16x32_bf16 v[36:39], a[4:7], v[152:155], 0
    buffer_load_dwordx4 v[120:123], v2, s[52:55], s78 offen offset:3072 sc1
    v_mfma_f32_16x16x32_bf16 v[40:43], a[8:11], v[152:155], 0
    v_mfma_f32_16x16x32_bf16 v[44:47], a[12:15], v[152:155], 0
    s_waitcnt vmcnt(14)
    v_mfma_f32_16x16x32_bf16 v[32:35], a[16:19], v[156:159], v[32:35]
    s_add_u32 s78, s17, 12288
    v_mfma_f32_16x16x32_bf16 v[36:39], a[20:23], v[156:159], v[36:39]
    buffer_load_dwordx4 v[124:127], v2, s[52:55], s78 offen offset:0 sc1
    v_mfma_f32_16x16x32_bf16 v[40:43], a[24:27], v[156:159], v[40:43]
    v_mfma_f32_16x16x32_bf16 v[44:47], a[28:31], v[156:159], v[44:47]
    s_waitcnt vmcnt(11)
    v_mfma_f32_16x16x32_bf16 v[32:35], a[48:51], v[160:163], v[32:35]
    v_mfma_f32_16x16x32_bf16 v[36:39], a[52:55], v[160:163], v[36:39]
    buffer_load_dwordx4 v[128:131], v2, s[52:55], s18 offen offset:0 sc1
    v_mfma_f32_16x16x32_bf16 v[40:43], a[56:59], v[160:163], v[40:43]
    v_mfma_f32_16x16x32_bf16 v[44:47], a[60:63], v[160:163], v[44:47]
    s_waitcnt vmcnt(11)
    v_mfma_f32_16x16x32_bf16 v[32:35], a[64:67], v[164:167], v[32:35]
    v_mfma_f32_16x16x32_bf16 v[36:39], a[68:71], v[164:167], v[36:39]
    buffer_load_dwordx4 v[132:135], v2, s[52:55], s18 offen offset:1024 sc1
    v_mfma_f32_16x16x32_bf16 v[40:43], a[72:75], v[164:167], v[40:43]
    v_mfma_f32_16x16x32_bf16 v[44:47], a[76:79], v[164:167], v[44:47]
    s_waitcnt vmcnt(11)
    v_mfma_f32_16x16x32_bf16 v[32:35], a[80:83], v[168:171], v[32:35]
    v_mfma_f32_16x16x32_bf16 v[36:39], a[84:87], v[168:171], v[36:39]
    buffer_load_dword v136, v109, s[52:55], s18 offen offset:3072 sc1
    buffer_load_dword v137, v109, s[52:55], s18 offen offset:3328 sc1
    buffer_load_dword v138, v109, s[52:55], s18 offen offset:3584 sc1
    buffer_load_dword v139, v109, s[52:55], s18 offen offset:3840 sc1
    v_mfma_f32_16x16x32_bf16 v[40:43], a[88:91], v[168:171], v[40:43]
    v_mfma_f32_16x16x32_bf16 v[44:47], a[92:95], v[168:171], v[44:47]
    s_waitcnt vmcnt(14)
    v_mfma_f32_16x16x32_bf16 v[32:35], a[112:115], v[172:175], v[32:35]
    s_add_u32 s78, s18, 4096
    v_mfma_f32_16x16x32_bf16 v[36:39], a[116:119], v[172:175], v[36:39]
    buffer_load_dwordx4 v[140:143], v2, s[52:55], s78 offen offset:0 sc1
    v_mfma_f32_16x16x32_bf16 v[40:43], a[120:123], v[172:175], v[40:43]
    v_mfma_f32_16x16x32_bf16 v[44:47], a[124:127], v[172:175], v[44:47]
    s_waitcnt vmcnt(13)
    v_mfma_f32_16x16x32_bf16 v[32:35], a[128:131], v[112:115], v[32:35]
    v_mfma_f32_16x16x32_bf16 v[36:39], a[132:135], v[112:115], v[36:39]
    buffer_load_dwordx4 v[144:147], v2, s[52:55], s78 offen offset:1024 sc1
    v_mfma_f32_16x16x32_bf16 v[40:43], a[136:139], v[112:115], v[40:43]
    buffer_load_dword v15, v104, s[52:55], 0 offen offset:128 sc1
    v_mfma_f32_16x16x32_bf16 v[44:47], a[140:143], v[112:115], v[44:47]
    s_waitcnt vmcnt(11)
    v_mfma_f32_16x16x32_bf16 v[32:35], a[160:163], v[116:119], v[32:35]
    v_mfma_f32_16x16x32_bf16 v[36:39], a[164:167], v[116:119], v[36:39]
    buffer_load_dwordx4 v[148:151], v2, s[52:55], s78 offen offset:3072 sc1
    v_mfma_f32_16x16x32_bf16 v[40:43], a[168:171], v[116:119], v[40:43]
    v_mfma_f32_16x16x32_bf16 v[44:47], a[172:175], v[116:119], v[44:47]
    s_waitcnt vmcnt(11)
    v_mfma_f32_16x16x32_bf16 v[32:35], a[176:179], v[120:123], v[32:35]
    s_add_u32 s78, s18, 8192
    v_mfma_f32_16x16x32_bf16 v[36:39], a[180:183], v[120:123], v[36:39]
    buffer_load_dwordx4 v[152:155], v2, s[52:55], s78 offen offset:0 sc1
    v_mfma_f32_16x16x32_bf16 v[40:43], a[184:187], v[120:123], v[40:43]
    v_mfma_f32_16x16x32_bf16 v[44:47], a[188:191], v[120:123], v[44:47]
    s_waitcnt vmcnt(11)
    v_mfma_f32_16x16x32_bf16 v[32:35], a[192:195], v[124:127], v[32:35]
    v_mfma_f32_16x16x32_bf16 v[36:39], a[196:199], v[124:127], v[36:39]
    buffer_load_dword v156, v109, s[52:55], s78 offen offset:2048 sc1
    buffer_load_dword v157, v109, s[52:55], s78 offen offset:2304 sc1
    buffer_load_dword v158, v109, s[52:55], s78 offen offset:2560 sc1
    buffer_load_dword v159, v109, s[52:55], s78 offen offset:2816 sc1
    v_mfma_f32_16x16x32_bf16 v[40:43], a[200:203], v[124:127], v[40:43]
    v_mfma_f32_16x16x32_bf16 v[44:47], a[204:207], v[124:127], v[44:47]
    s_waitcnt vmcnt(14)
    v_mfma_f32_16x16x32_bf16 v[64:67], a[0:3], v[128:131], 0
    v_mfma_f32_16x16x32_bf16 v[68:71], a[4:7], v[128:131], 0
    buffer_load_dwordx4 v[160:163], v2, s[52:55], s78 offen offset:3072 sc1
    v_mfma_f32_16x16x32_bf16 v[72:75], a[8:11], v[128:131], 0
    v_mfma_f32_16x16x32_bf16 v[76:79], a[12:15], v[128:131], 0
    s_waitcnt vmcnt(14)
    v_mfma_f32_16x16x32_bf16 v[64:67], a[16:19], v[132:135], v[64:67]
    s_add_u32 s78, s18, 12288
    v_mfma_f32_16x16x32_bf16 v[68:71], a[20:23], v[132:135], v[68:71]
    buffer_load_dwordx4 v[164:167], v2, s[52:55], s78 offen offset:0 sc1
    v_mfma_f32_16x16x32_bf16 v[72:75], a[24:27], v[132:135], v[72:75]
    v_mfma_f32_16x16x32_bf16 v[76:79], a[28:31], v[132:135], v[76:79]
    s_waitcnt vmcnt(11)
    v_mfma_f32_16x16x32_bf16 v[64:67], a[48:51], v[136:139], v[64:67]
    v_mfma_f32_16x16x32_bf16 v[68:71], a[52:55], v[136:139], v[68:71]
    buffer_load_dwordx4 v[168:171], v2, s[52:55], s19 offen offset:0 sc1
    v_mfma_f32_16x16x32_bf16 v[72:75], a[56:59], v[136:139], v[72:75]
    v_mfma_f32_16x16x32_bf16 v[76:79], a[60:63], v[136:139], v[76:79]
    s_waitcnt vmcnt(11)
    v_mfma_f32_16x16x32_bf16 v[64:67], a[64:67], v[140:143], v[64:67]
    v_mfma_f32_16x16x32_bf16 v[68:71], a[68:71], v[140:143], v[68:71]
    buffer_load_dwordx4 v[172:175], v2, s[52:55], s19 offen offset:1024 sc1
    v_mfma_f32_16x16x32_bf16 v[72:75], a[72:75], v[140:143], v[72:75]
    v_mfma_f32_16x16x32_bf16 v[76:79], a[76:79], v[140:143], v[76:79]
    s_waitcnt vmcnt(10)
    v_subrev_u32 v15, s68, v15
    v_cmp_ne_u32 vcc, 1, v15
    s_nop 0
    s_and_b64 vcc, vcc, s[60:61]
    s_cbranch_scc0 L_hidb_80
    s_mov_b32 s82, 0
L_phb_81:
    buffer_load_dword v15, v104, s[52:55], 0 offen offset:128 sc1
    s_add_u32 s82, s82, 1
    s_waitcnt vmcnt(0)
    v_subrev_u32 v15, s68, v15
    v_cmp_ne_u32 vcc, 1, v15
    s_nop 0
    s_and_b64 vcc, vcc, s[60:61]
    s_cbranch_scc0 L_dhb_82
    s_cmp_lt_u32 s82, 131072
    s_cbranch_scc1 L_phb_81
L_dhb_82:
L_hidb_80:
    v_mfma_f32_16x16x32_bf16 v[64:67], a[80:83], v[144:147], v[64:67]
    v_mfma_f32_16x16x32_bf16 v[68:71], a[84:87], v[144:147], v[68:71]
    buffer_load_dwordx4 v[112:115], v2, s[52:55], s16 offen offset:2048 sc1
    v_mfma_f32_16x16x32_bf16 v[72:75], a[88:91], v[144:147], v[72:75]
    v_mfma_f32_16x16x32_bf16 v[76:79], a[92:95], v[144:147], v[76:79]
    s_waitcnt vmcnt(10)
    v_mfma_f32_16x16x32_bf16 v[64:67], a[112:115], v[148:151], v[64:67]
    s_add_u32 s78, s16, 4096
    v_mfma_f32_16x16x32_bf16 v[68:71], a[116:119], v[148:151], v[68:71]
    buffer_load_dwordx4 v[116:119], v2, s[52:55], s78 offen offset:2048 sc1
    v_mfma_f32_16x16x32_bf16 v[72:75], a[120:123], v[148:151], v[72:75]
    v_mfma_f32_16x16x32_bf16 v[76:79], a[124:127], v[148:151], v[76:79]
    s_waitcnt vmcnt(10)
    v_mfma_f32_16x16x32_bf16 v[64:67], a[128:131], v[152:155], v[64:67]
    s_add_u32 s78, s16, 8192
    v_mfma_f32_16x16x32_bf16 v[68:71], a[132:135], v[152:155], v[68:71]
    buffer_load_dwordx4 v[120:123], v2, s[52:55], s78 offen offset:1024 sc1
    v_mfma_f32_16x16x32_bf16 v[72:75], a[136:139], v[152:155], v[72:75]
    v_mfma_f32_16x16x32_bf16 v[76:79], a[140:143], v[152:155], v[76:79]
    s_waitcnt vmcnt(7)
    v_mfma_f32_16x16x32_bf16 v[64:67], a[160:163], v[156:159], v[64:67]
    s_add_u32 s78, s16, 12288
    v_mfma_f32_16x16x32_bf16 v[68:71], a[164:167], v[156:159], v[68:71]
    buffer_load_dwordx4 v[124:127], v2, s[52:55], s78 offen offset:1024 sc1
    v_mfma_f32_16x16x32_bf16 v[72:75], a[168:171], v[156:159], v[72:75]
    v_mfma_f32_16x16x32_bf16 v[76:79], a[172:175], v[156:159], v[76:79]
    s_waitcnt vmcnt(7)
    v_mfma_f32_16x16x32_bf16 v[64:67], a[176:179], v[160:163], v[64:67]
    v_mfma_f32_16x16x32_bf16 v[68:71], a[180:183], v[160:163], v[68:71]
    buffer_load_dwordx4 v[128:131], v2, s[52:55], s17 offen offset:2048 sc1
    v_mfma_f32_16x16x32_bf16 v[72:75], a[184:187], v[160:163], v[72:75]
    v_mfma_f32_16x16x32_bf16 v[76:79], a[188:191], v[160:163], v[76:79]
    s_waitcnt vmcnt(7)
    v_mfma_f32_16x16x32_bf16 v[64:67], a[192:195], v[164:167], v[64:67]
    s_add_u32 s78, s17, 4096
    v_mfma_f32_16x16x32_bf16 v[68:71], a[196:199], v[164:167], v[68:71]
    buffer_load_dwordx4 v[132:135], v2, s[52:55], s78 offen offset:2048 sc1
    v_mfma_f32_16x16x32_bf16 v[72:75], a[200:203], v[164:167], v[72:75]
    v_mfma_f32_16x16x32_bf16 v[76:79], a[204:207], v[164:167], v[76:79]
    s_waitcnt vmcnt(7)
    v_mfma_f32_16x16x32_bf16 v[48:51], a[0:3], v[168:171], 0
    s_add_u32 s78, s17, 8192
    v_mfma_f32_16x16x32_bf16 v[52:55], a[4:7], v[168:171], 0
    buffer_load_dwordx4 v[136:139], v2, s[52:55], s78 offen offset:1024 sc1
    v_mfma_f32_16x16x32_bf16 v[56:59], a[8:11], v[168:171], 0
    v_mfma_f32_16x16x32_bf16 v[60:63], a[12:15], v[168:171], 0
    s_waitcnt vmcnt(7)
    v_mfma_f32_16x16x32_bf16 v[48:51], a[16:19], v[172:175], v[48:51]
    s_add_u32 s78, s17, 12288
    v_mfma_f32_16x16x32_bf16 v[52:55], a[20:23], v[172:175], v[52:55]
    buffer_load_dwordx4 v[140:143], v2, s[52:55], s78 offen offset:1024 sc1
    v_mfma_f32_16x16x32_bf16 v[56:59], a[24:27], v[172:175], v[56:59]
    v_mfma_f32_16x16x32_bf16 v[60:63], a[28:31], v[172:175], v[60:63]
    s_barrier
    s_waitcnt vmcnt(7)
    v_mfma_f32_16x16x32_bf16 v[16:19], a[32:35], v[112:115], v[16:19]
    v_mfma_f32_16x16x32_bf16 v[20:23], a[36:39], v[112:115], v[20:23]
    buffer_load_dwordx4 v[144:147], v2, s[52:55], s18 offen offset:2048 sc1
    v_mfma_f32_16x16x32_bf16 v[24:27], a[40:43], v[112:115], v[24:27]
    v_mfma_f32_16x16x32_bf16 v[28:31], a[44:47], v[112:115], v[28:31]
    s_waitcnt vmcnt(7)
    v_mfma_f32_16x16x32_bf16 v[16:19], a[96:99], v[116:119], v[16:19]
    s_add_u32 s78, s18, 4096
    v_mfma_f32_16x16x32_bf16 v[20:23], a[100:103], v[116:119], v[20:23]
    buffer_load_dwordx4 v[148:151], v2, s[52:55], s78 offen offset:2048 sc1
    v_mfma_f32_16x16x32_bf16 v[24:27], a[104:107], v[116:119], v[24:27]
    v_mfma_f32_16x16x32_bf16 v[28:31], a[108:111], v[116:119], v[28:31]
    s_waitcnt vmcnt(7)
    v_mfma_f32_16x16x32_bf16 v[16:19], a[144:147], v[120:123], v[16:19]
    s_add_u32 s78, s18, 8192
    v_mfma_f32_16x16x32_bf16 v[20:23], a[148:151], v[120:123], v[20:23]
    buffer_load_dwordx4 v[152:155], v2, s[52:55], s78 offen offset:1024 sc1
    v_mfma_f32_16x16x32_bf16 v[24:27], a[152:155], v[120:123], v[24:27]
    v_mfma_f32_16x16x32_bf16 v[28:31], a[156:159], v[120:123], v[28:31]
    s_waitcnt vmcnt(7)
    v_mfma_f32_16x16x32_bf16 v[16:19], a[208:211], v[124:127], v[16:19]
    s_add_u32 s78, s18, 12288
    v_mfma_f32_16x16x32_bf16 v[20:23], a[212:215], v[124:127], v[20:23]
    buffer_load_dwordx4 v[156:159], v2, s[52:55], s78 offen offset:1024 sc1
    v_mfma_f32_16x16x32_bf16 v[24:27], a[216:219], v[124:127], v[24:27]
    v_mfma_f32_16x16x32_bf16 v[28:31], a[220:223], v[124:127], v[28:31]
    s_waitcnt vmcnt(7)
    v_mfma_f32_16x16x32_bf16 v[32:35], a[32:35], v[128:131], v[32:35]
    v_mfma_f32_16x16x32_bf16 v[36:39], a[36:39], v[128:131], v[36:39]
    buffer_load_dword v160, v109, s[52:55], s19 offen offset:3072 sc1
    buffer_load_dword v161, v109, s[52:55], s19 offen offset:3328 sc1
    buffer_load_dword v162, v109, s[52:55], s19 offen offset:3584 sc1
    buffer_load_dword v163, v109, s[52:55], s19 offen offset:3840 sc1
    v_mfma_f32_16x16x32_bf16 v[40:43], a[40:43], v[128:131], v[40:43]
    v_mfma_f32_16x16x32_bf16 v[44:47], a[44:47], v[128:131], v[44:47]
    ds_write_b128 v6, v[16:19] offset:0
    s_waitcnt vmcnt(10)
    v_mfma_f32_16x16x32_bf16 v[32:35], a[96:99], v[132:135], v[32:35]
    s_add_u32 s78, s19, 4096
    v_mfma_f32_16x16x32_bf16 v[36:39], a[100:103], v[132:135], v[36:39]
    buffer_load_dwordx4 v[164:167], v2, s[52:55], s78 offen offset:0 sc1
    v_mfma_f32_16x16x32_bf16 v[40:43], a[104:107], v[132:135], v[40:43]
    v_mfma_f32_16x16x32_bf16 v[44:47], a[108:111], v[132:135], v[44:47]
    ds_write_b128 v6, v[20:23] offset:1024
    s_waitcnt vmcnt(10)
    v_mfma_f32_16x16x32_bf16 v[32:35], a[144:147], v[136:139], v[32:35]
    v_mfma_f32_16x16x32_bf16 v[36:39], a[148:151], v[136:139], v[36:39]
    buffer_load_dwordx4 v[168:171], v2, s[52:55], s78 offen offset:1024 sc1
    v_mfma_f32_16x16x32_bf16 v[40:43], a[152:155], v[136:139], v[40:43]
    v_mfma_f32_16x16x32_bf16 v[44:47], a[156:159], v[136:139], v[44:47]
    ds_write_b128 v6, v[24:27] offset:2048
    s_waitcnt vmcnt(10)
    v_mfma_f32_16x16x32_bf16 v[32:35], a[208:211], v[140:143], v[32:35]
    v_mfma_f32_16x16x32_bf16 v[36:39], a[212:215], v[140:143], v[36:39]
    buffer_load_dwordx4 v[172:175], v2, s[52:55], s78 offen offset:3072 sc1
    v_mfma_f32_16x16x32_bf16 v[40:43], a[216:219], v[140:143], v[40:43]
    v_mfma_f32_16x16x32_bf16 v[44:47], a[220:223], v[140:143], v[44:47]
    ds_write_b128 v6, v[28:31] offset:3072
    s_waitcnt vmcnt(10)
    v_mfma_f32_16x16x32_bf16 v[64:67], a[32:35], v[144:147], v[64:67]
    s_add_u32 s78, s19, 8192
    v_mfma_f32_16x16x32_bf16 v[68:71], a[36:39], v[144:147], v[68:71]
    buffer_load_dwordx4 v[112:115], v2, s[52:55], s78 offen offset:0 sc1
    v_mfma_f32_16x16x32_bf16 v[72:75], a[40:43], v[144:147], v[72:75]
    v_mfma_f32_16x16x32_bf16 v[76:79], a[44:47], v[144:147], v[76:79]
    ds_write_b128 v7, v[32:35] offset:0
    s_waitcnt vmcnt(10)
    v_mfma_f32_16x16x32_bf16 v[64:67], a[96:99], v[148:151], v[64:67]
    v_mfma_f32_16x16x32_bf16 v[68:71], a[100:103], v[148:151], v[68:71]
    buffer_load_dword v116, v109, s[52:55], s78 offen offset:2048 sc1
    buffer_load_dword v117, v109, s[52:55], s78 offen offset:2304 sc1
    buffer_load_dword v118, v109, s[52:55], s78 offen offset:2560 sc1
    buffer_load_dword v119, v109, s[52:55], s78 offen offset:2816 sc1
    v_mfma_f32_16x16x32_bf16 v[72:75], a[104:107], v[148:151], v[72:75]
    v_mfma_f32_16x16x32_bf16 v[76:79], a[108:111], v[148:151], v[76:79]
    ds_write_b128 v7, v[36:39] offset:1024
    s_waitcnt vmcnt(13)
    v_mfma_f32_16x16x32_bf16 v[64:67], a[144:147], v[152:155], v[64:67]
    v_mfma_f32_16x16x32_bf16 v[68:71], a[148:151], v[152:155], v[68:71]
    buffer_load_dwordx4 v[120:123], v2, s[52:55], s78 offen offset:3072 sc1
    v_mfma_f32_16x16x32_bf16 v[72:75], a[152:155], v[152:155], v[72:75]
    v_mfma_f32_16x16x32_bf16 v[76:79], a[156:159], v[152:155], v[76:79]
    ds_write_b128 v7, v[40:43] offset:2048
    s_waitcnt vmcnt(13)
    v_mfma_f32_16x16x32_bf16 v[64:67], a[208:211], v[156:159], v[64:67]
    s_add_u32 s78, s19, 12288
    v_mfma_f32_16x16x32_bf16 v[68:71], a[212:215], v[156:159], v[68:71]
    buffer_load_dwordx4 v[124:127], v2, s[52:55], s78 offen offset:0 sc1
    v_mfma_f32_16x16x32_bf16 v[72:75], a[216:219], v[156:159], v[72:75]
    v_mfma_f32_16x16x32_bf16 v[76:79], a[220:223], v[156:159], v[76:79]
    ds_write_b128 v7, v[44:47] offset:3072
    s_waitcnt vmcnt(10)
    v_mfma_f32_16x16x32_bf16 v[48:51], a[48:51], v[160:163], v[48:51]
    v_mfma_f32_16x16x32_bf16 v[52:55], a[52:55], v[160:163], v[52:55]
    buffer_load_dwordx4 v[128:131], v2, s[52:55], s19 offen offset:2048 sc1
    v_mfma_f32_16x16x32_bf16 v[56:59], a[56:59], v[160:163], v[56:59]
    v_mfma_f32_16x16x32_bf16 v[60:63], a[60:63], v[160:163], v[60:63]
    ds_write_b128 v8, v[64:67] offset:0
    s_waitcnt vmcnt(10)
    v_mfma_f32_16x16x32_bf16 v[48:51], a[64:67], v[164:167], v[48:51]
    s_add_u32 s78, s19, 4096
    v_mfma_f32_16x16x32_bf16 v[52:55], a[68:71], v[164:167], v[52:55]
    buffer_load_dwordx4 v[132:135], v2, s[52:55], s78 offen offset:2048 sc1
    v_mfma_f32_16x16x32_bf16 v[56:59], a[72:75], v[164:167], v[56:59]
    v_mfma_f32_16x16x32_bf16 v[60:63], a[76:79], v[164:167], v[60:63]
    ds_write_b128 v8, v[68:71] offset:1024
    s_waitcnt vmcnt(10)
    v_mfma_f32_16x16x32_bf16 v[48:51], a[80:83], v[168:171], v[48:51]
    s_add_u32 s78, s19, 8192
    v_mfma_f32_16x16x32_bf16 v[52:55], a[84:87], v[168:171], v[52:55]
    buffer_load_dwordx4 v[136:139], v2, s[52:55], s78 offen offset:1024 sc1
    v_mfma_f32_16x16x32_bf16 v[56:59], a[88:91], v[168:171], v[56:59]
    v_mfma_f32_16x16x32_bf16 v[60:63], a[92:95], v[168:171], v[60:63]
    ds_write_b128 v8, v[72:75] offset:2048
    s_waitcnt vmcnt(10)
    v_mfma_f32_16x16x32_bf16 v[48:51], a[112:115], v[172:175], v[48:51]
    s_add_u32 s78, s19, 12288
    v_mfma_f32_16x16x32_bf16 v[52:55], a[116:119], v[172:175], v[52:55]
    buffer_load_dwordx4 v[140:143], v2, s[52:55], s78 offen offset:1024 sc1
    v_mfma_f32_16x16x32_bf16 v[56:59], a[120:123], v[172:175], v[56:59]
    v_mfma_f32_16x16x32_bf16 v[60:63], a[124:127], v[172:175], v[60:63]
    ds_write_b128 v8, v[76:79] offset:3072
    s_waitcnt vmcnt(10)
    v_mfma_f32_16x16x32_bf16 v[48:51], a[128:131], v[112:115], v[48:51]
    v_mfma_f32_16x16x32_bf16 v[52:55], a[132:135], v[112:115], v[52:55]
    v_mfma_f32_16x16x32_bf16 v[56:59], a[136:139], v[112:115], v[56:59]
    v_mfma_f32_16x16x32_bf16 v[60:63], a[140:143], v[112:115], v[60:63]
    s_waitcnt vmcnt(6) lgkmcnt(0)
    s_barrier
    v_mfma_f32_16x16x32_bf16 v[48:51], a[160:163], v[116:119], v[48:51]
    ds_read_b128 v[16:19], v9 offset:0
    v_mfma_f32_16x16x32_bf16 v[52:55], a[164:167], v[116:119], v[52:55]
    ds_read_b128 v[20:23], v9 offset:1024
    v_mfma_f32_16x16x32_bf16 v[56:59], a[168:171], v[116:119], v[56:59]
    ds_read_b128 v[24:27], v9 offset:2048
    v_mfma_f32_16x16x32_bf16 v[60:63], a[172:175], v[116:119], v[60:63]
    ds_read_b128 v[28:31], v9 offset:3072
    s_waitcnt vmcnt(5)
    v_mfma_f32_16x16x32_bf16 v[48:51], a[176:179], v[120:123], v[48:51]
    ds_read_b128 v[32:35], v9 offset:4096
    v_mfma_f32_16x16x32_bf16 v[52:55], a[180:183], v[120:123], v[52:55]
    ds_read_b128 v[36:39], v9 offset:5120
    v_mfma_f32_16x16x32_bf16 v[56:59], a[184:187], v[120:123], v[56:59]
    ds_read_b128 v[40:43], v9 offset:6144
    v_mfma_f32_16x16x32_bf16 v[60:63], a[188:191], v[120:123], v[60:63]
    ds_read_b128 v[44:47], v9 offset:7168
    s_waitcnt vmcnt(4)
    v_mfma_f32_16x16x32_bf16 v[48:51], a[192:195], v[124:127], v[48:51]
    ds_read_b128 v[64:67], v11 offset:0
    v_mfma_f32_16x16x32_bf16 v[52:55], a[196:199], v[124:127], v[52:55]
    ds_read_b128 v[68:71], v11 offset:1024
    v_mfma_f32_16x16x32_bf16 v[56:59], a[200:203], v[124:127], v[56:59]
    ds_read_b128 v[72:75], v11 offset:2048
    v_mfma_f32_16x16x32_bf16 v[60:63], a[204:207], v[124:127], v[60:63]
    ds_read_b128 v[76:79], v11 offset:3072
    s_waitcnt vmcnt(3) lgkmcnt(4)
    v_mfma_f32_16x16x32_bf16 v[48:51], a[32:35], v[128:131], v[48:51]
    v_add_f32 v16, v16, v32
    v_add_f32 v17, v17, v33
    v_mfma_f32_16x16x32_bf16 v[52:55], a[36:39], v[128:131], v[52:55]
    v_add_f32 v18, v18, v34
    v_add_f32 v19, v19, v35
    v_mfma_f32_16x16x32_bf16 v[56:59], a[40:43], v[128:131], v[56:59]
    v_add_f32 v20, v20, v36
    v_add_f32 v21, v21, v37
    v_mfma_f32_16x16x32_bf16 v[60:63], a[44:47], v[128:131], v[60:63]
    v_add_f32 v22, v22, v38
    v_add_f32 v23, v23, v39
    s_waitcnt vmcnt(2)
    v_mfma_f32_16x16x32_bf16 v[48:51], a[96:99], v[132:135], v[48:51]
    v_add_f32 v24, v24, v40
    v_add_f32 v25, v25, v41
    v_mfma_f32_16x16x32_bf16 v[52:55], a[100:103], v[132:135], v[52:55]
    v_add_f32 v26, v26, v42
    v_add_f32 v27, v27, v43
    v_mfma_f32_16x16x32_bf16 v[56:59], a[104:107], v[132:135], v[56:59]
    v_add_f32 v28, v28, v44
    v_add_f32 v29, v29, v45
    v_mfma_f32_16x16x32_bf16 v[60:63], a[108:111], v[132:135], v[60:63]
    v_add_f32 v30, v30, v46
    v_add_f32 v31, v31, v47
    s_waitcnt vmcnt(1) lgkmcnt(0)
    v_mfma_f32_16x16x32_bf16 v[48:51], a[144:147], v[136:139], v[48:51]
    v_add_f32 v16, v16, v64
    v_add_f32 v17, v17, v65
    v_mfma_f32_16x16x32_bf16 v[52:55], a[148:151], v[136:139], v[52:55]
    v_add_f32 v18, v18, v66
    v_add_f32 v19, v19, v67
    v_mfma_f32_16x16x32_bf16 v[56:59], a[152:155], v[136:139], v[56:59]
    v_add_f32 v20, v20, v68
    v_add_f32 v21, v21, v69
    v_mfma_f32_16x16x32_bf16 v[60:63], a[156:159], v[136:139], v[60:63]
    v_add_f32 v22, v22, v70
    v_add_f32 v23, v23, v71
    s_waitcnt vmcnt(0)
    v_mfma_f32_16x16x32_bf16 v[48:51], a[208:211], v[140:143], v[48:51]
    v_add_f32 v24, v24, v72
    v_add_f32 v25, v25, v73
    v_mfma_f32_16x16x32_bf16 v[52:55], a[212:215], v[140:143], v[52:55]
    v_add_f32 v26, v26, v74
    v_add_f32 v27, v27, v75
    v_mfma_f32_16x16x32_bf16 v[56:59], a[216:219], v[140:143], v[56:59]
    v_add_f32 v28, v28, v76
    v_add_f32 v29, v29, v77
    v_mfma_f32_16x16x32_bf16 v[60:63], a[220:223], v[140:143], v[60:63]
    v_add_f32 v30, v30, v78
    v_add_f32 v31, v31, v79
    v_fmac_f32 v240, v16, v80
    v_fmac_f32 v241, v17, v81
    v_fmac_f32 v242, v18, v82
    v_fmac_f32 v243, v19, v83
    v_fmac_f32 v244, v20, v84
    v_fmac_f32 v245, v21, v85
    v_fmac_f32 v246, v22, v86
    v_fmac_f32 v247, v23, v87
    v_fmac_f32 v248, v24, v88
    v_fmac_f32 v249, v25, v89
    v_fmac_f32 v250, v26, v90
    v_fmac_f32 v251, v27, v91
    v_fmac_f32 v252, v28, v92
    v_fmac_f32 v253, v29, v93
    v_fmac_f32 v254, v30, v94
    v_fmac_f32 v255, v31, v95
    v_pk_fma_f32 v[240:241], v[48:49], v[80:81], v[240:241]
    v_pk_fma_f32 v[242:243], v[50:51], v[82:83], v[242:243]
    v_pk_fma_f32 v[244:245], v[52:53], v[84:85], v[244:245]
    v_pk_fma_f32 v[246:247], v[54:55], v[86:87], v[246:247]
    v_cvt_pk_bf16_f32 v16, v240, v241
    v_cvt_pk_bf16_f32 v17, v242, v243
    v_cvt_pk_bf16_f32 v18, v244, v245
    v_cvt_pk_bf16_f32 v19, v246, v247
    ds_write_b128 v13, v[16:19]
    v_pk_fma_f32 v[248:249], v[56:57], v[88:89], v[248:249]
    v_pk_fma_f32 v[250:251], v[58:59], v[90:91], v[250:251]
    v_pk_fma_f32 v[252:253], v[60:61], v[92:93], v[252:253]
    v_pk_fma_f32 v[254:255], v[62:63], v[94:95], v[254:255]
    v_cvt_pk_bf16_f32 v20, v248, v249
    v_cvt_pk_bf16_f32 v21, v250, v251
    v_cvt_pk_bf16_f32 v22, v252, v253
    v_cvt_pk_bf16_f32 v23, v254, v255
    ds_write_b128 v14, v[20:23]
    ds_read_b128 v[24:27], v9 offset:4096
    ds_read_b128 v[28:31], v9 offset:5120
    s_waitcnt lgkmcnt(1)
    buffer_store_dwordx4 v[24:27], v4, s[56:59], 0 offen sc1
    s_waitcnt lgkmcnt(0)
    buffer_store_dwordx4 v[28:31], v4, s[56:59], s77 offen sc1
    s_or_b32 s76, s75, s5
    s_cbranch_scc1 L_noep_83
    s_mov_b32 s78, 0
    s_mov_b64 exec, 1
    buffer_store_dword v3, off, s[52:55], s78
    s_mov_b64 exec, -1
L_noep_83:
    s_endpgm
L_fpretry_62:
    s_cselect_b32 s66, 1, 0
    s_mov_b32 s82, 0
L_pfp_84:
    buffer_load_dword v15, v126, s[52:55], 0 offen offset:0 sc1
    s_add_u32 s82, s82, 1
    s_waitcnt vmcnt(0)
    v_cmp_ne_u32 vcc, s68, v15
    s_nop 0
    s_and_b64 vcc, vcc, -1
    s_cbranch_scc0 L_dfp_85
    s_cmp_lt_u32 s82, 131072
    s_cbranch_scc1 L_pfp_84
L_dfp_85:
    s_cmp_lg_u32 s66, 0
    s_branch L_fpback_63
L_fb_66:
    s_min_u32 s79, s6, 8
    s_mov_b32 s92, 0x00110011
    s_mov_b32 s93, 0x00110011
    v_mov_b32 v10, 0x3f803f80
    v_cndmask_b32 v136, 0, v10, s[92:93]
    v_mov_b32 v137, v136
    v_mov_b32 v138, v136
    v_mov_b32 v139, v136
    v_mov_b32 v140, v136
    v_mov_b32 v141, v136
    v_mov_b32 v142, v136
    v_mov_b32 v143, v136
    v_mov_b32 v144, v136
    v_mov_b32 v145, v136
    v_mov_b32 v146, v136
    v_mov_b32 v147, v136
    v_mov_b32 v148, v136
    v_mov_b32 v149, v136
    v_mov_b32 v150, v136
    v_mov_b32 v151, v136
    s_mov_b32 s80, 0
    v_add_u32 v10, 32768, v119
    v_mov_b32 v11, 0xff800000
L_fl_86:
    ds_read_b128 v[128:131], v10 offset:0
    s_waitcnt lgkmcnt(0)
    v_mfma_f32_32x32x16_bf16 v[160:175], v[128:131], v[48:51], 0
    s_nop 15
    s_cmp_lg_u32 s80, 0
    s_cbranch_scc1 L_fnd_87
    v_add_f32 v160, v160, v16
    v_add_f32 v161, v161, v17
    v_add_f32 v162, v162, v18
    v_add_f32 v163, v163, v19
    v_add_f32 v164, v164, v20
    v_add_f32 v165, v165, v21
    v_add_f32 v166, v166, v22
    v_add_f32 v167, v167, v23
    v_add_f32 v168, v168, v24
    v_add_f32 v169, v169, v25
    v_add_f32 v170, v170, v26
    v_add_f32 v171, v171, v27
    v_add_f32 v172, v172, v28
    v_add_f32 v173, v173, v29
    v_add_f32 v174, v174, v30
    v_add_f32 v175, v175, v31
L_fnd_87:
    s_cmp_lg_u32 s80, 8
    s_cbranch_scc1 L_fnf_88
    v_add_f32 v160, v160, v32
    v_add_f32 v161, v161, v33
    v_add_f32 v162, v162, v34
    v_add_f32 v163, v163, v35
    v_add_f32 v164, v164, v36
    v_add_f32 v165, v165, v37
    v_add_f32 v166, v166, v38
    v_add_f32 v167, v167, v39
    v_add_f32 v168, v168, v40
    v_add_f32 v169, v169, v41
    v_add_f32 v170, v170, v42
    v_add_f32 v171, v171, v43
    v_add_f32 v172, v172, v44
    v_add_f32 v173, v173, v45
    v_add_f32 v174, v174, v46
    v_add_f32 v175, v175, v47
L_fnf_88:
    v_max3_f32 v11, v11, v160, v161
    v_max3_f32 v11, v11, v162, v163
    v_max3_f32 v11, v11, v164, v165
    v_max3_f32 v11, v11, v166, v167
    v_max3_f32 v11, v11, v168, v169
    v_max3_f32 v11, v11, v170, v171
    v_max3_f32 v11, v11, v172, v173
    v_max3_f32 v11, v11, v174, v175
    v_subrev_u32 v10, 4096, v10
    s_add_u32 s80, s80, 1
    s_cmp_le_u32 s80, s79
    s_cbranch_scc1 L_fl_86
    v_mov_b32 v12, v11
    s_nop 1
    v_permlane32_swap_b32 v11, v12
    v_max_f32 v11, v11, v12
    s_mov_b32 s80, 0
    v_add_u32 v10, 32768, v119
    v_mov_b32 v208, 0
    v_mov_b32 v209, 0
    v_mov_b32 v210, 0
    v_mov_b32 v211, 0
    v_mov_b32 v212, 0
    v_mov_b32 v213, 0
    v_mov_b32 v214, 0
    v_mov_b32 v215, 0
    v_mov_b32 v216, 0
    v_mov_b32 v217, 0
    v_mov_b32 v218, 0
    v_mov_b32 v219, 0
    v_mov_b32 v220, 0
    v_mov_b32 v221, 0
    v_mov_b32 v222, 0
    v_mov_b32 v223, 0
L_fl_89:
    ds_read_b128 v[128:131], v10 offset:0
    s_mov_b64 exec, s[86:87]
    ds_read_b128 v[136:139], v10 offset:2048
    ds_read_b128 v[140:143], v10 offset:3072
    s_mov_b64 exec, -1
    s_waitcnt lgkmcnt(0)
    v_mfma_f32_32x32x16_bf16 v[160:175], v[128:131], v[48:51], 0
    s_nop 15
    s_cmp_lg_u32 s80, 0
    s_cbranch_scc1 L_fnd_90
    v_add_f32 v160, v160, v16
    v_add_f32 v161, v161, v17
    v_add_f32 v162, v162, v18
    v_add_f32 v163, v163, v19
    v_add_f32 v164, v164, v20
    v_add_f32 v165, v165, v21
    v_add_f32 v166, v166, v22
    v_add_f32 v167, v167, v23
    v_add_f32 v168, v168, v24
    v_add_f32 v169, v169, v25
    v_add_f32 v170, v170, v26
    v_add_f32 v171, v171, v27
    v_add_f32 v172, v172, v28
    v_add_f32 v173, v173, v29
    v_add_f32 v174, v174, v30
    v_add_f32 v175, v175, v31
L_fnd_90:
    s_cmp_lg_u32 s80, 8
    s_cbranch_scc1 L_fnf_91
    v_add_f32 v160, v160, v32
    v_add_f32 v161, v161, v33
    v_add_f32 v162, v162, v34
    v_add_f32 v163, v163, v35
    v_add_f32 v164, v164, v36
    v_add_f32 v165, v165, v37
    v_add_f32 v166, v166, v38
    v_add_f32 v167, v167, v39
    v_add_f32 v168, v168, v40
    v_add_f32 v169, v169, v41
    v_add_f32 v170, v170, v42
    v_add_f32 v171, v171, v43
    v_add_f32 v172, v172, v44
    v_add_f32 v173, v173, v45
    v_add_f32 v174, v174, v46
    v_add_f32 v175, v175, v47
L_fnf_91:
    v_sub_f32 v160, v160, v11
    v_sub_f32 v161, v161, v11
    v_sub_f32 v162, v162, v11
    v_sub_f32 v163, v163, v11
    v_sub_f32 v164, v164, v11
    v_sub_f32 v165, v165, v11
    v_sub_f32 v166, v166, v11
    v_sub_f32 v167, v167, v11
    v_sub_f32 v168, v168, v11
    v_sub_f32 v169, v169, v11
    v_sub_f32 v170, v170, v11
    v_sub_f32 v171, v171, v11
    v_sub_f32 v172, v172, v11
    v_sub_f32 v173, v173, v11
    v_sub_f32 v174, v174, v11
    v_sub_f32 v175, v175, v11
    v_exp_f32 v160, v160
    v_exp_f32 v161, v161
    v_exp_f32 v162, v162
    v_exp_f32 v163, v163
    v_exp_f32 v164, v164
    v_exp_f32 v165, v165
    v_exp_f32 v166, v166
    v_exp_f32 v167, v167
    v_exp_f32 v168, v168
    v_exp_f32 v169, v169
    v_exp_f32 v170, v170
    v_exp_f32 v171, v171
    v_exp_f32 v172, v172
    v_exp_f32 v173, v173
    v_exp_f32 v174, v174
    v_exp_f32 v175, v175
    v_cvt_pk_bf16_f32 v192, v160, v161
    v_cvt_pk_bf16_f32 v193, v162, v163
    v_cvt_pk_bf16_f32 v194, v164, v165
    v_cvt_pk_bf16_f32 v195, v166, v167
    v_cvt_pk_bf16_f32 v196, v168, v169
    v_cvt_pk_bf16_f32 v197, v170, v171
    v_cvt_pk_bf16_f32 v198, v172, v173
    v_cvt_pk_bf16_f32 v199, v174, v175
    v_mfma_f32_32x32x16_bf16 v[208:223], v[136:139], v[192:195], v[208:223]
    s_nop 0
    v_mfma_f32_32x32x16_bf16 v[208:223], v[140:143], v[196:199], v[208:223]
    s_nop 15
    v_subrev_u32 v10, 4096, v10
    s_add_u32 s80, s80, 1
    s_cmp_le_u32 s80, s79
    s_cbranch_scc1 L_fl_89
    s_mov_b32 s80, 0
    v_add_u32 v10, 32768, v119
    v_mov_b32 v11, 0xff800000
L_fl_92:
    ds_read_b128 v[128:131], v10 offset:1024
    s_waitcnt lgkmcnt(0)
    v_mfma_f32_32x32x16_bf16 v[160:175], v[128:131], v[52:55], 0
    s_nop 15
    s_cmp_lg_u32 s80, 0
    s_cbranch_scc1 L_fnd_93
    v_add_f32 v160, v160, v16
    v_add_f32 v161, v161, v17
    v_add_f32 v162, v162, v18
    v_add_f32 v163, v163, v19
    v_add_f32 v164, v164, v20
    v_add_f32 v165, v165, v21
    v_add_f32 v166, v166, v22
    v_add_f32 v167, v167, v23
    v_add_f32 v168, v168, v24
    v_add_f32 v169, v169, v25
    v_add_f32 v170, v170, v26
    v_add_f32 v171, v171, v27
    v_add_f32 v172, v172, v28
    v_add_f32 v173, v173, v29
    v_add_f32 v174, v174, v30
    v_add_f32 v175, v175, v31
L_fnd_93:
    s_cmp_lg_u32 s80, 8
    s_cbranch_scc1 L_fnf_94
    v_add_f32 v160, v160, v32
    v_add_f32 v161, v161, v33
    v_add_f32 v162, v162, v34
    v_add_f32 v163, v163, v35
    v_add_f32 v164, v164, v36
    v_add_f32 v165, v165, v37
    v_add_f32 v166, v166, v38
    v_add_f32 v167, v167, v39
    v_add_f32 v168, v168, v40
    v_add_f32 v169, v169, v41
    v_add_f32 v170, v170, v42
    v_add_f32 v171, v171, v43
    v_add_f32 v172, v172, v44
    v_add_f32 v173, v173, v45
    v_add_f32 v174, v174, v46
    v_add_f32 v175, v175, v47
L_fnf_94:
    v_max3_f32 v11, v11, v160, v161
    v_max3_f32 v11, v11, v162, v163
    v_max3_f32 v11, v11, v164, v165
    v_max3_f32 v11, v11, v166, v167
    v_max3_f32 v11, v11, v168, v169
    v_max3_f32 v11, v11, v170, v171
    v_max3_f32 v11, v11, v172, v173
    v_max3_f32 v11, v11, v174, v175
    v_subrev_u32 v10, 4096, v10
    s_add_u32 s80, s80, 1
    s_cmp_le_u32 s80, s79
    s_cbranch_scc1 L_fl_92
    v_mov_b32 v12, v11
    s_nop 1
    v_permlane32_swap_b32 v11, v12
    v_max_f32 v11, v11, v12
    s_mov_b32 s80, 0
    v_add_u32 v10, 32768, v119
    v_mov_b32 v224, 0
    v_mov_b32 v225, 0
    v_mov_b32 v226, 0
    v_mov_b32 v227, 0
    v_mov_b32 v228, 0
    v_mov_b32 v229, 0
    v_mov_b32 v230, 0
    v_mov_b32 v231, 0
    v_mov_b32 v232, 0
    v_mov_b32 v233, 0
    v_mov_b32 v234, 0
    v_mov_b32 v235, 0
    v_mov_b32 v236, 0
    v_mov_b32 v237, 0
    v_mov_b32 v238, 0
    v_mov_b32 v239, 0
L_fl_95:
    ds_read_b128 v[128:131], v10 offset:1024
    s_mov_b64 exec, s[88:89]
    ds_read_b128 v[144:147], v10 offset:2048
    ds_read_b128 v[148:151], v10 offset:3072
    s_mov_b64 exec, -1
    s_waitcnt lgkmcnt(0)
    v_mfma_f32_32x32x16_bf16 v[160:175], v[128:131], v[52:55], 0
    s_nop 15
    s_cmp_lg_u32 s80, 0
    s_cbranch_scc1 L_fnd_96
    v_add_f32 v160, v160, v16
    v_add_f32 v161, v161, v17
    v_add_f32 v162, v162, v18
    v_add_f32 v163, v163, v19
    v_add_f32 v164, v164, v20
    v_add_f32 v165, v165, v21
    v_add_f32 v166, v166, v22
    v_add_f32 v167, v167, v23
    v_add_f32 v168, v168, v24
    v_add_f32 v169, v169, v25
    v_add_f32 v170, v170, v26
    v_add_f32 v171, v171, v27
    v_add_f32 v172, v172, v28
    v_add_f32 v173, v173, v29
    v_add_f32 v174, v174, v30
    v_add_f32 v175, v175, v31
L_fnd_96:
    s_cmp_lg_u32 s80, 8
    s_cbranch_scc1 L_fnf_97
    v_add_f32 v160, v160, v32
    v_add_f32 v161, v161, v33
    v_add_f32 v162, v162, v34
    v_add_f32 v163, v163, v35
    v_add_f32 v164, v164, v36
    v_add_f32 v165, v165, v37
    v_add_f32 v166, v166, v38
    v_add_f32 v167, v167, v39
    v_add_f32 v168, v168, v40
    v_add_f32 v169, v169, v41
    v_add_f32 v170, v170, v42
    v_add_f32 v171, v171, v43
    v_add_f32 v172, v172, v44
    v_add_f32 v173, v173, v45
    v_add_f32 v174, v174, v46
    v_add_f32 v175, v175, v47
L_fnf_97:
    v_sub_f32 v160, v160, v11
    v_sub_f32 v161, v161, v11
    v_sub_f32 v162, v162, v11
    v_sub_f32 v163, v163, v11
    v_sub_f32 v164, v164, v11
    v_sub_f32 v165, v165, v11
    v_sub_f32 v166, v166, v11
    v_sub_f32 v167, v167, v11
    v_sub_f32 v168, v168, v11
    v_sub_f32 v169, v169, v11
    v_sub_f32 v170, v170, v11
    v_sub_f32 v171, v171, v11
    v_sub_f32 v172, v172, v11
    v_sub_f32 v173, v173, v11
    v_sub_f32 v174, v174, v11
    v_sub_f32 v175, v175, v11
    v_exp_f32 v160, v160
    v_exp_f32 v161, v161
    v_exp_f32 v162, v162
    v_exp_f32 v163, v163
    v_exp_f32 v164, v164
    v_exp_f32 v165, v165
    v_exp_f32 v166, v166
    v_exp_f32 v167, v167
    v_exp_f32 v168, v168
    v_exp_f32 v169, v169
    v_exp_f32 v170, v170
    v_exp_f32 v171, v171
    v_exp_f32 v172, v172
    v_exp_f32 v173, v173
    v_exp_f32 v174, v174
    v_exp_f32 v175, v175
    v_cvt_pk_bf16_f32 v192, v160, v161
    v_cvt_pk_bf16_f32 v193, v162, v163
    v_cvt_pk_bf16_f32 v194, v164, v165
    v_cvt_pk_bf16_f32 v195, v166, v167
    v_cvt_pk_bf16_f32 v196, v168, v169
    v_cvt_pk_bf16_f32 v197, v170, v171
    v_cvt_pk_bf16_f32 v198, v172, v173
    v_cvt_pk_bf16_f32 v199, v174, v175
    v_mfma_f32_32x32x16_bf16 v[224:239], v[144:147], v[192:195], v[224:239]
    s_nop 0
    v_mfma_f32_32x32x16_bf16 v[224:239], v[148:151], v[196:199], v[224:239]
    s_nop 15
    v_subrev_u32 v10, 4096, v10
    s_add_u32 s80, s80, 1
    s_cmp_le_u32 s80, s79
    s_cbranch_scc1 L_fl_95
    v_rcp_f32 v10, v216
    v_rcp_f32 v12, v224
    s_nop 1
    s_branch L_attok_67
L_textend:
.if (L_textend - L_pc) < 32768
.error "code prefetch reads past the code"
.endif
.section .rodata,"a"
.p2align 6
.amdhsa_kernel adaLN_cond__sliding_block__dense_activation_relu__prompt_kernel
  .amdhsa_next_free_vgpr 512
  .amdhsa_next_free_sgpr 102
  .amdhsa_accum_offset 256
  .amdhsa_group_segment_fixed_size 0
  .amdhsa_kernarg_size 88
  .amdhsa_user_sgpr_count 2
  .amdhsa_user_sgpr_kernarg_segment_ptr 1
  .amdhsa_system_sgpr_workgroup_id_x 1
  .amdhsa_float_denorm_mode_32 3
.end_amdhsa_kernel
```
